```python
import torch

def _softmax(x, axis=-1):
    return torch.softmax(x, dim=axis)
def _gelu(x):
    return torch.nn.functional.gelu(x, approximate="tanh")
def _silu(x):
    return torch.nn.functional.silu(x)
def _sigmoid(x):
    return torch.sigmoid(x)
def _layernorm(x, axis=-1, eps=1e-5):
    m = x.mean(dim=axis, keepdim=True)
    v = x.var(dim=axis, keepdim=True, unbiased=False)
    return (x - m) / torch.sqrt(v + eps)
def _scatter_add(tgt, idx, src, axis=0):
    return tgt.clone().index_add_(axis, idx, src)
def _segment_sum(src, seg, n):
    out = torch.zeros((n,) + src.shape[1:], dtype=src.dtype)
    return out.index_add_(0, seg, src)
def _pad(x, pw):
    flat = tuple(v for pair in reversed(pw) for v in pair)
    return torch.nn.functional.pad(x, flat)

kernel_name = 'concat_heads__gqa_block_cached__gqa_block_cached__near_ridge'

def setup_inputs():

    _w = (lambda a: (lambda t: t.to(torch.bfloat16) if t.is_floating_point() else t)(torch.as_tensor(a)))
    def _A_setup():
        B, Sq, D = 8, 48, 1024
        Hq, Hkv, Sk, Dh = 32, 4, 1024, 128
        assert Hq % Hkv == 0, (Hq, Hkv)
        return {
            "x": _w((lambda *s: torch.randn(*s, dtype=torch.bfloat16) * 0.8)(B, Sq, D)),
            "k_cache": _w((lambda *s: torch.randn(*s, dtype=torch.bfloat16) * 0.8)(B, Hkv, Sk, Dh)),
            "v_cache": _w((lambda *s: torch.randn(*s, dtype=torch.bfloat16) * 0.05)(B, Hkv, Sk, Dh)),
            "wq": _w((lambda *s: torch.randn(*s, dtype=torch.bfloat16) * 0.8)(D, Hq * Dh) * (D ** -0.5)),
            "wo": _w((lambda *s: torch.randn(*s, dtype=torch.bfloat16) * 0.05)(Hq * Dh, D) * ((Hq * Dh) ** -0.5)),
        }
    _A_in = _A_setup()

    def _B_setup():
        B, Sq, D = 8, 48, 1024
        Hq, Hkv, Sk, Dh = 32, 4, 1024, 128
        assert Hq % Hkv == 0, (Hq, Hkv)
        return {
            "x": _w((lambda *s: torch.randn(*s, dtype=torch.bfloat16) * 0.8)(B, Sq, D)),
            "k_cache": _w((lambda *s: torch.randn(*s, dtype=torch.bfloat16) * 0.8)(B, Hkv, Sk, Dh)),
            "v_cache": _w((lambda *s: torch.randn(*s, dtype=torch.bfloat16) * 0.05)(B, Hkv, Sk, Dh)),
            "wq": _w((lambda *s: torch.randn(*s, dtype=torch.bfloat16) * 0.8)(D, Hq * Dh) * (D ** -0.5)),
            "wo": _w((lambda *s: torch.randn(*s, dtype=torch.bfloat16) * 0.05)(Hq * Dh, D) * ((Hq * Dh) ** -0.5)),
        }
    _B_in = _B_setup()

    return {
        "A_x": _A_in["x"],
        "A_k_cache": _A_in["k_cache"],
        "A_v_cache": _A_in["v_cache"],
        "A_wq": _A_in["wq"],
        "A_wo": _A_in["wo"],
        "B_x": _B_in["x"],
        "B_k_cache": _B_in["k_cache"],
        "B_v_cache": _B_in["v_cache"],
        "B_wq": _B_in["wq"],
        "B_wo": _B_in["wo"],
    }

def reference(A_x, A_k_cache, A_v_cache, A_wq, A_wo, B_x, B_k_cache, B_v_cache, B_wq, B_wo):
    def _A_ref(x, k_cache, v_cache, wq, wo):
        B, Sq, D = x.shape
        Hq, Dh = 32, 128
        Hkv = k_cache.shape[1]
        rep = Hq // Hkv
        q = (lambda x, *d: x.permute(*d))((x @ wq).reshape(B, Sq, Hq, Dh), 0, 2, 1, 3)
        k = (lambda x, n, axis: torch.repeat_interleave(x, n, dim=axis))(k_cache, rep, axis=1)
        v = (lambda x, n, axis: torch.repeat_interleave(x, n, dim=axis))(v_cache, rep, axis=1)
        scores = torch.einsum("bhqd,bhkd->bhqk", q, k) * (Dh ** -0.5)
        p = _softmax(scores, axis=-1)
        o = torch.einsum("bhqk,bhkd->bhqd", p, v)
        return (lambda x, *d: x.permute(*d))(o, 0, 2, 1, 3).reshape(B, Sq, Hq * Dh) @ wo

    def _B_ref(x, k_cache, v_cache, wq, wo):
        B, Sq, D = x.shape
        Hq, Dh = 32, 128
        Hkv = k_cache.shape[1]
        rep = Hq // Hkv
        q = (lambda x, *d: x.permute(*d))((x @ wq).reshape(B, Sq, Hq, Dh), 0, 2, 1, 3)
        k = (lambda x, n, axis: torch.repeat_interleave(x, n, dim=axis))(k_cache, rep, axis=1)
        v = (lambda x, n, axis: torch.repeat_interleave(x, n, dim=axis))(v_cache, rep, axis=1)
        scores = torch.einsum("bhqd,bhkd->bhqk", q, k) * (Dh ** -0.5)
        p = _softmax(scores, axis=-1)
        o = torch.einsum("bhqk,bhkd->bhqd", p, v)
        return (lambda x, *d: x.permute(*d))(o, 0, 2, 1, 3).reshape(B, Sq, Hq * Dh) @ wo

    a = _A_ref(A_x, A_k_cache, A_v_cache, A_wq, A_wo)
    b = _B_ref(B_x, B_k_cache, B_v_cache, B_wq, B_wo)
    return torch.concatenate([a, b], axis=-1)
```

```asm
; @launch kernel=gqa_fused_kernel grid=(256,1,1) block=(768,1,1) lds=163840
.amdgcn_target "amdgcn-amd-amdhsa--gfx950"
.text
.globl gqa_fused_kernel
.p2align 8
.type gqa_fused_kernel,@function
gqa_fused_kernel:
    s_cmp_ge_u32 s2, 256
    s_cbranch_scc1 L_end
    s_load_dwordx16 s[48:63], s[0:1], 0
    s_load_dwordx8 s[64:71], s[0:1], 64
    s_load_dwordx2 s[72:73], s[0:1], 96
    v_lshrrev_b32 v1, 6, v0
    v_and_b32 v163, 63, v0
    s_and_b32 s3, s2, 7
    v_readfirstlane_b32 s28, v1
    s_lshr_b32 s29, s3, 2
    s_and_b32 s30, s3, 3
    s_lshr_b32 s3, s2, 3
    s_lshr_b32 s31, s3, 2
    s_and_b32 s32, s3, 3
    s_and_b32 s33, s28, 3
    s_lshr_b32 s34, s28, 2
    s_cmp_ge_u32 s28, 8
    s_cbranch_scc1 L_p1_compute
    s_lshl_b32 s45, s30, 11
    s_lshl_b32 s3, s32, 9
    s_add_u32 s45, s45, s3
    s_mul_i32 s46, s31, 98304
    v_lshrrev_b32 v128, 5, v163
    v_and_b32 v129, 31, v163
    s_and_b32 s42, s28, 1
    s_lshl_b32 s42, s42, 2
    v_or_b32 v130, s42, v128
    v_lshlrev_b32 v131, 1, v130
    v_xor_b32 v131, v131, v129
    v_lshlrev_b32 v131, 4, v131
    v_lshlrev_b32 v132, 13, v128
    v_add_u32 v136, v132, v131
    v_xor_b32 v131, 64, v131
    v_add_u32 v137, v132, v131
    s_mul_i32 s42, s28, 8
    v_lshrrev_b32 v128, 3, v163
    v_add_u32 v128, s42, v128
    v_lshrrev_b32 v129, 1, v128
    v_xor_b32 v129, v129, v163
    v_and_b32 v129, 7, v129
    v_lshlrev_b32 v129, 4, v129
    v_lshlrev_b32 v128, 11, v128
    v_add_u32 v138, v128, v129
    s_lshl_b32 s43, s28, 16
    s_add_u32 s45, s45, s43
    s_lshl_b32 s43, s28, 12
    s_mul_i32 s44, s28, 1024
    s_add_u32 s44, s44, 32768
    s_mul_i32 s3, s32, 2
    s_add_u32 s3, s3, s31
    s_and_b32 s3, s3, 7
    s_mov_b32 s4, 1985225008
    s_mov_b32 s5, 4275874232
    s_cmp_eq_u32 s3, 1
    s_cselect_b32 s4, 1985160208, s4
    s_cselect_b32 s5, 4275809432, s5
    s_cmp_eq_u32 s3, 2
    s_cselect_b32 s4, 1984123408, s4
    s_cselect_b32 s5, 4274772632, s5
    s_cmp_eq_u32 s3, 3
    s_cselect_b32 s4, 1967534593, s4
    s_cselect_b32 s5, 4258183832, s5
    s_cmp_eq_u32 s3, 4
    s_cselect_b32 s4, 1702113793, s4
    s_cselect_b32 s5, 3992763032, s5
    s_cmp_eq_u32 s3, 5
    s_cselect_b32 s4, 1750348289, s4
    s_cselect_b32 s5, 4275878551, s5
    s_cmp_eq_u32 s3, 6
    s_cselect_b32 s4, 2522099970, s4
    s_cselect_b32 s5, 4275878535, s5
    s_cmp_eq_u32 s3, 7
    s_cselect_b32 s4, 1985229058, s4
    s_cselect_b32 s5, 4275878282, s5
    s_mul_i32 s6, s32, 4
    s_cmp_eq_u32 s29, 0
    s_waitcnt lgkmcnt(0)
    s_cselect_b32 s8, s48, s58
    s_cselect_b32 s9, s49, s59
    s_mov_b32 s10, 786432
    s_mov_b32 s11, 0x00020000
    s_cselect_b32 s12, s54, s64
    s_cselect_b32 s13, s55, s65
    s_mov_b32 s14, 8388608
    s_mov_b32 s15, 0x00020000
    s_mov_b32 s75, 0
    s_mov_b32 s78, 0
    s_lshl_b32 s3, s75, 2
    s_lshr_b64 s[76:77], s[4:5], s3
    s_add_u32 s3, s76, s6
    s_and_b32 s3, s3, 15
    s_lshl_b32 s76, s3, 19
    s_add_u32 s76, s76, s45
    s_add_u32 s77, s78, s43
    s_lshl_b32 s79, s3, 7
    s_add_u32 s79, s79, s46
    s_add_u32 s74, s78, s44
    s_mov_b32 m0, s77
    s_nop 0
    buffer_load_dwordx4 v136, s[12:15], s76 offen lds
    s_add_u32 m0, s77, 1024
    s_add_u32 s76, s76, 16384
    buffer_load_dwordx4 v137, s[12:15], s76 offen lds
    s_add_u32 m0, s77, 2048
    s_add_u32 s76, s76, 16384
    buffer_load_dwordx4 v136, s[12:15], s76 offen lds
    s_add_u32 m0, s77, 3072
    s_add_u32 s76, s76, 16384
    buffer_load_dwordx4 v137, s[12:15], s76 offen lds
    s_cmp_lt_u32 s28, 6
    s_cbranch_scc0 L_nox_1
    s_mov_b32 m0, s74
    s_nop 0
    buffer_load_dwordx4 v138, s[8:11], s79 offen lds
L_nox_1:
    s_mov_b32 s75, 1
    s_mov_b32 s78, 40960
    s_lshl_b32 s3, s75, 2
    s_lshr_b64 s[76:77], s[4:5], s3
    s_add_u32 s3, s76, s6
    s_and_b32 s3, s3, 15
    s_lshl_b32 s76, s3, 19
    s_add_u32 s76, s76, s45
    s_add_u32 s77, s78, s43
    s_lshl_b32 s79, s3, 7
    s_add_u32 s79, s79, s46
    s_add_u32 s74, s78, s44
    s_mov_b32 m0, s77
    s_nop 0
    buffer_load_dwordx4 v136, s[12:15], s76 offen lds
    s_add_u32 m0, s77, 1024
    s_add_u32 s76, s76, 16384
    buffer_load_dwordx4 v137, s[12:15], s76 offen lds
    s_add_u32 m0, s77, 2048
    s_add_u32 s76, s76, 16384
    buffer_load_dwordx4 v136, s[12:15], s76 offen lds
    s_add_u32 m0, s77, 3072
    s_add_u32 s76, s76, 16384
    buffer_load_dwordx4 v137, s[12:15], s76 offen lds
    s_cmp_lt_u32 s28, 6
    s_cbranch_scc0 L_nox_2
    s_mov_b32 m0, s74
    s_nop 0
    buffer_load_dwordx4 v138, s[8:11], s79 offen lds
L_nox_2:
    s_mov_b32 s75, 2
    s_mov_b32 s78, 81920
    s_or_b32 s3, s2, s28
    s_cmp_eq_u32 s3, 0
    s_cbranch_scc0 L_notok
    s_memrealtime s[76:77]
    s_mov_b32 s16, s70
    s_mov_b32 s17, s71
    s_mov_b32 s18, 256
    s_mov_b32 s19, 0x00020000
    v_mov_b32 v128, 0
    s_waitcnt lgkmcnt(0)
    s_or_b32 s76, s76, 1
    v_mov_b32 v129, s76
    s_mov_b64 exec, 1
    buffer_store_dword v129, v128, s[16:19], 0 offen sc1
    s_mov_b64 exec, -1
L_notok:
    s_cmp_eq_u32 s29, 0
    s_cselect_b32 s16, s50, s60
    s_cselect_b32 s17, s51, s61
    s_mov_b32 s18, 8388608
    s_mov_b32 s19, 0x00020000
    s_cselect_b32 s20, s52, s62
    s_cselect_b32 s21, s53, s63
    s_mov_b32 s22, 8388608
    s_mov_b32 s23, 0x00020000
    s_mov_b32 s24, s72
    s_mov_b32 s25, s73
    s_mov_b32 s26, 268435456
    s_mov_b32 s27, 0x00020000
    s_lshr_b32 s54, s31, 1
    s_and_b32 s55, s31, 1
    s_lshl_b32 s55, s55, 2
    s_add_u32 s55, s55, s32
    s_lshl_b32 s58, s29, 2
    s_add_u32 s58, s58, s30
    s_lshl_b32 s58, s58, 2
    s_add_u32 s58, s58, s54
    s_lshl_b32 s59, s29, 2
    s_add_u32 s59, s59, s54
    s_lshl_b32 s59, s59, 3
    s_add_u32 s59, s59, s55
    s_lshl_b32 s3, s31, 2
    s_add_u32 s3, s3, s30
    s_lshl_b32 s47, s3, 18
    s_lshl_b32 s3, s33, 16
    s_add_u32 s47, s47, s3
    v_lshrrev_b32 v128, 4, v163
    v_and_b32 v129, 15, v163
    v_lshlrev_b32 v130, 8, v128
    v_xor_b32 v131, v129, v128
    v_lshlrev_b32 v132, 4, v131
    v_add_u32 v164, v130, v132
    v_xor_b32 v132, 64, v132
    v_add_u32 v165, v130, v132
    v_xor_b32 v132, 0xc0, v132
    v_add_u32 v166, v130, v132
    v_xor_b32 v132, 64, v132
    v_add_u32 v167, v130, v132
    s_cmp_eq_u32 s34, 0
    s_cbranch_scc1 L_voff_done
    v_lshlrev_b32 v131, 2, v128
    v_xor_b32 v131, v131, v129
    v_lshlrev_b32 v131, 4, v131
    v_add_u32 v164, v130, v131
L_voff_done:
    s_mov_b32 s7, 0
    s_mov_b32 s7, 1969500448
    s_cmp_eq_u32 s32, 1
    s_mov_b32 s63, 1733567248
    s_cselect_b32 s7, s63, s7
    s_cmp_eq_u32 s32, 2
    s_mov_b32 s63, 1985167873
    s_cselect_b32 s7, s63, s7
    s_cmp_eq_u32 s32, 3
    s_mov_b32 s63, 1984246273
    s_cselect_b32 s7, s63, s7
    s_mul_i32 s62, s32, 1
    v_and_b32 v160, 31, v163
    v_lshlrev_b32 v160, 8, v160
    v_lshrrev_b32 v161, 5, v163
    v_and_b32 v162, 15, v163
    v_xor_b32 v161, v161, v162
    v_lshlrev_b32 v161, 4, v161
    v_add_u32 v160, v160, v161
    s_add_u32 s3, s34, 1
    s_mul_i32 s3, s3, 40960
    s_add_u32 s3, s3, 16384
    s_mul_i32 s76, s33, 40960
    v_xor_b32 v161, 0, v160
    v_add_u32 v112, s3, v161
    v_add_u32 v144, s76, v161
    v_xor_b32 v161, 32, v160
    v_add_u32 v113, s3, v161
    v_add_u32 v145, s76, v161
    v_xor_b32 v161, 64, v160
    v_add_u32 v114, s3, v161
    v_add_u32 v146, s76, v161
    v_xor_b32 v161, 96, v160
    v_add_u32 v115, s3, v161
    v_add_u32 v147, s76, v161
    v_xor_b32 v161, 128, v160
    v_add_u32 v116, s3, v161
    v_add_u32 v148, s76, v161
    v_xor_b32 v161, 160, v160
    v_add_u32 v117, s3, v161
    v_add_u32 v149, s76, v161
    v_xor_b32 v161, 192, v160
    v_add_u32 v118, s3, v161
    v_add_u32 v150, s76, v161
    v_xor_b32 v161, 224, v160
    v_add_u32 v119, s3, v161
    v_add_u32 v151, s76, v161
    v_lshrrev_b32 v160, 5, v163
    v_lshlrev_b32 v160, 2, v160
    v_bfe_u32 v161, v163, 2, 2
    v_add_u32 v160, v160, v161
    v_lshlrev_b32 v160, 8, v160
    v_bfe_u32 v162, v163, 4, 1
    v_lshlrev_b32 v162, 5, v162
    v_add_u32 v160, v160, v162
    v_and_b32 v162, 3, v163
    v_lshlrev_b32 v162, 3, v162
    v_add_u32 v160, v160, v162
    s_add_u32 s76, s76, 24576
    v_add_u32 v160, s76, v160
    s_add_u32 s3, s33, 0
    s_and_b32 s3, s3, 3
    v_xor_b32 v162, s3, v161
    v_lshlrev_b32 v162, 6, v162
    v_add_u32 v152, v160, v162
    s_add_u32 s3, s33, 1
    s_and_b32 s3, s3, 3
    v_xor_b32 v162, s3, v161
    v_lshlrev_b32 v162, 6, v162
    v_add_u32 v153, v160, v162
    s_add_u32 s3, s33, 2
    s_and_b32 s3, s3, 3
    v_xor_b32 v162, s3, v161
    v_lshlrev_b32 v162, 6, v162
    v_add_u32 v154, v160, v162
    s_add_u32 s3, s33, 3
    s_and_b32 s3, s3, 3
    v_xor_b32 v162, s3, v161
    v_lshlrev_b32 v162, 6, v162
    v_add_u32 v155, v160, v162
    v_mov_b32 v0, 0
    v_mov_b32 v1, 0
    v_mov_b32 v2, 0
    v_mov_b32 v3, 0
    v_mov_b32 v4, 0
    v_mov_b32 v5, 0
    v_mov_b32 v6, 0
    v_mov_b32 v7, 0
    v_mov_b32 v8, 0
    v_mov_b32 v9, 0
    v_mov_b32 v10, 0
    v_mov_b32 v11, 0
    v_mov_b32 v12, 0
    v_mov_b32 v13, 0
    v_mov_b32 v14, 0
    v_mov_b32 v15, 0
    v_mov_b32 v16, 0
    v_mov_b32 v17, 0
    v_mov_b32 v18, 0
    v_mov_b32 v19, 0
    v_mov_b32 v20, 0
    v_mov_b32 v21, 0
    v_mov_b32 v22, 0
    v_mov_b32 v23, 0
    v_mov_b32 v24, 0
    v_mov_b32 v25, 0
    v_mov_b32 v26, 0
    v_mov_b32 v27, 0
    v_mov_b32 v28, 0
    v_mov_b32 v29, 0
    v_mov_b32 v30, 0
    v_mov_b32 v31, 0
    v_mov_b32 v32, 0
    v_mov_b32 v33, 0
    v_mov_b32 v34, 0
    v_mov_b32 v35, 0
    v_mov_b32 v36, 0
    v_mov_b32 v37, 0
    v_mov_b32 v38, 0
    v_mov_b32 v39, 0
    v_mov_b32 v40, 0
    v_mov_b32 v41, 0
    v_mov_b32 v42, 0
    v_mov_b32 v43, 0
    v_mov_b32 v44, 0
    v_mov_b32 v45, 0
    v_mov_b32 v46, 0
    v_mov_b32 v47, 0
    v_mov_b32 v48, 0
    v_mov_b32 v49, 0
    v_mov_b32 v50, 0
    v_mov_b32 v51, 0
    v_mov_b32 v52, 0
    v_mov_b32 v53, 0
    v_mov_b32 v54, 0
    v_mov_b32 v55, 0
    v_mov_b32 v56, 0
    v_mov_b32 v57, 0
    v_mov_b32 v58, 0
    v_mov_b32 v59, 0
    v_mov_b32 v60, 0
    v_mov_b32 v61, 0
    v_mov_b32 v62, 0
    v_mov_b32 v63, 0
    s_mov_b32 s37, 1098907648
    s_mov_b32 s36, 3263168512
    s_mov_b64 s[50:51], 0
    v_mov_b32 v156, 0
    v_mov_b32 v159, s37
    v_mov_b32 v157, 0
    s_cmp_lt_u32 s28, 6
    s_cbranch_scc1 L_p1_ld_x
L_p1_ld_loopn:
    s_lshl_b32 s3, s75, 2
    s_lshr_b64 s[76:77], s[4:5], s3
    s_add_u32 s3, s76, s6
    s_and_b32 s3, s3, 15
    s_lshl_b32 s76, s3, 19
    s_add_u32 s76, s76, s45
    s_add_u32 s77, s78, s43
    s_lshl_b32 s79, s3, 7
    s_add_u32 s79, s79, s46
    s_add_u32 s74, s78, s44
    s_mov_b32 m0, s77
    s_waitcnt vmcnt(4)
    s_barrier
    buffer_load_dwordx4 v136, s[12:15], s76 offen lds
    s_add_u32 m0, s77, 1024
    s_add_u32 s76, s76, 16384
    buffer_load_dwordx4 v137, s[12:15], s76 offen lds
    s_add_u32 m0, s77, 2048
    s_add_u32 s76, s76, 16384
    buffer_load_dwordx4 v136, s[12:15], s76 offen lds
    s_add_u32 m0, s77, 3072
    s_add_u32 s76, s76, 16384
    buffer_load_dwordx4 v137, s[12:15], s76 offen lds
    s_add_u32 s78, s78, 40960
    s_cmp_eq_u32 s78, 122880
    s_cselect_b32 s78, 0, s78
    s_add_u32 s75, s75, 1
    s_cmp_lt_u32 s75, 16
    s_cbranch_scc1 L_p1_ld_loopn
    s_waitcnt vmcnt(4)
    s_branch L_p1_ld_done
L_p1_ld_x:
L_p1_ld_loop:
    s_lshl_b32 s3, s75, 2
    s_lshr_b64 s[76:77], s[4:5], s3
    s_add_u32 s3, s76, s6
    s_and_b32 s3, s3, 15
    s_lshl_b32 s76, s3, 19
    s_add_u32 s76, s76, s45
    s_add_u32 s77, s78, s43
    s_lshl_b32 s79, s3, 7
    s_add_u32 s79, s79, s46
    s_add_u32 s74, s78, s44
    s_mov_b32 m0, s77
    s_waitcnt vmcnt(5)
    s_barrier
    buffer_load_dwordx4 v136, s[12:15], s76 offen lds
    s_add_u32 m0, s77, 1024
    s_add_u32 s76, s76, 16384
    buffer_load_dwordx4 v137, s[12:15], s76 offen lds
    s_add_u32 m0, s77, 2048
    s_add_u32 s76, s76, 16384
    buffer_load_dwordx4 v136, s[12:15], s76 offen lds
    s_add_u32 m0, s77, 3072
    s_add_u32 s76, s76, 16384
    buffer_load_dwordx4 v137, s[12:15], s76 offen lds
    s_mov_b32 m0, s74
    s_nop 0
    buffer_load_dwordx4 v138, s[8:11], s79 offen lds
    s_add_u32 s78, s78, 40960
    s_cmp_eq_u32 s78, 122880
    s_cselect_b32 s78, 0, s78
    s_add_u32 s75, s75, 1
    s_cmp_lt_u32 s75, 16
    s_cbranch_scc1 L_p1_ld_loop
    s_waitcnt vmcnt(5)
L_p1_ld_done:
    s_barrier
    s_and_b32 s3, s33, 1
    s_cmp_eq_u32 s3, 1
    s_cbranch_scc1 L_w15_early
    s_waitcnt vmcnt(0)
    s_branch L_w15_done
L_w15_early:
    s_call_b64 s[38:39], L_early
    s_waitcnt vmcnt(8)
L_w15_done:
    s_barrier
    s_cmp_eq_u32 s33, 2
    s_cbranch_scc0 L_ne_3
    s_call_b64 s[38:39], L_early
L_ne_3:
    s_barrier
    s_cmp_eq_u32 s33, 0
    s_cbranch_scc0 L_ne_4
    s_call_b64 s[38:39], L_early
L_ne_4:
    s_branch L_p1_join
L_early:
    s_cmp_eq_u32 s34, 0
    s_cbranch_scc0 L_early_v
    s_bfe_u32 s76, s7, 262144
    s_lshl_b32 s76, s76, 13
    s_add_u32 s76, s76, s47
    s_mul_i32 s77, s33, 40960
    s_add_u32 m0, s77, 0
    s_nop 0
    buffer_load_dwordx4 v164, s[16:19], s76 offen offset:0 lds
    buffer_load_dwordx4 v165, s[16:19], s76 offen offset:1024 lds
    buffer_load_dwordx4 v166, s[16:19], s76 offen offset:2048 lds
    buffer_load_dwordx4 v167, s[16:19], s76 offen offset:3072 lds
    s_add_u32 m0, s77, 4096
    s_add_u32 s76, s76, 4096
    buffer_load_dwordx4 v164, s[16:19], s76 offen offset:0 lds
    buffer_load_dwordx4 v165, s[16:19], s76 offen offset:1024 lds
    buffer_load_dwordx4 v166, s[16:19], s76 offen offset:2048 lds
    buffer_load_dwordx4 v167, s[16:19], s76 offen offset:3072 lds
    s_setpc_b64 s[38:39]
L_early_v:
    s_bfe_u32 s76, s7, 262144
    s_lshl_b32 s76, s76, 13
    s_add_u32 s76, s76, s47
    s_mul_i32 s77, s33, 40960
    s_add_u32 m0, s77, 24576
    s_nop 0
    buffer_load_dwordx4 v164, s[20:23], s76 offen offset:0 lds
    buffer_load_dwordx4 v164, s[20:23], s76 offen offset:1024 lds
    buffer_load_dwordx4 v164, s[20:23], s76 offen offset:2048 lds
    buffer_load_dwordx4 v164, s[20:23], s76 offen offset:3072 lds
    s_add_u32 m0, s77, 28672
    s_add_u32 s76, s76, 4096
    buffer_load_dwordx4 v164, s[20:23], s76 offen offset:0 lds
    buffer_load_dwordx4 v164, s[20:23], s76 offen offset:1024 lds
    buffer_load_dwordx4 v164, s[20:23], s76 offen offset:2048 lds
    buffer_load_dwordx4 v164, s[20:23], s76 offen offset:3072 lds
    s_setpc_b64 s[38:39]
L_p1_compute:
    v_lshrrev_b32 v110, 4, v163
    v_and_b32 v111, 15, v163
    v_lshrrev_b32 v112, 2, v111
    v_and_b32 v113, 3, v111
    v_lshlrev_b32 v114, 3, v110
    v_add_u32 v114, v114, v112
    v_lshlrev_b32 v114, 9, v114
    v_lshlrev_b32 v113, 3, v113
    v_add_u32 v114, v114, v113
    v_and_b32 v115, 1, v110
    v_lshlrev_b32 v115, 2, v115
    v_or_b32 v115, v115, v112
    s_lshl_b32 s41, s33, 2
    s_add_u32 s42, s41, 0
    v_xor_b32 v116, s42, v115
    v_lshlrev_b32 v116, 5, v116
    v_add_u32 v104, v114, v116
    s_add_u32 s42, s41, 1
    v_xor_b32 v116, s42, v115
    v_lshlrev_b32 v116, 5, v116
    v_add_u32 v105, v114, v116
    s_add_u32 s42, s41, 2
    v_xor_b32 v116, s42, v115
    v_lshlrev_b32 v116, 5, v116
    v_add_u32 v106, v114, v116
    s_add_u32 s42, s41, 3
    v_xor_b32 v116, s42, v115
    v_lshlrev_b32 v116, 5, v116
    v_add_u32 v107, v114, v116
    v_lshrrev_b32 v112, 1, v111
    v_xor_b32 v112, v112, v110
    v_lshlrev_b32 v112, 4, v112
    v_lshlrev_b32 v113, 7, v111
    v_add_u32 v112, v112, v113
    v_add_u32 v108, 32768, v112
    v_xor_b32 v109, 64, v108
    v_mov_b32 v0, 0
    v_mov_b32 v1, 0
    v_mov_b32 v2, 0
    v_mov_b32 v3, 0
    v_mov_b32 v4, 0
    v_mov_b32 v5, 0
    v_mov_b32 v6, 0
    v_mov_b32 v7, 0
    v_mov_b32 v8, 0
    v_mov_b32 v9, 0
    v_mov_b32 v10, 0
    v_mov_b32 v11, 0
    v_mov_b32 v12, 0
    v_mov_b32 v13, 0
    v_mov_b32 v14, 0
    v_mov_b32 v15, 0
    v_mov_b32 v16, 0
    v_mov_b32 v17, 0
    v_mov_b32 v18, 0
    v_mov_b32 v19, 0
    v_mov_b32 v20, 0
    v_mov_b32 v21, 0
    v_mov_b32 v22, 0
    v_mov_b32 v23, 0
    v_mov_b32 v24, 0
    v_mov_b32 v25, 0
    v_mov_b32 v26, 0
    v_mov_b32 v27, 0
    v_mov_b32 v28, 0
    v_mov_b32 v29, 0
    v_mov_b32 v30, 0
    v_mov_b32 v31, 0
    v_mov_b32 v32, 0
    v_mov_b32 v33, 0
    v_mov_b32 v34, 0
    v_mov_b32 v35, 0
    v_mov_b32 v36, 0
    v_mov_b32 v37, 0
    v_mov_b32 v38, 0
    v_mov_b32 v39, 0
    v_mov_b32 v40, 0
    v_mov_b32 v41, 0
    v_mov_b32 v42, 0
    v_mov_b32 v43, 0
    v_mov_b32 v44, 0
    v_mov_b32 v45, 0
    v_mov_b32 v46, 0
    v_mov_b32 v47, 0
    v_mov_b32 v164, 0
    v_mov_b32 v165, 0
    v_mov_b32 v166, 0
    v_mov_b32 v167, 0
    v_and_b32 v160, 31, v163
    v_lshlrev_b32 v160, 8, v160
    v_lshrrev_b32 v161, 5, v163
    v_and_b32 v162, 15, v163
    v_xor_b32 v161, v161, v162
    v_lshlrev_b32 v161, 4, v161
    v_add_u32 v160, v160, v161
    s_add_u32 s3, s34, 1
    s_mul_i32 s3, s3, 40960
    s_add_u32 s3, s3, 16384
    s_mul_i32 s76, s33, 40960
    v_xor_b32 v161, 0, v160
    v_add_u32 v128, s3, v161
    v_add_u32 v144, s76, v161
    v_xor_b32 v161, 32, v160
    v_add_u32 v129, s3, v161
    v_add_u32 v145, s76, v161
    v_xor_b32 v161, 64, v160
    v_add_u32 v130, s3, v161
    v_add_u32 v146, s76, v161
    v_xor_b32 v161, 96, v160
    v_add_u32 v131, s3, v161
    v_add_u32 v147, s76, v161
    v_xor_b32 v161, 128, v160
    v_add_u32 v132, s3, v161
    v_add_u32 v148, s76, v161
    v_xor_b32 v161, 160, v160
    v_add_u32 v133, s3, v161
    v_add_u32 v149, s76, v161
    v_xor_b32 v161, 192, v160
    v_add_u32 v134, s3, v161
    v_add_u32 v150, s76, v161
    v_xor_b32 v161, 224, v160
    v_add_u32 v135, s3, v161
    v_add_u32 v151, s76, v161
    v_lshrrev_b32 v160, 5, v163
    v_lshlrev_b32 v160, 2, v160
    v_bfe_u32 v161, v163, 2, 2
    v_add_u32 v160, v160, v161
    v_lshlrev_b32 v160, 8, v160
    v_bfe_u32 v162, v163, 4, 1
    v_lshlrev_b32 v162, 5, v162
    v_add_u32 v160, v160, v162
    v_and_b32 v162, 3, v163
    v_lshlrev_b32 v162, 3, v162
    v_add_u32 v160, v160, v162
    s_add_u32 s76, s76, 24576
    v_add_u32 v160, s76, v160
    s_add_u32 s3, s33, 0
    s_and_b32 s3, s3, 3
    v_xor_b32 v162, s3, v161
    v_lshlrev_b32 v162, 6, v162
    v_add_u32 v152, v160, v162
    s_add_u32 s3, s33, 1
    s_and_b32 s3, s3, 3
    v_xor_b32 v162, s3, v161
    v_lshlrev_b32 v162, 6, v162
    v_add_u32 v153, v160, v162
    s_add_u32 s3, s33, 2
    s_and_b32 s3, s3, 3
    v_xor_b32 v162, s3, v161
    v_lshlrev_b32 v162, 6, v162
    v_add_u32 v154, v160, v162
    s_add_u32 s3, s33, 3
    s_and_b32 s3, s3, 3
    v_xor_b32 v162, s3, v161
    v_lshlrev_b32 v162, 6, v162
    v_add_u32 v155, v160, v162
    s_waitcnt lgkmcnt(0)
    s_mov_b32 s24, s72
    s_mov_b32 s25, s73
    s_mov_b32 s26, 268435456
    s_mov_b32 s27, 0x00020000
    s_cmp_eq_u32 s29, 0
    s_cselect_b32 s12, s56, s66
    s_cselect_b32 s13, s57, s67
    s_mov_b32 s14, 8388608
    s_mov_b32 s15, 0x00020000
    s_cselect_b32 s20, s52, s62
    s_cselect_b32 s21, s53, s63
    s_mov_b32 s22, 8388608
    s_mov_b32 s23, 0x00020000
    s_lshr_b32 s54, s31, 1
    s_and_b32 s55, s31, 1
    s_lshl_b32 s55, s55, 2
    s_add_u32 s55, s55, s32
    s_lshl_b32 s58, s29, 2
    s_add_u32 s58, s58, s30
    s_lshl_b32 s58, s58, 2
    s_add_u32 s58, s58, s54
    s_lshl_b32 s59, s29, 2
    s_add_u32 s59, s59, s54
    s_lshl_b32 s59, s59, 3
    s_add_u32 s59, s59, s55
    s_mov_b32 s16, s70
    s_mov_b32 s17, s71
    s_mov_b32 s18, 256
    s_mov_b32 s19, 0x00020000
    s_mov_b32 s40, 0
    s_mov_b32 s75, 0
    s_mov_b32 s78, 0
    v_lshrrev_b32 v165, 1, v163
    v_lshlrev_b32 v165, 11, v165
    v_and_b32 v166, 1, v163
    v_lshlrev_b32 v166, 7, v166
    v_add_u32 v165, v165, v166
    v_add_u32 v165, 60, v165
    s_lshl_b32 s45, s30, 10
    s_add_u32 s3, s32, s33
    s_and_b32 s3, s3, 3
    s_lshl_b32 s3, s3, 8
    s_add_u32 s45, s45, s3
    s_lshl_b32 s3, s54, 6
    s_add_u32 s45, s45, s3
    s_lshl_b32 s45, s45, 11
    s_lshl_b32 s3, s55, 8
    s_add_u32 s45, s45, s3
    s_barrier
    ds_read_b128 v[80:83], v108 offset:0
    ds_read_b128 v[84:87], v108 offset:2048
    ds_read_b128 v[88:91], v108 offset:4096
    ds_read_b64_tr_b16 v[48:49], v104 offset:0
    ds_read_b64_tr_b16 v[50:51], v104 offset:2048
    ds_read_b64_tr_b16 v[52:53], v105 offset:0
    ds_read_b64_tr_b16 v[54:55], v105 offset:2048
    ds_read_b64_tr_b16 v[56:57], v106 offset:0
    ds_read_b64_tr_b16 v[58:59], v106 offset:2048
    ds_read_b64_tr_b16 v[60:61], v107 offset:0
    ds_read_b64_tr_b16 v[62:63], v107 offset:2048
    s_waitcnt lgkmcnt(6)
    v_mfma_f32_16x16x32_bf16 v[0:3], v[48:51], v[80:83], v[0:3]
    ds_read_b128 v[92:95], v109 offset:0
    ds_read_b128 v[96:99], v109 offset:2048
    v_mfma_f32_16x16x32_bf16 v[4:7], v[48:51], v[84:87], v[4:7]
    ds_read_b128 v[100:103], v109 offset:4096
    ds_read_b64_tr_b16 v[64:65], v104 offset:16384
    v_mfma_f32_16x16x32_bf16 v[8:11], v[48:51], v[88:91], v[8:11]
    ds_read_b64_tr_b16 v[66:67], v104 offset:18432
    ds_read_b64_tr_b16 v[68:69], v105 offset:16384
    s_waitcnt lgkmcnt(10)
    v_mfma_f32_16x16x32_bf16 v[12:15], v[52:55], v[80:83], v[12:15]
    ds_read_b64_tr_b16 v[70:71], v105 offset:18432
    ds_read_b64_tr_b16 v[72:73], v106 offset:16384
    v_mfma_f32_16x16x32_bf16 v[16:19], v[52:55], v[84:87], v[16:19]
    ds_read_b64_tr_b16 v[74:75], v106 offset:18432
    ds_read_b64_tr_b16 v[76:77], v107 offset:16384
    v_mfma_f32_16x16x32_bf16 v[20:23], v[52:55], v[88:91], v[20:23]
    ds_read_b64_tr_b16 v[78:79], v107 offset:18432
    s_waitcnt lgkmcnt(13)
    v_mfma_f32_16x16x32_bf16 v[24:27], v[56:59], v[80:83], v[24:27]
    v_add_u32 v104, 40960, v104
    v_mfma_f32_16x16x32_bf16 v[28:31], v[56:59], v[84:87], v[28:31]
    v_add_u32 v105, 40960, v105
    v_mfma_f32_16x16x32_bf16 v[32:35], v[56:59], v[88:91], v[32:35]
    v_add_u32 v106, 40960, v106
    s_waitcnt lgkmcnt(11)
    v_mfma_f32_16x16x32_bf16 v[36:39], v[60:63], v[80:83], v[36:39]
    v_add_u32 v107, 40960, v107
    v_mfma_f32_16x16x32_bf16 v[40:43], v[60:63], v[84:87], v[40:43]
    v_add_u32 v108, 40960, v108
    v_mfma_f32_16x16x32_bf16 v[44:47], v[60:63], v[88:91], v[44:47]
    v_add_u32 v109, 40960, v109
    s_waitcnt lgkmcnt(0)
    s_barrier
    s_waitcnt lgkmcnt(6)
    v_mfma_f32_16x16x32_bf16 v[0:3], v[64:67], v[92:95], v[0:3]
    ds_read_b128 v[80:83], v108 offset:0
    ds_read_b128 v[84:87], v108 offset:2048
    v_mfma_f32_16x16x32_bf16 v[4:7], v[64:67], v[96:99], v[4:7]
    ds_read_b128 v[88:91], v108 offset:4096
    ds_read_b64_tr_b16 v[48:49], v104 offset:0
    v_mfma_f32_16x16x32_bf16 v[8:11], v[64:67], v[100:103], v[8:11]
    ds_read_b64_tr_b16 v[50:51], v104 offset:2048
    ds_read_b64_tr_b16 v[52:53], v105 offset:0
    s_waitcnt lgkmcnt(10)
    v_mfma_f32_16x16x32_bf16 v[12:15], v[68:71], v[92:95], v[12:15]
    ds_read_b64_tr_b16 v[54:55], v105 offset:2048
    ds_read_b64_tr_b16 v[56:57], v106 offset:0
    v_mfma_f32_16x16x32_bf16 v[16:19], v[68:71], v[96:99], v[16:19]
    ds_read_b64_tr_b16 v[58:59], v106 offset:2048
    ds_read_b64_tr_b16 v[60:61], v107 offset:0
    v_mfma_f32_16x16x32_bf16 v[20:23], v[68:71], v[100:103], v[20:23]
    ds_read_b64_tr_b16 v[62:63], v107 offset:2048
    s_waitcnt lgkmcnt(13)
    v_mfma_f32_16x16x32_bf16 v[24:27], v[72:75], v[92:95], v[24:27]
    v_mfma_f32_16x16x32_bf16 v[28:31], v[72:75], v[96:99], v[28:31]
    v_mfma_f32_16x16x32_bf16 v[32:35], v[72:75], v[100:103], v[32:35]
    s_waitcnt lgkmcnt(11)
    v_mfma_f32_16x16x32_bf16 v[36:39], v[76:79], v[92:95], v[36:39]
    v_mfma_f32_16x16x32_bf16 v[40:43], v[76:79], v[96:99], v[40:43]
    v_mfma_f32_16x16x32_bf16 v[44:47], v[76:79], v[100:103], v[44:47]
    s_waitcnt lgkmcnt(6)
    v_mfma_f32_16x16x32_bf16 v[0:3], v[48:51], v[80:83], v[0:3]
    ds_read_b128 v[92:95], v109 offset:0
    ds_read_b128 v[96:99], v109 offset:2048
    v_mfma_f32_16x16x32_bf16 v[4:7], v[48:51], v[84:87], v[4:7]
    ds_read_b128 v[100:103], v109 offset:4096
    ds_read_b64_tr_b16 v[64:65], v104 offset:16384
    v_mfma_f32_16x16x32_bf16 v[8:11], v[48:51], v[88:91], v[8:11]
    ds_read_b64_tr_b16 v[66:67], v104 offset:18432
    ds_read_b64_tr_b16 v[68:69], v105 offset:16384
    s_waitcnt lgkmcnt(10)
    v_mfma_f32_16x16x32_bf16 v[12:15], v[52:55], v[80:83], v[12:15]
    ds_read_b64_tr_b16 v[70:71], v105 offset:18432
    ds_read_b64_tr_b16 v[72:73], v106 offset:16384
    v_mfma_f32_16x16x32_bf16 v[16:19], v[52:55], v[84:87], v[16:19]
    ds_read_b64_tr_b16 v[74:75], v106 offset:18432
    ds_read_b64_tr_b16 v[76:77], v107 offset:16384
    v_mfma_f32_16x16x32_bf16 v[20:23], v[52:55], v[88:91], v[20:23]
    ds_read_b64_tr_b16 v[78:79], v107 offset:18432
    s_waitcnt lgkmcnt(13)
    v_mfma_f32_16x16x32_bf16 v[24:27], v[56:59], v[80:83], v[24:27]
    v_add_u32 v104, 40960, v104
    v_mfma_f32_16x16x32_bf16 v[28:31], v[56:59], v[84:87], v[28:31]
    v_add_u32 v105, 40960, v105
    v_mfma_f32_16x16x32_bf16 v[32:35], v[56:59], v[88:91], v[32:35]
    v_add_u32 v106, 40960, v106
    s_waitcnt lgkmcnt(11)
    v_mfma_f32_16x16x32_bf16 v[36:39], v[60:63], v[80:83], v[36:39]
    v_add_u32 v107, 40960, v107
    v_mfma_f32_16x16x32_bf16 v[40:43], v[60:63], v[84:87], v[40:43]
    v_add_u32 v108, 40960, v108
    v_mfma_f32_16x16x32_bf16 v[44:47], v[60:63], v[88:91], v[44:47]
    v_add_u32 v109, 40960, v109
    s_waitcnt lgkmcnt(0)
    s_barrier
    s_waitcnt lgkmcnt(6)
    v_mfma_f32_16x16x32_bf16 v[0:3], v[64:67], v[92:95], v[0:3]
    ds_read_b128 v[80:83], v108 offset:0
    ds_read_b128 v[84:87], v108 offset:2048
    v_mfma_f32_16x16x32_bf16 v[4:7], v[64:67], v[96:99], v[4:7]
    ds_read_b128 v[88:91], v108 offset:4096
    ds_read_b64_tr_b16 v[48:49], v104 offset:0
    v_mfma_f32_16x16x32_bf16 v[8:11], v[64:67], v[100:103], v[8:11]
    ds_read_b64_tr_b16 v[50:51], v104 offset:2048
    ds_read_b64_tr_b16 v[52:53], v105 offset:0
    s_waitcnt lgkmcnt(10)
    v_mfma_f32_16x16x32_bf16 v[12:15], v[68:71], v[92:95], v[12:15]
    ds_read_b64_tr_b16 v[54:55], v105 offset:2048
    ds_read_b64_tr_b16 v[56:57], v106 offset:0
    v_mfma_f32_16x16x32_bf16 v[16:19], v[68:71], v[96:99], v[16:19]
    ds_read_b64_tr_b16 v[58:59], v106 offset:2048
    ds_read_b64_tr_b16 v[60:61], v107 offset:0
    v_mfma_f32_16x16x32_bf16 v[20:23], v[68:71], v[100:103], v[20:23]
    ds_read_b64_tr_b16 v[62:63], v107 offset:2048
    s_waitcnt lgkmcnt(13)
    v_mfma_f32_16x16x32_bf16 v[24:27], v[72:75], v[92:95], v[24:27]
    v_mfma_f32_16x16x32_bf16 v[28:31], v[72:75], v[96:99], v[28:31]
    v_mfma_f32_16x16x32_bf16 v[32:35], v[72:75], v[100:103], v[32:35]
    s_waitcnt lgkmcnt(11)
    v_mfma_f32_16x16x32_bf16 v[36:39], v[76:79], v[92:95], v[36:39]
    v_mfma_f32_16x16x32_bf16 v[40:43], v[76:79], v[96:99], v[40:43]
    v_mfma_f32_16x16x32_bf16 v[44:47], v[76:79], v[100:103], v[44:47]
    s_waitcnt lgkmcnt(6)
    v_mfma_f32_16x16x32_bf16 v[0:3], v[48:51], v[80:83], v[0:3]
    ds_read_b128 v[92:95], v109 offset:0
    ds_read_b128 v[96:99], v109 offset:2048
    v_mfma_f32_16x16x32_bf16 v[4:7], v[48:51], v[84:87], v[4:7]
    ds_read_b128 v[100:103], v109 offset:4096
    ds_read_b64_tr_b16 v[64:65], v104 offset:16384
    v_mfma_f32_16x16x32_bf16 v[8:11], v[48:51], v[88:91], v[8:11]
    ds_read_b64_tr_b16 v[66:67], v104 offset:18432
    ds_read_b64_tr_b16 v[68:69], v105 offset:16384
    s_waitcnt lgkmcnt(10)
    v_mfma_f32_16x16x32_bf16 v[12:15], v[52:55], v[80:83], v[12:15]
    ds_read_b64_tr_b16 v[70:71], v105 offset:18432
    ds_read_b64_tr_b16 v[72:73], v106 offset:16384
    v_mfma_f32_16x16x32_bf16 v[16:19], v[52:55], v[84:87], v[16:19]
    ds_read_b64_tr_b16 v[74:75], v106 offset:18432
    ds_read_b64_tr_b16 v[76:77], v107 offset:16384
    v_mfma_f32_16x16x32_bf16 v[20:23], v[52:55], v[88:91], v[20:23]
    ds_read_b64_tr_b16 v[78:79], v107 offset:18432
    s_waitcnt lgkmcnt(13)
    v_mfma_f32_16x16x32_bf16 v[24:27], v[56:59], v[80:83], v[24:27]
    v_add_u32 v104, 4294885376, v104
    v_mfma_f32_16x16x32_bf16 v[28:31], v[56:59], v[84:87], v[28:31]
    v_add_u32 v105, 4294885376, v105
    v_mfma_f32_16x16x32_bf16 v[32:35], v[56:59], v[88:91], v[32:35]
    v_add_u32 v106, 4294885376, v106
    s_waitcnt lgkmcnt(11)
    v_mfma_f32_16x16x32_bf16 v[36:39], v[60:63], v[80:83], v[36:39]
    v_add_u32 v107, 4294885376, v107
    v_mfma_f32_16x16x32_bf16 v[40:43], v[60:63], v[84:87], v[40:43]
    v_add_u32 v108, 4294885376, v108
    v_mfma_f32_16x16x32_bf16 v[44:47], v[60:63], v[88:91], v[44:47]
    v_add_u32 v109, 4294885376, v109
    s_waitcnt lgkmcnt(0)
    s_barrier
    s_waitcnt lgkmcnt(6)
    v_mfma_f32_16x16x32_bf16 v[0:3], v[64:67], v[92:95], v[0:3]
    ds_read_b128 v[80:83], v108 offset:0
    ds_read_b128 v[84:87], v108 offset:2048
    v_mfma_f32_16x16x32_bf16 v[4:7], v[64:67], v[96:99], v[4:7]
    ds_read_b128 v[88:91], v108 offset:4096
    ds_read_b64_tr_b16 v[48:49], v104 offset:0
    v_mfma_f32_16x16x32_bf16 v[8:11], v[64:67], v[100:103], v[8:11]
    ds_read_b64_tr_b16 v[50:51], v104 offset:2048
    ds_read_b64_tr_b16 v[52:53], v105 offset:0
    s_waitcnt lgkmcnt(10)
    v_mfma_f32_16x16x32_bf16 v[12:15], v[68:71], v[92:95], v[12:15]
    ds_read_b64_tr_b16 v[54:55], v105 offset:2048
    ds_read_b64_tr_b16 v[56:57], v106 offset:0
    v_mfma_f32_16x16x32_bf16 v[16:19], v[68:71], v[96:99], v[16:19]
    ds_read_b64_tr_b16 v[58:59], v106 offset:2048
    ds_read_b64_tr_b16 v[60:61], v107 offset:0
    v_mfma_f32_16x16x32_bf16 v[20:23], v[68:71], v[100:103], v[20:23]
    ds_read_b64_tr_b16 v[62:63], v107 offset:2048
    s_waitcnt lgkmcnt(13)
    v_mfma_f32_16x16x32_bf16 v[24:27], v[72:75], v[92:95], v[24:27]
    v_mfma_f32_16x16x32_bf16 v[28:31], v[72:75], v[96:99], v[28:31]
    v_mfma_f32_16x16x32_bf16 v[32:35], v[72:75], v[100:103], v[32:35]
    s_waitcnt lgkmcnt(11)
    v_mfma_f32_16x16x32_bf16 v[36:39], v[76:79], v[92:95], v[36:39]
    v_mfma_f32_16x16x32_bf16 v[40:43], v[76:79], v[96:99], v[40:43]
    v_mfma_f32_16x16x32_bf16 v[44:47], v[76:79], v[100:103], v[44:47]
    s_waitcnt lgkmcnt(6)
    v_mfma_f32_16x16x32_bf16 v[0:3], v[48:51], v[80:83], v[0:3]
    ds_read_b128 v[92:95], v109 offset:0
    ds_read_b128 v[96:99], v109 offset:2048
    v_mfma_f32_16x16x32_bf16 v[4:7], v[48:51], v[84:87], v[4:7]
    ds_read_b128 v[100:103], v109 offset:4096
    ds_read_b64_tr_b16 v[64:65], v104 offset:16384
    v_mfma_f32_16x16x32_bf16 v[8:11], v[48:51], v[88:91], v[8:11]
    ds_read_b64_tr_b16 v[66:67], v104 offset:18432
    ds_read_b64_tr_b16 v[68:69], v105 offset:16384
    s_waitcnt lgkmcnt(10)
    v_mfma_f32_16x16x32_bf16 v[12:15], v[52:55], v[80:83], v[12:15]
    ds_read_b64_tr_b16 v[70:71], v105 offset:18432
    ds_read_b64_tr_b16 v[72:73], v106 offset:16384
    v_mfma_f32_16x16x32_bf16 v[16:19], v[52:55], v[84:87], v[16:19]
    ds_read_b64_tr_b16 v[74:75], v106 offset:18432
    ds_read_b64_tr_b16 v[76:77], v107 offset:16384
    v_mfma_f32_16x16x32_bf16 v[20:23], v[52:55], v[88:91], v[20:23]
    ds_read_b64_tr_b16 v[78:79], v107 offset:18432
    s_waitcnt lgkmcnt(13)
    v_mfma_f32_16x16x32_bf16 v[24:27], v[56:59], v[80:83], v[24:27]
    v_add_u32 v104, 40960, v104
    v_mfma_f32_16x16x32_bf16 v[28:31], v[56:59], v[84:87], v[28:31]
    v_add_u32 v105, 40960, v105
    v_mfma_f32_16x16x32_bf16 v[32:35], v[56:59], v[88:91], v[32:35]
    v_add_u32 v106, 40960, v106
    s_waitcnt lgkmcnt(11)
    v_mfma_f32_16x16x32_bf16 v[36:39], v[60:63], v[80:83], v[36:39]
    v_add_u32 v107, 40960, v107
    v_mfma_f32_16x16x32_bf16 v[40:43], v[60:63], v[84:87], v[40:43]
    v_add_u32 v108, 40960, v108
    v_mfma_f32_16x16x32_bf16 v[44:47], v[60:63], v[88:91], v[44:47]
    v_add_u32 v109, 40960, v109
    s_waitcnt lgkmcnt(0)
    s_barrier
    s_waitcnt lgkmcnt(6)
    v_mfma_f32_16x16x32_bf16 v[0:3], v[64:67], v[92:95], v[0:3]
    ds_read_b128 v[80:83], v108 offset:0
    ds_read_b128 v[84:87], v108 offset:2048
    v_mfma_f32_16x16x32_bf16 v[4:7], v[64:67], v[96:99], v[4:7]
    ds_read_b128 v[88:91], v108 offset:4096
    ds_read_b64_tr_b16 v[48:49], v104 offset:0
    v_mfma_f32_16x16x32_bf16 v[8:11], v[64:67], v[100:103], v[8:11]
    ds_read_b64_tr_b16 v[50:51], v104 offset:2048
    ds_read_b64_tr_b16 v[52:53], v105 offset:0
    s_waitcnt lgkmcnt(10)
    v_mfma_f32_16x16x32_bf16 v[12:15], v[68:71], v[92:95], v[12:15]
    ds_read_b64_tr_b16 v[54:55], v105 offset:2048
    ds_read_b64_tr_b16 v[56:57], v106 offset:0
    v_mfma_f32_16x16x32_bf16 v[16:19], v[68:71], v[96:99], v[16:19]
    ds_read_b64_tr_b16 v[58:59], v106 offset:2048
    ds_read_b64_tr_b16 v[60:61], v107 offset:0
    v_mfma_f32_16x16x32_bf16 v[20:23], v[68:71], v[100:103], v[20:23]
    ds_read_b64_tr_b16 v[62:63], v107 offset:2048
    s_waitcnt lgkmcnt(13)
    v_mfma_f32_16x16x32_bf16 v[24:27], v[72:75], v[92:95], v[24:27]
    v_mfma_f32_16x16x32_bf16 v[28:31], v[72:75], v[96:99], v[28:31]
    v_mfma_f32_16x16x32_bf16 v[32:35], v[72:75], v[100:103], v[32:35]
    s_waitcnt lgkmcnt(11)
    v_mfma_f32_16x16x32_bf16 v[36:39], v[76:79], v[92:95], v[36:39]
    v_mfma_f32_16x16x32_bf16 v[40:43], v[76:79], v[96:99], v[40:43]
    v_mfma_f32_16x16x32_bf16 v[44:47], v[76:79], v[100:103], v[44:47]
    s_waitcnt lgkmcnt(6)
    v_mfma_f32_16x16x32_bf16 v[0:3], v[48:51], v[80:83], v[0:3]
    ds_read_b128 v[92:95], v109 offset:0
    ds_read_b128 v[96:99], v109 offset:2048
    v_mfma_f32_16x16x32_bf16 v[4:7], v[48:51], v[84:87], v[4:7]
    ds_read_b128 v[100:103], v109 offset:4096
    ds_read_b64_tr_b16 v[64:65], v104 offset:16384
    v_mfma_f32_16x16x32_bf16 v[8:11], v[48:51], v[88:91], v[8:11]
    ds_read_b64_tr_b16 v[66:67], v104 offset:18432
    ds_read_b64_tr_b16 v[68:69], v105 offset:16384
    s_waitcnt lgkmcnt(10)
    v_mfma_f32_16x16x32_bf16 v[12:15], v[52:55], v[80:83], v[12:15]
    ds_read_b64_tr_b16 v[70:71], v105 offset:18432
    ds_read_b64_tr_b16 v[72:73], v106 offset:16384
    v_mfma_f32_16x16x32_bf16 v[16:19], v[52:55], v[84:87], v[16:19]
    ds_read_b64_tr_b16 v[74:75], v106 offset:18432
    ds_read_b64_tr_b16 v[76:77], v107 offset:16384
    v_mfma_f32_16x16x32_bf16 v[20:23], v[52:55], v[88:91], v[20:23]
    ds_read_b64_tr_b16 v[78:79], v107 offset:18432
    s_waitcnt lgkmcnt(13)
    v_mfma_f32_16x16x32_bf16 v[24:27], v[56:59], v[80:83], v[24:27]
    v_add_u32 v104, 40960, v104
    v_mfma_f32_16x16x32_bf16 v[28:31], v[56:59], v[84:87], v[28:31]
    v_add_u32 v105, 40960, v105
    v_mfma_f32_16x16x32_bf16 v[32:35], v[56:59], v[88:91], v[32:35]
    v_add_u32 v106, 40960, v106
    s_waitcnt lgkmcnt(11)
    v_mfma_f32_16x16x32_bf16 v[36:39], v[60:63], v[80:83], v[36:39]
    v_add_u32 v107, 40960, v107
    v_mfma_f32_16x16x32_bf16 v[40:43], v[60:63], v[84:87], v[40:43]
    v_add_u32 v108, 40960, v108
    v_mfma_f32_16x16x32_bf16 v[44:47], v[60:63], v[88:91], v[44:47]
    v_add_u32 v109, 40960, v109
    s_waitcnt lgkmcnt(0)
    s_barrier
    s_waitcnt lgkmcnt(6)
    v_mfma_f32_16x16x32_bf16 v[0:3], v[64:67], v[92:95], v[0:3]
    ds_read_b128 v[80:83], v108 offset:0
    ds_read_b128 v[84:87], v108 offset:2048
    v_mfma_f32_16x16x32_bf16 v[4:7], v[64:67], v[96:99], v[4:7]
    ds_read_b128 v[88:91], v108 offset:4096
    ds_read_b64_tr_b16 v[48:49], v104 offset:0
    v_mfma_f32_16x16x32_bf16 v[8:11], v[64:67], v[100:103], v[8:11]
    ds_read_b64_tr_b16 v[50:51], v104 offset:2048
    ds_read_b64_tr_b16 v[52:53], v105 offset:0
    s_waitcnt lgkmcnt(10)
    v_mfma_f32_16x16x32_bf16 v[12:15], v[68:71], v[92:95], v[12:15]
    ds_read_b64_tr_b16 v[54:55], v105 offset:2048
    ds_read_b64_tr_b16 v[56:57], v106 offset:0
    v_mfma_f32_16x16x32_bf16 v[16:19], v[68:71], v[96:99], v[16:19]
    ds_read_b64_tr_b16 v[58:59], v106 offset:2048
    ds_read_b64_tr_b16 v[60:61], v107 offset:0
    v_mfma_f32_16x16x32_bf16 v[20:23], v[68:71], v[100:103], v[20:23]
    ds_read_b64_tr_b16 v[62:63], v107 offset:2048
    s_waitcnt lgkmcnt(13)
    v_mfma_f32_16x16x32_bf16 v[24:27], v[72:75], v[92:95], v[24:27]
    v_mfma_f32_16x16x32_bf16 v[28:31], v[72:75], v[96:99], v[28:31]
    v_mfma_f32_16x16x32_bf16 v[32:35], v[72:75], v[100:103], v[32:35]
    s_waitcnt lgkmcnt(11)
    v_mfma_f32_16x16x32_bf16 v[36:39], v[76:79], v[92:95], v[36:39]
    v_mfma_f32_16x16x32_bf16 v[40:43], v[76:79], v[96:99], v[40:43]
    v_mfma_f32_16x16x32_bf16 v[44:47], v[76:79], v[100:103], v[44:47]
    s_waitcnt lgkmcnt(6)
    v_mfma_f32_16x16x32_bf16 v[0:3], v[48:51], v[80:83], v[0:3]
    ds_read_b128 v[92:95], v109 offset:0
    ds_read_b128 v[96:99], v109 offset:2048
    v_mfma_f32_16x16x32_bf16 v[4:7], v[48:51], v[84:87], v[4:7]
    ds_read_b128 v[100:103], v109 offset:4096
    ds_read_b64_tr_b16 v[64:65], v104 offset:16384
    v_mfma_f32_16x16x32_bf16 v[8:11], v[48:51], v[88:91], v[8:11]
    ds_read_b64_tr_b16 v[66:67], v104 offset:18432
    ds_read_b64_tr_b16 v[68:69], v105 offset:16384
    s_waitcnt lgkmcnt(10)
    v_mfma_f32_16x16x32_bf16 v[12:15], v[52:55], v[80:83], v[12:15]
    ds_read_b64_tr_b16 v[70:71], v105 offset:18432
    ds_read_b64_tr_b16 v[72:73], v106 offset:16384
    v_mfma_f32_16x16x32_bf16 v[16:19], v[52:55], v[84:87], v[16:19]
    ds_read_b64_tr_b16 v[74:75], v106 offset:18432
    ds_read_b64_tr_b16 v[76:77], v107 offset:16384
    v_mfma_f32_16x16x32_bf16 v[20:23], v[52:55], v[88:91], v[20:23]
    ds_read_b64_tr_b16 v[78:79], v107 offset:18432
    s_waitcnt lgkmcnt(13)
    v_mfma_f32_16x16x32_bf16 v[24:27], v[56:59], v[80:83], v[24:27]
    v_add_u32 v104, 4294885376, v104
    v_mfma_f32_16x16x32_bf16 v[28:31], v[56:59], v[84:87], v[28:31]
    v_add_u32 v105, 4294885376, v105
    v_mfma_f32_16x16x32_bf16 v[32:35], v[56:59], v[88:91], v[32:35]
    v_add_u32 v106, 4294885376, v106
    s_waitcnt lgkmcnt(11)
    v_mfma_f32_16x16x32_bf16 v[36:39], v[60:63], v[80:83], v[36:39]
    v_add_u32 v107, 4294885376, v107
    v_mfma_f32_16x16x32_bf16 v[40:43], v[60:63], v[84:87], v[40:43]
    v_add_u32 v108, 4294885376, v108
    v_mfma_f32_16x16x32_bf16 v[44:47], v[60:63], v[88:91], v[44:47]
    v_add_u32 v109, 4294885376, v109
    s_waitcnt lgkmcnt(0)
    s_barrier
    s_waitcnt lgkmcnt(6)
    v_mfma_f32_16x16x32_bf16 v[0:3], v[64:67], v[92:95], v[0:3]
    ds_read_b128 v[80:83], v108 offset:0
    ds_read_b128 v[84:87], v108 offset:2048
    v_mfma_f32_16x16x32_bf16 v[4:7], v[64:67], v[96:99], v[4:7]
    ds_read_b128 v[88:91], v108 offset:4096
    ds_read_b64_tr_b16 v[48:49], v104 offset:0
    v_mfma_f32_16x16x32_bf16 v[8:11], v[64:67], v[100:103], v[8:11]
    ds_read_b64_tr_b16 v[50:51], v104 offset:2048
    ds_read_b64_tr_b16 v[52:53], v105 offset:0
    s_waitcnt lgkmcnt(10)
    v_mfma_f32_16x16x32_bf16 v[12:15], v[68:71], v[92:95], v[12:15]
    ds_read_b64_tr_b16 v[54:55], v105 offset:2048
    ds_read_b64_tr_b16 v[56:57], v106 offset:0
    v_mfma_f32_16x16x32_bf16 v[16:19], v[68:71], v[96:99], v[16:19]
    ds_read_b64_tr_b16 v[58:59], v106 offset:2048
    ds_read_b64_tr_b16 v[60:61], v107 offset:0
    v_mfma_f32_16x16x32_bf16 v[20:23], v[68:71], v[100:103], v[20:23]
    ds_read_b64_tr_b16 v[62:63], v107 offset:2048
    s_waitcnt lgkmcnt(13)
    v_mfma_f32_16x16x32_bf16 v[24:27], v[72:75], v[92:95], v[24:27]
    v_mfma_f32_16x16x32_bf16 v[28:31], v[72:75], v[96:99], v[28:31]
    v_mfma_f32_16x16x32_bf16 v[32:35], v[72:75], v[100:103], v[32:35]
    s_waitcnt lgkmcnt(11)
    v_mfma_f32_16x16x32_bf16 v[36:39], v[76:79], v[92:95], v[36:39]
    v_mfma_f32_16x16x32_bf16 v[40:43], v[76:79], v[96:99], v[40:43]
    v_mfma_f32_16x16x32_bf16 v[44:47], v[76:79], v[100:103], v[44:47]
    s_waitcnt lgkmcnt(6)
    v_mfma_f32_16x16x32_bf16 v[0:3], v[48:51], v[80:83], v[0:3]
    ds_read_b128 v[92:95], v109 offset:0
    ds_read_b128 v[96:99], v109 offset:2048
    v_mfma_f32_16x16x32_bf16 v[4:7], v[48:51], v[84:87], v[4:7]
    ds_read_b128 v[100:103], v109 offset:4096
    ds_read_b64_tr_b16 v[64:65], v104 offset:16384
    v_mfma_f32_16x16x32_bf16 v[8:11], v[48:51], v[88:91], v[8:11]
    ds_read_b64_tr_b16 v[66:67], v104 offset:18432
    ds_read_b64_tr_b16 v[68:69], v105 offset:16384
    s_waitcnt lgkmcnt(10)
    v_mfma_f32_16x16x32_bf16 v[12:15], v[52:55], v[80:83], v[12:15]
    ds_read_b64_tr_b16 v[70:71], v105 offset:18432
    ds_read_b64_tr_b16 v[72:73], v106 offset:16384
    v_mfma_f32_16x16x32_bf16 v[16:19], v[52:55], v[84:87], v[16:19]
    ds_read_b64_tr_b16 v[74:75], v106 offset:18432
    ds_read_b64_tr_b16 v[76:77], v107 offset:16384
    v_mfma_f32_16x16x32_bf16 v[20:23], v[52:55], v[88:91], v[20:23]
    ds_read_b64_tr_b16 v[78:79], v107 offset:18432
    s_waitcnt lgkmcnt(13)
    v_mfma_f32_16x16x32_bf16 v[24:27], v[56:59], v[80:83], v[24:27]
    v_add_u32 v104, 40960, v104
    v_mfma_f32_16x16x32_bf16 v[28:31], v[56:59], v[84:87], v[28:31]
    v_add_u32 v105, 40960, v105
    v_mfma_f32_16x16x32_bf16 v[32:35], v[56:59], v[88:91], v[32:35]
    v_add_u32 v106, 40960, v106
    s_waitcnt lgkmcnt(11)
    v_mfma_f32_16x16x32_bf16 v[36:39], v[60:63], v[80:83], v[36:39]
    v_add_u32 v107, 40960, v107
    v_mfma_f32_16x16x32_bf16 v[40:43], v[60:63], v[84:87], v[40:43]
    v_add_u32 v108, 40960, v108
    v_mfma_f32_16x16x32_bf16 v[44:47], v[60:63], v[88:91], v[44:47]
    v_add_u32 v109, 40960, v109
    s_waitcnt lgkmcnt(0)
    s_barrier
    s_waitcnt lgkmcnt(6)
    v_mfma_f32_16x16x32_bf16 v[0:3], v[64:67], v[92:95], v[0:3]
    ds_read_b128 v[80:83], v108 offset:0
    ds_read_b128 v[84:87], v108 offset:2048
    v_mfma_f32_16x16x32_bf16 v[4:7], v[64:67], v[96:99], v[4:7]
    ds_read_b128 v[88:91], v108 offset:4096
    ds_read_b64_tr_b16 v[48:49], v104 offset:0
    v_mfma_f32_16x16x32_bf16 v[8:11], v[64:67], v[100:103], v[8:11]
    ds_read_b64_tr_b16 v[50:51], v104 offset:2048
    ds_read_b64_tr_b16 v[52:53], v105 offset:0
    s_waitcnt lgkmcnt(10)
    v_mfma_f32_16x16x32_bf16 v[12:15], v[68:71], v[92:95], v[12:15]
    ds_read_b64_tr_b16 v[54:55], v105 offset:2048
    ds_read_b64_tr_b16 v[56:57], v106 offset:0
    v_mfma_f32_16x16x32_bf16 v[16:19], v[68:71], v[96:99], v[16:19]
    ds_read_b64_tr_b16 v[58:59], v106 offset:2048
    ds_read_b64_tr_b16 v[60:61], v107 offset:0
    v_mfma_f32_16x16x32_bf16 v[20:23], v[68:71], v[100:103], v[20:23]
    ds_read_b64_tr_b16 v[62:63], v107 offset:2048
    s_waitcnt lgkmcnt(13)
    v_mfma_f32_16x16x32_bf16 v[24:27], v[72:75], v[92:95], v[24:27]
    v_mfma_f32_16x16x32_bf16 v[28:31], v[72:75], v[96:99], v[28:31]
    v_mfma_f32_16x16x32_bf16 v[32:35], v[72:75], v[100:103], v[32:35]
    s_waitcnt lgkmcnt(11)
    v_mfma_f32_16x16x32_bf16 v[36:39], v[76:79], v[92:95], v[36:39]
    v_mfma_f32_16x16x32_bf16 v[40:43], v[76:79], v[96:99], v[40:43]
    v_mfma_f32_16x16x32_bf16 v[44:47], v[76:79], v[100:103], v[44:47]
    s_waitcnt lgkmcnt(6)
    v_mfma_f32_16x16x32_bf16 v[0:3], v[48:51], v[80:83], v[0:3]
    ds_read_b128 v[92:95], v109 offset:0
    ds_read_b128 v[96:99], v109 offset:2048
    v_mfma_f32_16x16x32_bf16 v[4:7], v[48:51], v[84:87], v[4:7]
    ds_read_b128 v[100:103], v109 offset:4096
    ds_read_b64_tr_b16 v[64:65], v104 offset:16384
    v_mfma_f32_16x16x32_bf16 v[8:11], v[48:51], v[88:91], v[8:11]
    ds_read_b64_tr_b16 v[66:67], v104 offset:18432
    ds_read_b64_tr_b16 v[68:69], v105 offset:16384
    s_waitcnt lgkmcnt(10)
    v_mfma_f32_16x16x32_bf16 v[12:15], v[52:55], v[80:83], v[12:15]
    ds_read_b64_tr_b16 v[70:71], v105 offset:18432
    ds_read_b64_tr_b16 v[72:73], v106 offset:16384
    v_mfma_f32_16x16x32_bf16 v[16:19], v[52:55], v[84:87], v[16:19]
    ds_read_b64_tr_b16 v[74:75], v106 offset:18432
    ds_read_b64_tr_b16 v[76:77], v107 offset:16384
    v_mfma_f32_16x16x32_bf16 v[20:23], v[52:55], v[88:91], v[20:23]
    ds_read_b64_tr_b16 v[78:79], v107 offset:18432
    s_waitcnt lgkmcnt(13)
    v_mfma_f32_16x16x32_bf16 v[24:27], v[56:59], v[80:83], v[24:27]
    v_add_u32 v104, 40960, v104
    v_mfma_f32_16x16x32_bf16 v[28:31], v[56:59], v[84:87], v[28:31]
    v_add_u32 v105, 40960, v105
    v_mfma_f32_16x16x32_bf16 v[32:35], v[56:59], v[88:91], v[32:35]
    v_add_u32 v106, 40960, v106
    s_waitcnt lgkmcnt(11)
    v_mfma_f32_16x16x32_bf16 v[36:39], v[60:63], v[80:83], v[36:39]
    v_add_u32 v107, 40960, v107
    v_mfma_f32_16x16x32_bf16 v[40:43], v[60:63], v[84:87], v[40:43]
    v_add_u32 v108, 40960, v108
    v_mfma_f32_16x16x32_bf16 v[44:47], v[60:63], v[88:91], v[44:47]
    v_add_u32 v109, 40960, v109
    s_waitcnt lgkmcnt(0)
    s_barrier
    s_waitcnt lgkmcnt(6)
    v_mfma_f32_16x16x32_bf16 v[0:3], v[64:67], v[92:95], v[0:3]
    ds_read_b128 v[80:83], v108 offset:0
    ds_read_b128 v[84:87], v108 offset:2048
    v_mfma_f32_16x16x32_bf16 v[4:7], v[64:67], v[96:99], v[4:7]
    ds_read_b128 v[88:91], v108 offset:4096
    ds_read_b64_tr_b16 v[48:49], v104 offset:0
    v_mfma_f32_16x16x32_bf16 v[8:11], v[64:67], v[100:103], v[8:11]
    ds_read_b64_tr_b16 v[50:51], v104 offset:2048
    ds_read_b64_tr_b16 v[52:53], v105 offset:0
    s_waitcnt lgkmcnt(10)
    v_mfma_f32_16x16x32_bf16 v[12:15], v[68:71], v[92:95], v[12:15]
    ds_read_b64_tr_b16 v[54:55], v105 offset:2048
    ds_read_b64_tr_b16 v[56:57], v106 offset:0
    v_mfma_f32_16x16x32_bf16 v[16:19], v[68:71], v[96:99], v[16:19]
    ds_read_b64_tr_b16 v[58:59], v106 offset:2048
    ds_read_b64_tr_b16 v[60:61], v107 offset:0
    v_mfma_f32_16x16x32_bf16 v[20:23], v[68:71], v[100:103], v[20:23]
    ds_read_b64_tr_b16 v[62:63], v107 offset:2048
    s_waitcnt lgkmcnt(13)
    v_mfma_f32_16x16x32_bf16 v[24:27], v[72:75], v[92:95], v[24:27]
    v_mfma_f32_16x16x32_bf16 v[28:31], v[72:75], v[96:99], v[28:31]
    v_mfma_f32_16x16x32_bf16 v[32:35], v[72:75], v[100:103], v[32:35]
    s_waitcnt lgkmcnt(11)
    v_mfma_f32_16x16x32_bf16 v[36:39], v[76:79], v[92:95], v[36:39]
    v_mfma_f32_16x16x32_bf16 v[40:43], v[76:79], v[96:99], v[40:43]
    v_mfma_f32_16x16x32_bf16 v[44:47], v[76:79], v[100:103], v[44:47]
    s_waitcnt lgkmcnt(6)
    v_mfma_f32_16x16x32_bf16 v[0:3], v[48:51], v[80:83], v[0:3]
    ds_read_b128 v[92:95], v109 offset:0
    ds_read_b128 v[96:99], v109 offset:2048
    v_mfma_f32_16x16x32_bf16 v[4:7], v[48:51], v[84:87], v[4:7]
    ds_read_b128 v[100:103], v109 offset:4096
    ds_read_b64_tr_b16 v[64:65], v104 offset:16384
    v_mfma_f32_16x16x32_bf16 v[8:11], v[48:51], v[88:91], v[8:11]
    ds_read_b64_tr_b16 v[66:67], v104 offset:18432
    ds_read_b64_tr_b16 v[68:69], v105 offset:16384
    s_waitcnt lgkmcnt(10)
    v_mfma_f32_16x16x32_bf16 v[12:15], v[52:55], v[80:83], v[12:15]
    ds_read_b64_tr_b16 v[70:71], v105 offset:18432
    ds_read_b64_tr_b16 v[72:73], v106 offset:16384
    v_mfma_f32_16x16x32_bf16 v[16:19], v[52:55], v[84:87], v[16:19]
    ds_read_b64_tr_b16 v[74:75], v106 offset:18432
    ds_read_b64_tr_b16 v[76:77], v107 offset:16384
    v_mfma_f32_16x16x32_bf16 v[20:23], v[52:55], v[88:91], v[20:23]
    ds_read_b64_tr_b16 v[78:79], v107 offset:18432
    s_waitcnt lgkmcnt(13)
    v_mfma_f32_16x16x32_bf16 v[24:27], v[56:59], v[80:83], v[24:27]
    v_add_u32 v104, 4294885376, v104
    v_mfma_f32_16x16x32_bf16 v[28:31], v[56:59], v[84:87], v[28:31]
    v_add_u32 v105, 4294885376, v105
    v_mfma_f32_16x16x32_bf16 v[32:35], v[56:59], v[88:91], v[32:35]
    v_add_u32 v106, 4294885376, v106
    s_waitcnt lgkmcnt(11)
    v_mfma_f32_16x16x32_bf16 v[36:39], v[60:63], v[80:83], v[36:39]
    v_add_u32 v107, 4294885376, v107
    v_mfma_f32_16x16x32_bf16 v[40:43], v[60:63], v[84:87], v[40:43]
    v_add_u32 v108, 4294885376, v108
    v_mfma_f32_16x16x32_bf16 v[44:47], v[60:63], v[88:91], v[44:47]
    v_add_u32 v109, 4294885376, v109
    s_waitcnt lgkmcnt(0)
    s_barrier
    s_waitcnt lgkmcnt(6)
    v_mfma_f32_16x16x32_bf16 v[0:3], v[64:67], v[92:95], v[0:3]
    ds_read_b128 v[80:83], v108 offset:0
    ds_read_b128 v[84:87], v108 offset:2048
    v_mfma_f32_16x16x32_bf16 v[4:7], v[64:67], v[96:99], v[4:7]
    ds_read_b128 v[88:91], v108 offset:4096
    ds_read_b64_tr_b16 v[48:49], v104 offset:0
    v_mfma_f32_16x16x32_bf16 v[8:11], v[64:67], v[100:103], v[8:11]
    ds_read_b64_tr_b16 v[50:51], v104 offset:2048
    ds_read_b64_tr_b16 v[52:53], v105 offset:0
    s_waitcnt lgkmcnt(10)
    v_mfma_f32_16x16x32_bf16 v[12:15], v[68:71], v[92:95], v[12:15]
    ds_read_b64_tr_b16 v[54:55], v105 offset:2048
    ds_read_b64_tr_b16 v[56:57], v106 offset:0
    v_mfma_f32_16x16x32_bf16 v[16:19], v[68:71], v[96:99], v[16:19]
    ds_read_b64_tr_b16 v[58:59], v106 offset:2048
    ds_read_b64_tr_b16 v[60:61], v107 offset:0
    v_mfma_f32_16x16x32_bf16 v[20:23], v[68:71], v[100:103], v[20:23]
    ds_read_b64_tr_b16 v[62:63], v107 offset:2048
    s_waitcnt lgkmcnt(13)
    v_mfma_f32_16x16x32_bf16 v[24:27], v[72:75], v[92:95], v[24:27]
    v_mfma_f32_16x16x32_bf16 v[28:31], v[72:75], v[96:99], v[28:31]
    v_mfma_f32_16x16x32_bf16 v[32:35], v[72:75], v[100:103], v[32:35]
    s_waitcnt lgkmcnt(11)
    v_mfma_f32_16x16x32_bf16 v[36:39], v[76:79], v[92:95], v[36:39]
    v_mfma_f32_16x16x32_bf16 v[40:43], v[76:79], v[96:99], v[40:43]
    v_mfma_f32_16x16x32_bf16 v[44:47], v[76:79], v[100:103], v[44:47]
    s_waitcnt lgkmcnt(6)
    v_mfma_f32_16x16x32_bf16 v[0:3], v[48:51], v[80:83], v[0:3]
    ds_read_b128 v[92:95], v109 offset:0
    ds_read_b128 v[96:99], v109 offset:2048
    v_mfma_f32_16x16x32_bf16 v[4:7], v[48:51], v[84:87], v[4:7]
    ds_read_b128 v[100:103], v109 offset:4096
    ds_read_b64_tr_b16 v[64:65], v104 offset:16384
    v_mfma_f32_16x16x32_bf16 v[8:11], v[48:51], v[88:91], v[8:11]
    ds_read_b64_tr_b16 v[66:67], v104 offset:18432
    ds_read_b64_tr_b16 v[68:69], v105 offset:16384
    s_waitcnt lgkmcnt(10)
    v_mfma_f32_16x16x32_bf16 v[12:15], v[52:55], v[80:83], v[12:15]
    ds_read_b64_tr_b16 v[70:71], v105 offset:18432
    ds_read_b64_tr_b16 v[72:73], v106 offset:16384
    v_mfma_f32_16x16x32_bf16 v[16:19], v[52:55], v[84:87], v[16:19]
    ds_read_b64_tr_b16 v[74:75], v106 offset:18432
    ds_read_b64_tr_b16 v[76:77], v107 offset:16384
    v_mfma_f32_16x16x32_bf16 v[20:23], v[52:55], v[88:91], v[20:23]
    ds_read_b64_tr_b16 v[78:79], v107 offset:18432
    s_waitcnt lgkmcnt(13)
    v_mfma_f32_16x16x32_bf16 v[24:27], v[56:59], v[80:83], v[24:27]
    v_add_u32 v104, 40960, v104
    v_mfma_f32_16x16x32_bf16 v[28:31], v[56:59], v[84:87], v[28:31]
    v_add_u32 v105, 40960, v105
    v_mfma_f32_16x16x32_bf16 v[32:35], v[56:59], v[88:91], v[32:35]
    v_add_u32 v106, 40960, v106
    s_waitcnt lgkmcnt(11)
    v_mfma_f32_16x16x32_bf16 v[36:39], v[60:63], v[80:83], v[36:39]
    v_add_u32 v107, 40960, v107
    v_mfma_f32_16x16x32_bf16 v[40:43], v[60:63], v[84:87], v[40:43]
    v_add_u32 v108, 40960, v108
    v_mfma_f32_16x16x32_bf16 v[44:47], v[60:63], v[88:91], v[44:47]
    v_add_u32 v109, 40960, v109
    s_waitcnt lgkmcnt(0)
    s_barrier
    s_waitcnt lgkmcnt(6)
    v_mfma_f32_16x16x32_bf16 v[0:3], v[64:67], v[92:95], v[0:3]
    ds_read_b128 v[80:83], v108 offset:0
    ds_read_b128 v[84:87], v108 offset:2048
    v_mfma_f32_16x16x32_bf16 v[4:7], v[64:67], v[96:99], v[4:7]
    ds_read_b128 v[88:91], v108 offset:4096
    ds_read_b64_tr_b16 v[48:49], v104 offset:0
    v_mfma_f32_16x16x32_bf16 v[8:11], v[64:67], v[100:103], v[8:11]
    ds_read_b64_tr_b16 v[50:51], v104 offset:2048
    ds_read_b64_tr_b16 v[52:53], v105 offset:0
    s_waitcnt lgkmcnt(10)
    v_mfma_f32_16x16x32_bf16 v[12:15], v[68:71], v[92:95], v[12:15]
    ds_read_b64_tr_b16 v[54:55], v105 offset:2048
    ds_read_b64_tr_b16 v[56:57], v106 offset:0
    v_mfma_f32_16x16x32_bf16 v[16:19], v[68:71], v[96:99], v[16:19]
    ds_read_b64_tr_b16 v[58:59], v106 offset:2048
    ds_read_b64_tr_b16 v[60:61], v107 offset:0
    v_mfma_f32_16x16x32_bf16 v[20:23], v[68:71], v[100:103], v[20:23]
    ds_read_b64_tr_b16 v[62:63], v107 offset:2048
    s_waitcnt lgkmcnt(13)
    v_mfma_f32_16x16x32_bf16 v[24:27], v[72:75], v[92:95], v[24:27]
    v_mfma_f32_16x16x32_bf16 v[28:31], v[72:75], v[96:99], v[28:31]
    v_mfma_f32_16x16x32_bf16 v[32:35], v[72:75], v[100:103], v[32:35]
    s_waitcnt lgkmcnt(11)
    v_mfma_f32_16x16x32_bf16 v[36:39], v[76:79], v[92:95], v[36:39]
    v_mfma_f32_16x16x32_bf16 v[40:43], v[76:79], v[96:99], v[40:43]
    v_mfma_f32_16x16x32_bf16 v[44:47], v[76:79], v[100:103], v[44:47]
    s_waitcnt lgkmcnt(6)
    v_mfma_f32_16x16x32_bf16 v[0:3], v[48:51], v[80:83], v[0:3]
    ds_read_b128 v[92:95], v109 offset:0
    ds_read_b128 v[96:99], v109 offset:2048
    v_mfma_f32_16x16x32_bf16 v[4:7], v[48:51], v[84:87], v[4:7]
    ds_read_b128 v[100:103], v109 offset:4096
    ds_read_b64_tr_b16 v[64:65], v104 offset:16384
    v_mfma_f32_16x16x32_bf16 v[8:11], v[48:51], v[88:91], v[8:11]
    ds_read_b64_tr_b16 v[66:67], v104 offset:18432
    ds_read_b64_tr_b16 v[68:69], v105 offset:16384
    s_waitcnt lgkmcnt(10)
    v_mfma_f32_16x16x32_bf16 v[12:15], v[52:55], v[80:83], v[12:15]
    ds_read_b64_tr_b16 v[70:71], v105 offset:18432
    ds_read_b64_tr_b16 v[72:73], v106 offset:16384
    v_mfma_f32_16x16x32_bf16 v[16:19], v[52:55], v[84:87], v[16:19]
    ds_read_b64_tr_b16 v[74:75], v106 offset:18432
    ds_read_b64_tr_b16 v[76:77], v107 offset:16384
    v_mfma_f32_16x16x32_bf16 v[20:23], v[52:55], v[88:91], v[20:23]
    ds_read_b64_tr_b16 v[78:79], v107 offset:18432
    s_waitcnt lgkmcnt(13)
    v_mfma_f32_16x16x32_bf16 v[24:27], v[56:59], v[80:83], v[24:27]
    v_add_u32 v104, 40960, v104
    v_mfma_f32_16x16x32_bf16 v[28:31], v[56:59], v[84:87], v[28:31]
    v_add_u32 v105, 40960, v105
    v_mfma_f32_16x16x32_bf16 v[32:35], v[56:59], v[88:91], v[32:35]
    v_add_u32 v106, 40960, v106
    s_waitcnt lgkmcnt(11)
    v_mfma_f32_16x16x32_bf16 v[36:39], v[60:63], v[80:83], v[36:39]
    v_add_u32 v107, 40960, v107
    v_mfma_f32_16x16x32_bf16 v[40:43], v[60:63], v[84:87], v[40:43]
    v_add_u32 v108, 40960, v108
    v_mfma_f32_16x16x32_bf16 v[44:47], v[60:63], v[88:91], v[44:47]
    v_add_u32 v109, 40960, v109
    s_waitcnt lgkmcnt(0)
    s_barrier
    s_waitcnt lgkmcnt(6)
    v_mfma_f32_16x16x32_bf16 v[0:3], v[64:67], v[92:95], v[0:3]
    ds_read_b128 v[80:83], v108 offset:0
    ds_read_b128 v[84:87], v108 offset:2048
    v_mfma_f32_16x16x32_bf16 v[4:7], v[64:67], v[96:99], v[4:7]
    ds_read_b128 v[88:91], v108 offset:4096
    ds_read_b64_tr_b16 v[48:49], v104 offset:0
    v_mfma_f32_16x16x32_bf16 v[8:11], v[64:67], v[100:103], v[8:11]
    ds_read_b64_tr_b16 v[50:51], v104 offset:2048
    ds_read_b64_tr_b16 v[52:53], v105 offset:0
    s_waitcnt lgkmcnt(10)
    v_mfma_f32_16x16x32_bf16 v[12:15], v[68:71], v[92:95], v[12:15]
    ds_read_b64_tr_b16 v[54:55], v105 offset:2048
    ds_read_b64_tr_b16 v[56:57], v106 offset:0
    v_mfma_f32_16x16x32_bf16 v[16:19], v[68:71], v[96:99], v[16:19]
    ds_read_b64_tr_b16 v[58:59], v106 offset:2048
    ds_read_b64_tr_b16 v[60:61], v107 offset:0
    v_mfma_f32_16x16x32_bf16 v[20:23], v[68:71], v[100:103], v[20:23]
    ds_read_b64_tr_b16 v[62:63], v107 offset:2048
    s_waitcnt lgkmcnt(13)
    v_mfma_f32_16x16x32_bf16 v[24:27], v[72:75], v[92:95], v[24:27]
    v_mfma_f32_16x16x32_bf16 v[28:31], v[72:75], v[96:99], v[28:31]
    v_mfma_f32_16x16x32_bf16 v[32:35], v[72:75], v[100:103], v[32:35]
    s_waitcnt lgkmcnt(11)
    v_mfma_f32_16x16x32_bf16 v[36:39], v[76:79], v[92:95], v[36:39]
    v_mfma_f32_16x16x32_bf16 v[40:43], v[76:79], v[96:99], v[40:43]
    v_mfma_f32_16x16x32_bf16 v[44:47], v[76:79], v[100:103], v[44:47]
    s_waitcnt lgkmcnt(6)
    v_mfma_f32_16x16x32_bf16 v[0:3], v[48:51], v[80:83], v[0:3]
    ds_read_b128 v[92:95], v109 offset:0
    ds_read_b128 v[96:99], v109 offset:2048
    v_mfma_f32_16x16x32_bf16 v[4:7], v[48:51], v[84:87], v[4:7]
    ds_read_b128 v[100:103], v109 offset:4096
    ds_read_b64_tr_b16 v[64:65], v104 offset:16384
    v_mfma_f32_16x16x32_bf16 v[8:11], v[48:51], v[88:91], v[8:11]
    ds_read_b64_tr_b16 v[66:67], v104 offset:18432
    ds_read_b64_tr_b16 v[68:69], v105 offset:16384
    s_waitcnt lgkmcnt(10)
    v_mfma_f32_16x16x32_bf16 v[12:15], v[52:55], v[80:83], v[12:15]
    ds_read_b64_tr_b16 v[70:71], v105 offset:18432
    ds_read_b64_tr_b16 v[72:73], v106 offset:16384
    v_mfma_f32_16x16x32_bf16 v[16:19], v[52:55], v[84:87], v[16:19]
    ds_read_b64_tr_b16 v[74:75], v106 offset:18432
    ds_read_b64_tr_b16 v[76:77], v107 offset:16384
    v_mfma_f32_16x16x32_bf16 v[20:23], v[52:55], v[88:91], v[20:23]
    ds_read_b64_tr_b16 v[78:79], v107 offset:18432
    s_waitcnt lgkmcnt(13)
    v_mfma_f32_16x16x32_bf16 v[24:27], v[56:59], v[80:83], v[24:27]
    v_add_u32 v104, 4294885376, v104
    v_mfma_f32_16x16x32_bf16 v[28:31], v[56:59], v[84:87], v[28:31]
    v_add_u32 v105, 4294885376, v105
    v_mfma_f32_16x16x32_bf16 v[32:35], v[56:59], v[88:91], v[32:35]
    v_add_u32 v106, 4294885376, v106
    s_waitcnt lgkmcnt(11)
    v_mfma_f32_16x16x32_bf16 v[36:39], v[60:63], v[80:83], v[36:39]
    v_add_u32 v107, 4294885376, v107
    v_mfma_f32_16x16x32_bf16 v[40:43], v[60:63], v[84:87], v[40:43]
    v_add_u32 v108, 4294885376, v108
    v_mfma_f32_16x16x32_bf16 v[44:47], v[60:63], v[88:91], v[44:47]
    v_add_u32 v109, 4294885376, v109
    s_waitcnt lgkmcnt(0)
    s_barrier
    s_waitcnt lgkmcnt(6)
    v_mfma_f32_16x16x32_bf16 v[0:3], v[64:67], v[92:95], v[0:3]
    ds_read_b128 v[80:83], v108 offset:0
    ds_read_b128 v[84:87], v108 offset:2048
    v_mfma_f32_16x16x32_bf16 v[4:7], v[64:67], v[96:99], v[4:7]
    ds_read_b128 v[88:91], v108 offset:4096
    ds_read_b64_tr_b16 v[48:49], v104 offset:0
    v_mfma_f32_16x16x32_bf16 v[8:11], v[64:67], v[100:103], v[8:11]
    ds_read_b64_tr_b16 v[50:51], v104 offset:2048
    ds_read_b64_tr_b16 v[52:53], v105 offset:0
    s_waitcnt lgkmcnt(10)
    v_mfma_f32_16x16x32_bf16 v[12:15], v[68:71], v[92:95], v[12:15]
    ds_read_b64_tr_b16 v[54:55], v105 offset:2048
    ds_read_b64_tr_b16 v[56:57], v106 offset:0
    v_mfma_f32_16x16x32_bf16 v[16:19], v[68:71], v[96:99], v[16:19]
    ds_read_b64_tr_b16 v[58:59], v106 offset:2048
    ds_read_b64_tr_b16 v[60:61], v107 offset:0
    v_mfma_f32_16x16x32_bf16 v[20:23], v[68:71], v[100:103], v[20:23]
    ds_read_b64_tr_b16 v[62:63], v107 offset:2048
    s_waitcnt lgkmcnt(13)
    v_mfma_f32_16x16x32_bf16 v[24:27], v[72:75], v[92:95], v[24:27]
    v_mfma_f32_16x16x32_bf16 v[28:31], v[72:75], v[96:99], v[28:31]
    v_mfma_f32_16x16x32_bf16 v[32:35], v[72:75], v[100:103], v[32:35]
    s_waitcnt lgkmcnt(11)
    v_mfma_f32_16x16x32_bf16 v[36:39], v[76:79], v[92:95], v[36:39]
    v_mfma_f32_16x16x32_bf16 v[40:43], v[76:79], v[96:99], v[40:43]
    v_mfma_f32_16x16x32_bf16 v[44:47], v[76:79], v[100:103], v[44:47]
    s_waitcnt lgkmcnt(6)
    v_mfma_f32_16x16x32_bf16 v[0:3], v[48:51], v[80:83], v[0:3]
    ds_read_b128 v[92:95], v109 offset:0
    ds_read_b128 v[96:99], v109 offset:2048
    v_mfma_f32_16x16x32_bf16 v[4:7], v[48:51], v[84:87], v[4:7]
    ds_read_b128 v[100:103], v109 offset:4096
    ds_read_b64_tr_b16 v[64:65], v104 offset:16384
    v_mfma_f32_16x16x32_bf16 v[8:11], v[48:51], v[88:91], v[8:11]
    ds_read_b64_tr_b16 v[66:67], v104 offset:18432
    ds_read_b64_tr_b16 v[68:69], v105 offset:16384
    s_waitcnt lgkmcnt(10)
    v_mfma_f32_16x16x32_bf16 v[12:15], v[52:55], v[80:83], v[12:15]
    ds_read_b64_tr_b16 v[70:71], v105 offset:18432
    ds_read_b64_tr_b16 v[72:73], v106 offset:16384
    v_mfma_f32_16x16x32_bf16 v[16:19], v[52:55], v[84:87], v[16:19]
    ds_read_b64_tr_b16 v[74:75], v106 offset:18432
    ds_read_b64_tr_b16 v[76:77], v107 offset:16384
    v_mfma_f32_16x16x32_bf16 v[20:23], v[52:55], v[88:91], v[20:23]
    ds_read_b64_tr_b16 v[78:79], v107 offset:18432
    s_waitcnt lgkmcnt(13)
    v_mfma_f32_16x16x32_bf16 v[24:27], v[56:59], v[80:83], v[24:27]
    v_add_u32 v104, 40960, v104
    v_mfma_f32_16x16x32_bf16 v[28:31], v[56:59], v[84:87], v[28:31]
    v_add_u32 v105, 40960, v105
    v_mfma_f32_16x16x32_bf16 v[32:35], v[56:59], v[88:91], v[32:35]
    v_add_u32 v106, 40960, v106
    s_waitcnt lgkmcnt(11)
    v_mfma_f32_16x16x32_bf16 v[36:39], v[60:63], v[80:83], v[36:39]
    v_add_u32 v107, 40960, v107
    v_mfma_f32_16x16x32_bf16 v[40:43], v[60:63], v[84:87], v[40:43]
    v_add_u32 v108, 40960, v108
    v_mfma_f32_16x16x32_bf16 v[44:47], v[60:63], v[88:91], v[44:47]
    v_add_u32 v109, 40960, v109
    s_waitcnt lgkmcnt(0)
    s_barrier
    s_waitcnt lgkmcnt(6)
    v_mfma_f32_16x16x32_bf16 v[0:3], v[64:67], v[92:95], v[0:3]
    ds_read_b128 v[80:83], v108 offset:0
    ds_read_b128 v[84:87], v108 offset:2048
    v_mfma_f32_16x16x32_bf16 v[4:7], v[64:67], v[96:99], v[4:7]
    ds_read_b128 v[88:91], v108 offset:4096
    ds_read_b64_tr_b16 v[48:49], v104 offset:0
    v_mfma_f32_16x16x32_bf16 v[8:11], v[64:67], v[100:103], v[8:11]
    ds_read_b64_tr_b16 v[50:51], v104 offset:2048
    ds_read_b64_tr_b16 v[52:53], v105 offset:0
    s_waitcnt lgkmcnt(10)
    v_mfma_f32_16x16x32_bf16 v[12:15], v[68:71], v[92:95], v[12:15]
    ds_read_b64_tr_b16 v[54:55], v105 offset:2048
    ds_read_b64_tr_b16 v[56:57], v106 offset:0
    v_mfma_f32_16x16x32_bf16 v[16:19], v[68:71], v[96:99], v[16:19]
    ds_read_b64_tr_b16 v[58:59], v106 offset:2048
    ds_read_b64_tr_b16 v[60:61], v107 offset:0
    v_mfma_f32_16x16x32_bf16 v[20:23], v[68:71], v[100:103], v[20:23]
    ds_read_b64_tr_b16 v[62:63], v107 offset:2048
    s_waitcnt lgkmcnt(13)
    v_mfma_f32_16x16x32_bf16 v[24:27], v[72:75], v[92:95], v[24:27]
    v_mfma_f32_16x16x32_bf16 v[28:31], v[72:75], v[96:99], v[28:31]
    v_mfma_f32_16x16x32_bf16 v[32:35], v[72:75], v[100:103], v[32:35]
    s_waitcnt lgkmcnt(11)
    v_mfma_f32_16x16x32_bf16 v[36:39], v[76:79], v[92:95], v[36:39]
    v_mfma_f32_16x16x32_bf16 v[40:43], v[76:79], v[96:99], v[40:43]
    v_mfma_f32_16x16x32_bf16 v[44:47], v[76:79], v[100:103], v[44:47]
    s_waitcnt lgkmcnt(6)
    v_mfma_f32_16x16x32_bf16 v[0:3], v[48:51], v[80:83], v[0:3]
    ds_read_b128 v[92:95], v109 offset:0
    ds_read_b128 v[96:99], v109 offset:2048
    v_mfma_f32_16x16x32_bf16 v[4:7], v[48:51], v[84:87], v[4:7]
    ds_read_b128 v[100:103], v109 offset:4096
    ds_read_b64_tr_b16 v[64:65], v104 offset:16384
    v_mfma_f32_16x16x32_bf16 v[8:11], v[48:51], v[88:91], v[8:11]
    ds_read_b64_tr_b16 v[66:67], v104 offset:18432
    ds_read_b64_tr_b16 v[68:69], v105 offset:16384
    s_waitcnt lgkmcnt(10)
    v_mfma_f32_16x16x32_bf16 v[12:15], v[52:55], v[80:83], v[12:15]
    ds_read_b64_tr_b16 v[70:71], v105 offset:18432
    ds_read_b64_tr_b16 v[72:73], v106 offset:16384
    v_mfma_f32_16x16x32_bf16 v[16:19], v[52:55], v[84:87], v[16:19]
    ds_read_b64_tr_b16 v[74:75], v106 offset:18432
    ds_read_b64_tr_b16 v[76:77], v107 offset:16384
    v_mfma_f32_16x16x32_bf16 v[20:23], v[52:55], v[88:91], v[20:23]
    ds_read_b64_tr_b16 v[78:79], v107 offset:18432
    s_waitcnt lgkmcnt(13)
    v_mfma_f32_16x16x32_bf16 v[24:27], v[56:59], v[80:83], v[24:27]
    v_add_u32 v104, 40960, v104
    v_mfma_f32_16x16x32_bf16 v[28:31], v[56:59], v[84:87], v[28:31]
    v_add_u32 v105, 40960, v105
    v_mfma_f32_16x16x32_bf16 v[32:35], v[56:59], v[88:91], v[32:35]
    v_add_u32 v106, 40960, v106
    s_waitcnt lgkmcnt(11)
    v_mfma_f32_16x16x32_bf16 v[36:39], v[60:63], v[80:83], v[36:39]
    v_add_u32 v107, 40960, v107
    v_mfma_f32_16x16x32_bf16 v[40:43], v[60:63], v[84:87], v[40:43]
    v_add_u32 v108, 40960, v108
    v_mfma_f32_16x16x32_bf16 v[44:47], v[60:63], v[88:91], v[44:47]
    v_add_u32 v109, 40960, v109
    s_waitcnt lgkmcnt(0)
    s_barrier
    s_waitcnt lgkmcnt(6)
    v_mfma_f32_16x16x32_bf16 v[0:3], v[64:67], v[92:95], v[0:3]
    ds_read_b128 v[80:83], v108 offset:0
    ds_read_b128 v[84:87], v108 offset:2048
    v_mfma_f32_16x16x32_bf16 v[4:7], v[64:67], v[96:99], v[4:7]
    ds_read_b128 v[88:91], v108 offset:4096
    ds_read_b64_tr_b16 v[48:49], v104 offset:0
    v_mfma_f32_16x16x32_bf16 v[8:11], v[64:67], v[100:103], v[8:11]
    ds_read_b64_tr_b16 v[50:51], v104 offset:2048
    ds_read_b64_tr_b16 v[52:53], v105 offset:0
    s_waitcnt lgkmcnt(10)
    v_mfma_f32_16x16x32_bf16 v[12:15], v[68:71], v[92:95], v[12:15]
    ds_read_b64_tr_b16 v[54:55], v105 offset:2048
    ds_read_b64_tr_b16 v[56:57], v106 offset:0
    v_mfma_f32_16x16x32_bf16 v[16:19], v[68:71], v[96:99], v[16:19]
    ds_read_b64_tr_b16 v[58:59], v106 offset:2048
    ds_read_b64_tr_b16 v[60:61], v107 offset:0
    v_mfma_f32_16x16x32_bf16 v[20:23], v[68:71], v[100:103], v[20:23]
    ds_read_b64_tr_b16 v[62:63], v107 offset:2048
    s_waitcnt lgkmcnt(13)
    v_mfma_f32_16x16x32_bf16 v[24:27], v[72:75], v[92:95], v[24:27]
    v_mfma_f32_16x16x32_bf16 v[28:31], v[72:75], v[96:99], v[28:31]
    v_mfma_f32_16x16x32_bf16 v[32:35], v[72:75], v[100:103], v[32:35]
    s_waitcnt lgkmcnt(11)
    v_mfma_f32_16x16x32_bf16 v[36:39], v[76:79], v[92:95], v[36:39]
    v_mfma_f32_16x16x32_bf16 v[40:43], v[76:79], v[96:99], v[40:43]
    v_mfma_f32_16x16x32_bf16 v[44:47], v[76:79], v[100:103], v[44:47]
    s_waitcnt lgkmcnt(6)
    v_mfma_f32_16x16x32_bf16 v[0:3], v[48:51], v[80:83], v[0:3]
    ds_read_b128 v[92:95], v109 offset:0
    ds_read_b128 v[96:99], v109 offset:2048
    v_mfma_f32_16x16x32_bf16 v[4:7], v[48:51], v[84:87], v[4:7]
    ds_read_b128 v[100:103], v109 offset:4096
    ds_read_b64_tr_b16 v[64:65], v104 offset:16384
    v_mfma_f32_16x16x32_bf16 v[8:11], v[48:51], v[88:91], v[8:11]
    ds_read_b64_tr_b16 v[66:67], v104 offset:18432
    ds_read_b64_tr_b16 v[68:69], v105 offset:16384
    s_waitcnt lgkmcnt(10)
    v_mfma_f32_16x16x32_bf16 v[12:15], v[52:55], v[80:83], v[12:15]
    ds_read_b64_tr_b16 v[70:71], v105 offset:18432
    ds_read_b64_tr_b16 v[72:73], v106 offset:16384
    v_mfma_f32_16x16x32_bf16 v[16:19], v[52:55], v[84:87], v[16:19]
    ds_read_b64_tr_b16 v[74:75], v106 offset:18432
    ds_read_b64_tr_b16 v[76:77], v107 offset:16384
    v_mfma_f32_16x16x32_bf16 v[20:23], v[52:55], v[88:91], v[20:23]
    ds_read_b64_tr_b16 v[78:79], v107 offset:18432
    s_waitcnt lgkmcnt(13)
    v_mfma_f32_16x16x32_bf16 v[24:27], v[56:59], v[80:83], v[24:27]
    v_add_u32 v104, 4294885376, v104
    v_mfma_f32_16x16x32_bf16 v[28:31], v[56:59], v[84:87], v[28:31]
    v_add_u32 v105, 4294885376, v105
    v_mfma_f32_16x16x32_bf16 v[32:35], v[56:59], v[88:91], v[32:35]
    v_add_u32 v106, 4294885376, v106
    s_waitcnt lgkmcnt(11)
    v_mfma_f32_16x16x32_bf16 v[36:39], v[60:63], v[80:83], v[36:39]
    v_add_u32 v107, 4294885376, v107
    v_mfma_f32_16x16x32_bf16 v[40:43], v[60:63], v[84:87], v[40:43]
    v_add_u32 v108, 4294885376, v108
    v_mfma_f32_16x16x32_bf16 v[44:47], v[60:63], v[88:91], v[44:47]
    v_add_u32 v109, 4294885376, v109
    s_waitcnt lgkmcnt(0)
    s_barrier
    s_waitcnt lgkmcnt(6)
    v_mfma_f32_16x16x32_bf16 v[0:3], v[64:67], v[92:95], v[0:3]
    ds_read_b128 v[80:83], v108 offset:0
    ds_read_b128 v[84:87], v108 offset:2048
    v_mfma_f32_16x16x32_bf16 v[4:7], v[64:67], v[96:99], v[4:7]
    ds_read_b128 v[88:91], v108 offset:4096
    ds_read_b64_tr_b16 v[48:49], v104 offset:0
    v_mfma_f32_16x16x32_bf16 v[8:11], v[64:67], v[100:103], v[8:11]
    ds_read_b64_tr_b16 v[50:51], v104 offset:2048
    ds_read_b64_tr_b16 v[52:53], v105 offset:0
    s_waitcnt lgkmcnt(10)
    v_mfma_f32_16x16x32_bf16 v[12:15], v[68:71], v[92:95], v[12:15]
    ds_read_b64_tr_b16 v[54:55], v105 offset:2048
    ds_read_b64_tr_b16 v[56:57], v106 offset:0
    v_mfma_f32_16x16x32_bf16 v[16:19], v[68:71], v[96:99], v[16:19]
    ds_read_b64_tr_b16 v[58:59], v106 offset:2048
    ds_read_b64_tr_b16 v[60:61], v107 offset:0
    v_mfma_f32_16x16x32_bf16 v[20:23], v[68:71], v[100:103], v[20:23]
    ds_read_b64_tr_b16 v[62:63], v107 offset:2048
    s_waitcnt lgkmcnt(13)
    v_mfma_f32_16x16x32_bf16 v[24:27], v[72:75], v[92:95], v[24:27]
    v_mfma_f32_16x16x32_bf16 v[28:31], v[72:75], v[96:99], v[28:31]
    v_mfma_f32_16x16x32_bf16 v[32:35], v[72:75], v[100:103], v[32:35]
    s_waitcnt lgkmcnt(11)
    v_mfma_f32_16x16x32_bf16 v[36:39], v[76:79], v[92:95], v[36:39]
    v_mfma_f32_16x16x32_bf16 v[40:43], v[76:79], v[96:99], v[40:43]
    v_mfma_f32_16x16x32_bf16 v[44:47], v[76:79], v[100:103], v[44:47]
    s_waitcnt lgkmcnt(6)
    v_mfma_f32_16x16x32_bf16 v[0:3], v[48:51], v[80:83], v[0:3]
    ds_read_b128 v[92:95], v109 offset:0
    ds_read_b128 v[96:99], v109 offset:2048
    v_mfma_f32_16x16x32_bf16 v[4:7], v[48:51], v[84:87], v[4:7]
    ds_read_b128 v[100:103], v109 offset:4096
    ds_read_b64_tr_b16 v[64:65], v104 offset:16384
    v_mfma_f32_16x16x32_bf16 v[8:11], v[48:51], v[88:91], v[8:11]
    ds_read_b64_tr_b16 v[66:67], v104 offset:18432
    ds_read_b64_tr_b16 v[68:69], v105 offset:16384
    s_waitcnt lgkmcnt(10)
    v_mfma_f32_16x16x32_bf16 v[12:15], v[52:55], v[80:83], v[12:15]
    ds_read_b64_tr_b16 v[70:71], v105 offset:18432
    ds_read_b64_tr_b16 v[72:73], v106 offset:16384
    v_mfma_f32_16x16x32_bf16 v[16:19], v[52:55], v[84:87], v[16:19]
    ds_read_b64_tr_b16 v[74:75], v106 offset:18432
    ds_read_b64_tr_b16 v[76:77], v107 offset:16384
    v_mfma_f32_16x16x32_bf16 v[20:23], v[52:55], v[88:91], v[20:23]
    ds_read_b64_tr_b16 v[78:79], v107 offset:18432
    s_waitcnt lgkmcnt(13)
    v_mfma_f32_16x16x32_bf16 v[24:27], v[56:59], v[80:83], v[24:27]
    v_add_u32 v104, 40960, v104
    v_mfma_f32_16x16x32_bf16 v[28:31], v[56:59], v[84:87], v[28:31]
    v_add_u32 v105, 40960, v105
    v_mfma_f32_16x16x32_bf16 v[32:35], v[56:59], v[88:91], v[32:35]
    v_add_u32 v106, 40960, v106
    s_waitcnt lgkmcnt(11)
    v_mfma_f32_16x16x32_bf16 v[36:39], v[60:63], v[80:83], v[36:39]
    v_add_u32 v107, 40960, v107
    v_mfma_f32_16x16x32_bf16 v[40:43], v[60:63], v[84:87], v[40:43]
    v_add_u32 v108, 40960, v108
    v_mfma_f32_16x16x32_bf16 v[44:47], v[60:63], v[88:91], v[44:47]
    v_add_u32 v109, 40960, v109
    s_waitcnt lgkmcnt(0)
    s_barrier
    v_mfma_f32_16x16x32_bf16 v[0:3], v[64:67], v[92:95], v[0:3]
    v_mfma_f32_16x16x32_bf16 v[4:7], v[64:67], v[96:99], v[4:7]
    v_mfma_f32_16x16x32_bf16 v[8:11], v[64:67], v[100:103], v[8:11]
    v_mfma_f32_16x16x32_bf16 v[12:15], v[68:71], v[92:95], v[12:15]
    v_mfma_f32_16x16x32_bf16 v[16:19], v[68:71], v[96:99], v[16:19]
    v_mfma_f32_16x16x32_bf16 v[20:23], v[68:71], v[100:103], v[20:23]
    v_mfma_f32_16x16x32_bf16 v[24:27], v[72:75], v[92:95], v[24:27]
    v_mfma_f32_16x16x32_bf16 v[28:31], v[72:75], v[96:99], v[28:31]
    v_mfma_f32_16x16x32_bf16 v[32:35], v[72:75], v[100:103], v[32:35]
    v_mfma_f32_16x16x32_bf16 v[36:39], v[76:79], v[92:95], v[36:39]
    v_mfma_f32_16x16x32_bf16 v[40:43], v[76:79], v[96:99], v[40:43]
    v_mfma_f32_16x16x32_bf16 v[44:47], v[76:79], v[100:103], v[44:47]
    s_mov_b32 s35, 1040356334
    v_lshrrev_b32 v110, 4, v163
    v_and_b32 v111, 15, v163
    v_lshlrev_b32 v112, 8, v111
    v_and_b32 v113, 1, v110
    v_lshlrev_b32 v113, 3, v113
    v_add_u32 v112, v112, v113
    v_lshrrev_b32 v113, 1, v110
    s_and_b32 s41, s33, 1
    s_lshl_b32 s41, s41, 3
    v_add_u32 v113, s41, v113
    s_lshr_b32 s42, s33, 1
    s_cmp_eq_u32 s42, 0
    s_mov_b32 s76, 102400
    s_mov_b32 s77, 139264
    s_mov_b32 s78, 143360
    s_cselect_b32 s76, 57344, s76
    s_cselect_b32 s77, 61440, s77
    s_cselect_b32 s78, 98304, s78
    v_add_u32 v114, 0, v113
    v_xor_b32 v114, v114, v111
    v_lshlrev_b32 v114, 4, v114
    v_add_u32 v114, v114, v112
    v_mul_f32 v0, s35, v0
    v_mul_f32 v1, s35, v1
    v_mul_f32 v2, s35, v2
    v_mul_f32 v3, s35, v3
    v_cvt_pk_bf16_f32 v116, v0, v1
    v_cvt_pk_bf16_f32 v117, v2, v3
    v_add_u32 v123, s76, v114
    ds_write_b64 v123, v[116:117]
    v_mul_f32 v4, s35, v4
    v_mul_f32 v5, s35, v5
    v_mul_f32 v6, s35, v6
    v_mul_f32 v7, s35, v7
    v_cvt_pk_bf16_f32 v118, v4, v5
    v_cvt_pk_bf16_f32 v119, v6, v7
    v_add_u32 v124, s77, v114
    ds_write_b64 v124, v[118:119]
    v_mul_f32 v8, s35, v8
    v_mul_f32 v9, s35, v9
    v_mul_f32 v10, s35, v10
    v_mul_f32 v11, s35, v11
    v_cvt_pk_bf16_f32 v116, v8, v9
    v_cvt_pk_bf16_f32 v117, v10, v11
    v_add_u32 v125, s78, v114
    ds_write_b64 v125, v[116:117]
    v_add_u32 v114, 2, v113
    v_xor_b32 v114, v114, v111
    v_lshlrev_b32 v114, 4, v114
    v_add_u32 v114, v114, v112
    v_mul_f32 v12, s35, v12
    v_mul_f32 v13, s35, v13
    v_mul_f32 v14, s35, v14
    v_mul_f32 v15, s35, v15
    v_cvt_pk_bf16_f32 v116, v12, v13
    v_cvt_pk_bf16_f32 v117, v14, v15
    v_add_u32 v123, s76, v114
    ds_write_b64 v123, v[116:117]
    v_mul_f32 v16, s35, v16
    v_mul_f32 v17, s35, v17
    v_mul_f32 v18, s35, v18
    v_mul_f32 v19, s35, v19
    v_cvt_pk_bf16_f32 v118, v16, v17
    v_cvt_pk_bf16_f32 v119, v18, v19
    v_add_u32 v124, s77, v114
    ds_write_b64 v124, v[118:119]
    v_mul_f32 v20, s35, v20
    v_mul_f32 v21, s35, v21
    v_mul_f32 v22, s35, v22
    v_mul_f32 v23, s35, v23
    v_cvt_pk_bf16_f32 v116, v20, v21
    v_cvt_pk_bf16_f32 v117, v22, v23
    v_add_u32 v125, s78, v114
    ds_write_b64 v125, v[116:117]
    v_add_u32 v114, 4, v113
    v_xor_b32 v114, v114, v111
    v_lshlrev_b32 v114, 4, v114
    v_add_u32 v114, v114, v112
    v_mul_f32 v24, s35, v24
    v_mul_f32 v25, s35, v25
    v_mul_f32 v26, s35, v26
    v_mul_f32 v27, s35, v27
    v_cvt_pk_bf16_f32 v116, v24, v25
    v_cvt_pk_bf16_f32 v117, v26, v27
    v_add_u32 v123, s76, v114
    ds_write_b64 v123, v[116:117]
    v_mul_f32 v28, s35, v28
    v_mul_f32 v29, s35, v29
    v_mul_f32 v30, s35, v30
    v_mul_f32 v31, s35, v31
    v_cvt_pk_bf16_f32 v118, v28, v29
    v_cvt_pk_bf16_f32 v119, v30, v31
    v_add_u32 v124, s77, v114
    ds_write_b64 v124, v[118:119]
    v_mul_f32 v32, s35, v32
    v_mul_f32 v33, s35, v33
    v_mul_f32 v34, s35, v34
    v_mul_f32 v35, s35, v35
    v_cvt_pk_bf16_f32 v116, v32, v33
    v_cvt_pk_bf16_f32 v117, v34, v35
    v_add_u32 v125, s78, v114
    ds_write_b64 v125, v[116:117]
    v_add_u32 v114, 6, v113
    v_xor_b32 v114, v114, v111
    v_lshlrev_b32 v114, 4, v114
    v_add_u32 v114, v114, v112
    v_mul_f32 v36, s35, v36
    v_mul_f32 v37, s35, v37
    v_mul_f32 v38, s35, v38
    v_mul_f32 v39, s35, v39
    v_cvt_pk_bf16_f32 v116, v36, v37
    v_cvt_pk_bf16_f32 v117, v38, v39
    v_add_u32 v123, s76, v114
    ds_write_b64 v123, v[116:117]
    v_mul_f32 v40, s35, v40
    v_mul_f32 v41, s35, v41
    v_mul_f32 v42, s35, v42
    v_mul_f32 v43, s35, v43
    v_cvt_pk_bf16_f32 v118, v40, v41
    v_cvt_pk_bf16_f32 v119, v42, v43
    v_add_u32 v124, s77, v114
    ds_write_b64 v124, v[118:119]
    v_mul_f32 v44, s35, v44
    v_mul_f32 v45, s35, v45
    v_mul_f32 v46, s35, v46
    v_mul_f32 v47, s35, v47
    v_cvt_pk_bf16_f32 v116, v44, v45
    v_cvt_pk_bf16_f32 v117, v46, v47
    v_add_u32 v125, s78, v114
    ds_write_b64 v125, v[116:117]
    v_mov_b32 v112, v128
    v_mov_b32 v113, v129
    v_mov_b32 v114, v130
    v_mov_b32 v115, v131
    v_mov_b32 v116, v132
    v_mov_b32 v117, v133
    v_mov_b32 v118, v134
    v_mov_b32 v119, v135
    s_waitcnt lgkmcnt(0)
L_p1_join:
    s_barrier
    ds_read_b128 v[64:67], v112
    ds_read_b128 v[68:71], v113
    ds_read_b128 v[72:75], v114
    ds_read_b128 v[76:79], v115
    ds_read_b128 v[80:83], v116
    ds_read_b128 v[84:87], v117
    ds_read_b128 v[88:91], v118
    ds_read_b128 v[92:95], v119
    s_waitcnt lgkmcnt(0)
    s_cmp_eq_u32 s34, 1
    s_cbranch_scc1 L_typeA
    s_cmp_eq_u32 s34, 2
    s_cbranch_scc1 L_typeC
    s_waitcnt vmcnt(0)
    s_barrier
    s_setprio 2
    ds_read_b128 v[112:115], v144 offset:0
    ds_read_b128 v[116:119], v145 offset:0
    ds_read_b128 v[120:123], v146 offset:0
    ds_read_b128 v[124:127], v147 offset:0
    ds_read_b128 v[128:131], v148 offset:0
    ds_read_b128 v[132:135], v149 offset:0
    ds_read_b128 v[136:139], v150 offset:0
    ds_read_b128 v[140:143], v151 offset:0
    s_bfe_u32 s76, s7, 262148
    s_lshl_b32 s76, s76, 13
    s_add_u32 s76, s76, s47
    s_mul_i32 s77, s33, 40960
    s_add_u32 m0, s77, 8192
    s_nop 0
    buffer_load_dwordx4 v164, s[16:19], s76 offen offset:0 lds
    buffer_load_dwordx4 v165, s[16:19], s76 offen offset:1024 lds
    buffer_load_dwordx4 v166, s[16:19], s76 offen offset:2048 lds
    buffer_load_dwordx4 v167, s[16:19], s76 offen offset:3072 lds
    s_add_u32 m0, s77, 12288
    s_add_u32 s76, s76, 4096
    buffer_load_dwordx4 v164, s[16:19], s76 offen offset:0 lds
    buffer_load_dwordx4 v165, s[16:19], s76 offen offset:1024 lds
    buffer_load_dwordx4 v166, s[16:19], s76 offen offset:2048 lds
    buffer_load_dwordx4 v167, s[16:19], s76 offen offset:3072 lds
    s_setprio 1
    s_bfe_u32 s76, s7, 262152
    s_lshl_b32 s76, s76, 13
    s_add_u32 s76, s76, s47
    s_mul_i32 s77, s33, 40960
    s_add_u32 m0, s77, 16384
    s_waitcnt lgkmcnt(7)
    v_mfma_f32_32x32x16_bf16 v[96:111], v[112:115], v[64:67], 0
    buffer_load_dwordx4 v164, s[16:19], s76 offen offset:0 lds
    s_waitcnt lgkmcnt(6)
    v_mfma_f32_32x32x16_bf16 v[96:111], v[116:119], v[68:71], v[96:111]
    ds_read_b64_tr_b16 v[112:113], v152 offset:0
    ds_read_b64_tr_b16 v[114:115], v152 offset:2048
    buffer_load_dwordx4 v165, s[16:19], s76 offen offset:1024 lds
    s_waitcnt lgkmcnt(7)
    v_mfma_f32_32x32x16_bf16 v[96:111], v[120:123], v[72:75], v[96:111]
    ds_read_b64_tr_b16 v[116:117], v153 offset:0
    ds_read_b64_tr_b16 v[118:119], v153 offset:2048
    buffer_load_dwordx4 v166, s[16:19], s76 offen offset:2048 lds
    s_waitcnt lgkmcnt(8)
    v_mfma_f32_32x32x16_bf16 v[96:111], v[124:127], v[76:79], v[96:111]
    ds_read_b64_tr_b16 v[120:121], v154 offset:0
    ds_read_b64_tr_b16 v[122:123], v154 offset:2048
    buffer_load_dwordx4 v167, s[16:19], s76 offen offset:3072 lds
    s_waitcnt lgkmcnt(9)
    v_mfma_f32_32x32x16_bf16 v[96:111], v[128:131], v[80:83], v[96:111]
    ds_read_b64_tr_b16 v[124:125], v155 offset:0
    ds_read_b64_tr_b16 v[126:127], v155 offset:2048
    s_add_u32 m0, s77, 20480
    s_add_u32 s76, s76, 4096
    buffer_load_dwordx4 v164, s[16:19], s76 offen offset:0 lds
    s_waitcnt lgkmcnt(10)
    v_mfma_f32_32x32x16_bf16 v[96:111], v[132:135], v[84:87], v[96:111]
    ds_read_b64_tr_b16 v[128:129], v152 offset:4096
    ds_read_b64_tr_b16 v[130:131], v152 offset:6144
    buffer_load_dwordx4 v165, s[16:19], s76 offen offset:1024 lds
    s_waitcnt lgkmcnt(11)
    v_mfma_f32_32x32x16_bf16 v[96:111], v[136:139], v[88:91], v[96:111]
    ds_read_b64_tr_b16 v[132:133], v153 offset:4096
    ds_read_b64_tr_b16 v[134:135], v153 offset:6144
    buffer_load_dwordx4 v166, s[16:19], s76 offen offset:2048 lds
    s_waitcnt lgkmcnt(12)
    v_mfma_f32_32x32x16_bf16 v[96:111], v[140:143], v[92:95], v[96:111]
    ds_read_b64_tr_b16 v[136:137], v154 offset:4096
    ds_read_b64_tr_b16 v[138:139], v154 offset:6144
    buffer_load_dwordx4 v167, s[16:19], s76 offen offset:3072 lds
    ds_read_b64_tr_b16 v[140:141], v155 offset:4096
    ds_read_b64_tr_b16 v[142:143], v155 offset:6144
    s_setprio 3
    s_nop 5
    v_max3_f32 v160, v96, v97, v98
    v_max3_f32 v161, v99, v100, v101
    v_max3_f32 v160, v160, v102, v103
    v_max3_f32 v161, v161, v104, v105
    v_max3_f32 v160, v160, v106, v107
    v_max3_f32 v161, v161, v108, v109
    v_max3_f32 v160, v160, v110, v111
    v_max_f32 v160, v160, v161
    v_cmp_gt_f32 vcc, v160, v159
    v_cmp_gt_f32 s[52:53], s36, v160
    s_nop 0
    s_or_b64 vcc, vcc, s[52:53]
    s_or_b64 s[52:53], vcc, s[50:51]
    s_cbranch_scc0 L_D0
    s_call_b64 s[38:39], L_slow_first
L_D0:
    v_exp_f32 v96, v96
    v_exp_f32 v97, v97
    v_exp_f32 v98, v98
    v_exp_f32 v99, v99
    v_exp_f32 v100, v100
    v_exp_f32 v101, v101
    v_exp_f32 v102, v102
    v_exp_f32 v103, v103
    v_add_f32 v157, v157, v96
    v_add_f32 v157, v157, v97
    v_add_f32 v157, v157, v98
    v_add_f32 v157, v157, v99
    v_add_f32 v157, v157, v100
    v_add_f32 v157, v157, v101
    v_add_f32 v157, v157, v102
    v_add_f32 v157, v157, v103
    v_cvt_pk_bf16_f32 v96, v96, v97
    v_cvt_pk_bf16_f32 v97, v98, v99
    v_cvt_pk_bf16_f32 v98, v100, v101
    v_cvt_pk_bf16_f32 v99, v102, v103
    v_exp_f32 v104, v104
    v_exp_f32 v105, v105
    v_exp_f32 v106, v106
    v_exp_f32 v107, v107
    v_exp_f32 v108, v108
    v_exp_f32 v109, v109
    v_exp_f32 v110, v110
    v_exp_f32 v111, v111
    v_add_f32 v157, v157, v104
    v_add_f32 v157, v157, v105
    v_add_f32 v157, v157, v106
    v_add_f32 v157, v157, v107
    v_add_f32 v157, v157, v108
    v_add_f32 v157, v157, v109
    v_add_f32 v157, v157, v110
    v_add_f32 v157, v157, v111
    v_cvt_pk_bf16_f32 v100, v104, v105
    v_cvt_pk_bf16_f32 v101, v106, v107
    v_cvt_pk_bf16_f32 v102, v108, v109
    v_cvt_pk_bf16_f32 v103, v110, v111
    s_waitcnt lgkmcnt(0)
    s_waitcnt vmcnt(8)
    s_barrier
    s_setprio 2
    v_mfma_f32_32x32x16_bf16 v[0:15], v[112:115], v[96:99], v[0:15]
    v_mfma_f32_32x32x16_bf16 v[16:31], v[116:119], v[96:99], v[16:31]
    ds_read_b128 v[112:115], v144 offset:8192
    v_mfma_f32_32x32x16_bf16 v[32:47], v[120:123], v[96:99], v[32:47]
    ds_read_b128 v[116:119], v145 offset:8192
    v_mfma_f32_32x32x16_bf16 v[48:63], v[124:127], v[96:99], v[48:63]
    ds_read_b128 v[120:123], v146 offset:8192
    v_mfma_f32_32x32x16_bf16 v[0:15], v[128:131], v[100:103], v[0:15]
    ds_read_b128 v[124:127], v147 offset:8192
    v_mfma_f32_32x32x16_bf16 v[16:31], v[132:135], v[100:103], v[16:31]
    ds_read_b128 v[128:131], v148 offset:8192
    v_mfma_f32_32x32x16_bf16 v[32:47], v[136:139], v[100:103], v[32:47]
    ds_read_b128 v[132:135], v149 offset:8192
    v_mfma_f32_32x32x16_bf16 v[48:63], v[140:143], v[100:103], v[48:63]
    ds_read_b128 v[136:139], v150 offset:8192
    ds_read_b128 v[140:143], v151 offset:8192
    s_setprio 1
    s_bfe_u32 s76, s7, 262156
    s_lshl_b32 s76, s76, 13
    s_add_u32 s76, s76, s47
    s_mul_i32 s77, s33, 40960
    s_add_u32 m0, s77, 0
    s_waitcnt lgkmcnt(7)
    v_mfma_f32_32x32x16_bf16 v[96:111], v[112:115], v[64:67], 0
    buffer_load_dwordx4 v164, s[16:19], s76 offen offset:0 lds
    s_waitcnt lgkmcnt(6)
    v_mfma_f32_32x32x16_bf16 v[96:111], v[116:119], v[68:71], v[96:111]
    ds_read_b64_tr_b16 v[112:113], v152 offset:8192
    ds_read_b64_tr_b16 v[114:115], v152 offset:10240
    buffer_load_dwordx4 v165, s[16:19], s76 offen offset:1024 lds
    s_waitcnt lgkmcnt(7)
    v_mfma_f32_32x32x16_bf16 v[96:111], v[120:123], v[72:75], v[96:111]
    ds_read_b64_tr_b16 v[116:117], v153 offset:8192
    ds_read_b64_tr_b16 v[118:119], v153 offset:10240
    buffer_load_dwordx4 v166, s[16:19], s76 offen offset:2048 lds
    s_waitcnt lgkmcnt(8)
    v_mfma_f32_32x32x16_bf16 v[96:111], v[124:127], v[76:79], v[96:111]
    ds_read_b64_tr_b16 v[120:121], v154 offset:8192
    ds_read_b64_tr_b16 v[122:123], v154 offset:10240
    buffer_load_dwordx4 v167, s[16:19], s76 offen offset:3072 lds
    s_waitcnt lgkmcnt(9)
    v_mfma_f32_32x32x16_bf16 v[96:111], v[128:131], v[80:83], v[96:111]
    ds_read_b64_tr_b16 v[124:125], v155 offset:8192
    ds_read_b64_tr_b16 v[126:127], v155 offset:10240
    s_add_u32 m0, s77, 4096
    s_add_u32 s76, s76, 4096
    buffer_load_dwordx4 v164, s[16:19], s76 offen offset:0 lds
    s_waitcnt lgkmcnt(10)
    v_mfma_f32_32x32x16_bf16 v[96:111], v[132:135], v[84:87], v[96:111]
    ds_read_b64_tr_b16 v[128:129], v152 offset:12288
    ds_read_b64_tr_b16 v[130:131], v152 offset:14336
    buffer_load_dwordx4 v165, s[16:19], s76 offen offset:1024 lds
    s_waitcnt lgkmcnt(11)
    v_mfma_f32_32x32x16_bf16 v[96:111], v[136:139], v[88:91], v[96:111]
    ds_read_b64_tr_b16 v[132:133], v153 offset:12288
    ds_read_b64_tr_b16 v[134:135], v153 offset:14336
    buffer_load_dwordx4 v166, s[16:19], s76 offen offset:2048 lds
    s_waitcnt lgkmcnt(12)
    v_mfma_f32_32x32x16_bf16 v[96:111], v[140:143], v[92:95], v[96:111]
    ds_read_b64_tr_b16 v[136:137], v154 offset:12288
    ds_read_b64_tr_b16 v[138:139], v154 offset:14336
    buffer_load_dwordx4 v167, s[16:19], s76 offen offset:3072 lds
    ds_read_b64_tr_b16 v[140:141], v155 offset:12288
    ds_read_b64_tr_b16 v[142:143], v155 offset:14336
    s_setprio 3
    s_nop 5
    v_max3_f32 v160, v96, v97, v98
    v_max3_f32 v161, v99, v100, v101
    v_max3_f32 v160, v160, v102, v103
    v_max3_f32 v161, v161, v104, v105
    v_max3_f32 v160, v160, v106, v107
    v_max3_f32 v161, v161, v108, v109
    v_max3_f32 v160, v160, v110, v111
    v_max_f32 v160, v160, v161
    v_cmp_gt_f32 vcc, v160, v159
    s_nop 0
    s_or_b64 s[52:53], vcc, s[50:51]
    s_cbranch_scc0 L_D1
    s_call_b64 s[38:39], L_slow
L_D1:
    v_exp_f32 v96, v96
    v_exp_f32 v97, v97
    v_exp_f32 v98, v98
    v_exp_f32 v99, v99
    v_exp_f32 v100, v100
    v_exp_f32 v101, v101
    v_exp_f32 v102, v102
    v_exp_f32 v103, v103
    v_add_f32 v157, v157, v96
    v_add_f32 v157, v157, v97
    v_add_f32 v157, v157, v98
    v_add_f32 v157, v157, v99
    v_add_f32 v157, v157, v100
    v_add_f32 v157, v157, v101
    v_add_f32 v157, v157, v102
    v_add_f32 v157, v157, v103
    v_cvt_pk_bf16_f32 v96, v96, v97
    v_cvt_pk_bf16_f32 v97, v98, v99
    v_cvt_pk_bf16_f32 v98, v100, v101
    v_cvt_pk_bf16_f32 v99, v102, v103
    v_exp_f32 v104, v104
    v_exp_f32 v105, v105
    v_exp_f32 v106, v106
    v_exp_f32 v107, v107
    v_exp_f32 v108, v108
    v_exp_f32 v109, v109
    v_exp_f32 v110, v110
    v_exp_f32 v111, v111
    v_add_f32 v157, v157, v104
    v_add_f32 v157, v157, v105
    v_add_f32 v157, v157, v106
    v_add_f32 v157, v157, v107
    v_add_f32 v157, v157, v108
    v_add_f32 v157, v157, v109
    v_add_f32 v157, v157, v110
    v_add_f32 v157, v157, v111
    v_cvt_pk_bf16_f32 v100, v104, v105
    v_cvt_pk_bf16_f32 v101, v106, v107
    v_cvt_pk_bf16_f32 v102, v108, v109
    v_cvt_pk_bf16_f32 v103, v110, v111
    s_waitcnt lgkmcnt(0)
    s_waitcnt vmcnt(8)
    s_barrier
    s_setprio 2
    v_mfma_f32_32x32x16_bf16 v[0:15], v[112:115], v[96:99], v[0:15]
    v_mfma_f32_32x32x16_bf16 v[16:31], v[116:119], v[96:99], v[16:31]
    ds_read_b128 v[112:115], v144 offset:16384
    v_mfma_f32_32x32x16_bf16 v[32:47], v[120:123], v[96:99], v[32:47]
    ds_read_b128 v[116:119], v145 offset:16384
    v_mfma_f32_32x32x16_bf16 v[48:63], v[124:127], v[96:99], v[48:63]
    ds_read_b128 v[120:123], v146 offset:16384
    v_mfma_f32_32x32x16_bf16 v[0:15], v[128:131], v[100:103], v[0:15]
    ds_read_b128 v[124:127], v147 offset:16384
    v_mfma_f32_32x32x16_bf16 v[16:31], v[132:135], v[100:103], v[16:31]
    ds_read_b128 v[128:131], v148 offset:16384
    v_mfma_f32_32x32x16_bf16 v[32:47], v[136:139], v[100:103], v[32:47]
    ds_read_b128 v[132:135], v149 offset:16384
    v_mfma_f32_32x32x16_bf16 v[48:63], v[140:143], v[100:103], v[48:63]
    ds_read_b128 v[136:139], v150 offset:16384
    ds_read_b128 v[140:143], v151 offset:16384
    s_setprio 1
    s_bfe_u32 s76, s7, 262160
    s_lshl_b32 s76, s76, 13
    s_add_u32 s76, s76, s47
    s_mul_i32 s77, s33, 40960
    s_add_u32 m0, s77, 8192
    s_waitcnt lgkmcnt(7)
    v_mfma_f32_32x32x16_bf16 v[96:111], v[112:115], v[64:67], 0
    buffer_load_dwordx4 v164, s[16:19], s76 offen offset:0 lds
    s_waitcnt lgkmcnt(6)
    v_mfma_f32_32x32x16_bf16 v[96:111], v[116:119], v[68:71], v[96:111]
    ds_read_b64_tr_b16 v[112:113], v152 offset:0
    ds_read_b64_tr_b16 v[114:115], v152 offset:2048
    buffer_load_dwordx4 v165, s[16:19], s76 offen offset:1024 lds
    s_waitcnt lgkmcnt(7)
    v_mfma_f32_32x32x16_bf16 v[96:111], v[120:123], v[72:75], v[96:111]
    ds_read_b64_tr_b16 v[116:117], v153 offset:0
    ds_read_b64_tr_b16 v[118:119], v153 offset:2048
    buffer_load_dwordx4 v166, s[16:19], s76 offen offset:2048 lds
    s_waitcnt lgkmcnt(8)
    v_mfma_f32_32x32x16_bf16 v[96:111], v[124:127], v[76:79], v[96:111]
    ds_read_b64_tr_b16 v[120:121], v154 offset:0
    ds_read_b64_tr_b16 v[122:123], v154 offset:2048
    buffer_load_dwordx4 v167, s[16:19], s76 offen offset:3072 lds
    s_waitcnt lgkmcnt(9)
    v_mfma_f32_32x32x16_bf16 v[96:111], v[128:131], v[80:83], v[96:111]
    ds_read_b64_tr_b16 v[124:125], v155 offset:0
    ds_read_b64_tr_b16 v[126:127], v155 offset:2048
    s_add_u32 m0, s77, 12288
    s_add_u32 s76, s76, 4096
    buffer_load_dwordx4 v164, s[16:19], s76 offen offset:0 lds
    s_waitcnt lgkmcnt(10)
    v_mfma_f32_32x32x16_bf16 v[96:111], v[132:135], v[84:87], v[96:111]
    ds_read_b64_tr_b16 v[128:129], v152 offset:4096
    ds_read_b64_tr_b16 v[130:131], v152 offset:6144
    buffer_load_dwordx4 v165, s[16:19], s76 offen offset:1024 lds
    s_waitcnt lgkmcnt(11)
    v_mfma_f32_32x32x16_bf16 v[96:111], v[136:139], v[88:91], v[96:111]
    ds_read_b64_tr_b16 v[132:133], v153 offset:4096
    ds_read_b64_tr_b16 v[134:135], v153 offset:6144
    buffer_load_dwordx4 v166, s[16:19], s76 offen offset:2048 lds
    s_waitcnt lgkmcnt(12)
    v_mfma_f32_32x32x16_bf16 v[96:111], v[140:143], v[92:95], v[96:111]
    ds_read_b64_tr_b16 v[136:137], v154 offset:4096
    ds_read_b64_tr_b16 v[138:139], v154 offset:6144
    buffer_load_dwordx4 v167, s[16:19], s76 offen offset:3072 lds
    ds_read_b64_tr_b16 v[140:141], v155 offset:4096
    ds_read_b64_tr_b16 v[142:143], v155 offset:6144
    s_setprio 3
    s_nop 5
    v_max3_f32 v160, v96, v97, v98
    v_max3_f32 v161, v99, v100, v101
    v_max3_f32 v160, v160, v102, v103
    v_max3_f32 v161, v161, v104, v105
    v_max3_f32 v160, v160, v106, v107
    v_max3_f32 v161, v161, v108, v109
    v_max3_f32 v160, v160, v110, v111
    v_max_f32 v160, v160, v161
    v_cmp_gt_f32 vcc, v160, v159
    s_nop 0
    s_or_b64 s[52:53], vcc, s[50:51]
    s_cbranch_scc0 L_D2
    s_call_b64 s[38:39], L_slow
L_D2:
    v_exp_f32 v96, v96
    v_exp_f32 v97, v97
    v_exp_f32 v98, v98
    v_exp_f32 v99, v99
    v_exp_f32 v100, v100
    v_exp_f32 v101, v101
    v_exp_f32 v102, v102
    v_exp_f32 v103, v103
    v_add_f32 v157, v157, v96
    v_add_f32 v157, v157, v97
    v_add_f32 v157, v157, v98
    v_add_f32 v157, v157, v99
    v_add_f32 v157, v157, v100
    v_add_f32 v157, v157, v101
    v_add_f32 v157, v157, v102
    v_add_f32 v157, v157, v103
    v_cvt_pk_bf16_f32 v96, v96, v97
    v_cvt_pk_bf16_f32 v97, v98, v99
    v_cvt_pk_bf16_f32 v98, v100, v101
    v_cvt_pk_bf16_f32 v99, v102, v103
    v_exp_f32 v104, v104
    v_exp_f32 v105, v105
    v_exp_f32 v106, v106
    v_exp_f32 v107, v107
    v_exp_f32 v108, v108
    v_exp_f32 v109, v109
    v_exp_f32 v110, v110
    v_exp_f32 v111, v111
    v_add_f32 v157, v157, v104
    v_add_f32 v157, v157, v105
    v_add_f32 v157, v157, v106
    v_add_f32 v157, v157, v107
    v_add_f32 v157, v157, v108
    v_add_f32 v157, v157, v109
    v_add_f32 v157, v157, v110
    v_add_f32 v157, v157, v111
    v_cvt_pk_bf16_f32 v100, v104, v105
    v_cvt_pk_bf16_f32 v101, v106, v107
    v_cvt_pk_bf16_f32 v102, v108, v109
    v_cvt_pk_bf16_f32 v103, v110, v111
    s_waitcnt lgkmcnt(0)
    s_waitcnt vmcnt(8)
    s_barrier
    s_setprio 2
    v_mfma_f32_32x32x16_bf16 v[0:15], v[112:115], v[96:99], v[0:15]
    v_mfma_f32_32x32x16_bf16 v[16:31], v[116:119], v[96:99], v[16:31]
    ds_read_b128 v[112:115], v144 offset:0
    v_mfma_f32_32x32x16_bf16 v[32:47], v[120:123], v[96:99], v[32:47]
    ds_read_b128 v[116:119], v145 offset:0
    v_mfma_f32_32x32x16_bf16 v[48:63], v[124:127], v[96:99], v[48:63]
    ds_read_b128 v[120:123], v146 offset:0
    v_mfma_f32_32x32x16_bf16 v[0:15], v[128:131], v[100:103], v[0:15]
    ds_read_b128 v[124:127], v147 offset:0
    v_mfma_f32_32x32x16_bf16 v[16:31], v[132:135], v[100:103], v[16:31]
    ds_read_b128 v[128:131], v148 offset:0
    v_mfma_f32_32x32x16_bf16 v[32:47], v[136:139], v[100:103], v[32:47]
    ds_read_b128 v[132:135], v149 offset:0
    v_mfma_f32_32x32x16_bf16 v[48:63], v[140:143], v[100:103], v[48:63]
    ds_read_b128 v[136:139], v150 offset:0
    ds_read_b128 v[140:143], v151 offset:0
    s_setprio 1
    s_bfe_u32 s76, s7, 262164
    s_lshl_b32 s76, s76, 13
    s_add_u32 s76, s76, s47
    s_mul_i32 s77, s33, 40960
    s_add_u32 m0, s77, 16384
    s_waitcnt lgkmcnt(7)
    v_mfma_f32_32x32x16_bf16 v[96:111], v[112:115], v[64:67], 0
    buffer_load_dwordx4 v164, s[16:19], s76 offen offset:0 lds
    s_waitcnt lgkmcnt(6)
    v_mfma_f32_32x32x16_bf16 v[96:111], v[116:119], v[68:71], v[96:111]
    ds_read_b64_tr_b16 v[112:113], v152 offset:8192
    ds_read_b64_tr_b16 v[114:115], v152 offset:10240
    buffer_load_dwordx4 v165, s[16:19], s76 offen offset:1024 lds
    s_waitcnt lgkmcnt(7)
    v_mfma_f32_32x32x16_bf16 v[96:111], v[120:123], v[72:75], v[96:111]
    ds_read_b64_tr_b16 v[116:117], v153 offset:8192
    ds_read_b64_tr_b16 v[118:119], v153 offset:10240
    buffer_load_dwordx4 v166, s[16:19], s76 offen offset:2048 lds
    s_waitcnt lgkmcnt(8)
    v_mfma_f32_32x32x16_bf16 v[96:111], v[124:127], v[76:79], v[96:111]
    ds_read_b64_tr_b16 v[120:121], v154 offset:8192
    ds_read_b64_tr_b16 v[122:123], v154 offset:10240
    buffer_load_dwordx4 v167, s[16:19], s76 offen offset:3072 lds
    s_waitcnt lgkmcnt(9)
    v_mfma_f32_32x32x16_bf16 v[96:111], v[128:131], v[80:83], v[96:111]
    ds_read_b64_tr_b16 v[124:125], v155 offset:8192
    ds_read_b64_tr_b16 v[126:127], v155 offset:10240
    s_add_u32 m0, s77, 20480
    s_add_u32 s76, s76, 4096
    buffer_load_dwordx4 v164, s[16:19], s76 offen offset:0 lds
    s_waitcnt lgkmcnt(10)
    v_mfma_f32_32x32x16_bf16 v[96:111], v[132:135], v[84:87], v[96:111]
    ds_read_b64_tr_b16 v[128:129], v152 offset:12288
    ds_read_b64_tr_b16 v[130:131], v152 offset:14336
    buffer_load_dwordx4 v165, s[16:19], s76 offen offset:1024 lds
    s_waitcnt lgkmcnt(11)
    v_mfma_f32_32x32x16_bf16 v[96:111], v[136:139], v[88:91], v[96:111]
    ds_read_b64_tr_b16 v[132:133], v153 offset:12288
    ds_read_b64_tr_b16 v[134:135], v153 offset:14336
    buffer_load_dwordx4 v166, s[16:19], s76 offen offset:2048 lds
    s_waitcnt lgkmcnt(12)
    v_mfma_f32_32x32x16_bf16 v[96:111], v[140:143], v[92:95], v[96:111]
    ds_read_b64_tr_b16 v[136:137], v154 offset:12288
    ds_read_b64_tr_b16 v[138:139], v154 offset:14336
    buffer_load_dwordx4 v167, s[16:19], s76 offen offset:3072 lds
    ds_read_b64_tr_b16 v[140:141], v155 offset:12288
    ds_read_b64_tr_b16 v[142:143], v155 offset:14336
    s_setprio 3
    s_nop 5
    v_max3_f32 v160, v96, v97, v98
    v_max3_f32 v161, v99, v100, v101
    v_max3_f32 v160, v160, v102, v103
    v_max3_f32 v161, v161, v104, v105
    v_max3_f32 v160, v160, v106, v107
    v_max3_f32 v161, v161, v108, v109
    v_max3_f32 v160, v160, v110, v111
    v_max_f32 v160, v160, v161
    v_cmp_gt_f32 vcc, v160, v159
    s_nop 0
    s_or_b64 s[52:53], vcc, s[50:51]
    s_cbranch_scc0 L_D3
    s_call_b64 s[38:39], L_slow
L_D3:
    v_exp_f32 v96, v96
    v_exp_f32 v97, v97
    v_exp_f32 v98, v98
    v_exp_f32 v99, v99
    v_exp_f32 v100, v100
    v_exp_f32 v101, v101
    v_exp_f32 v102, v102
    v_exp_f32 v103, v103
    v_add_f32 v157, v157, v96
    v_add_f32 v157, v157, v97
    v_add_f32 v157, v157, v98
    v_add_f32 v157, v157, v99
    v_add_f32 v157, v157, v100
    v_add_f32 v157, v157, v101
    v_add_f32 v157, v157, v102
    v_add_f32 v157, v157, v103
    v_cvt_pk_bf16_f32 v96, v96, v97
    v_cvt_pk_bf16_f32 v97, v98, v99
    v_cvt_pk_bf16_f32 v98, v100, v101
    v_cvt_pk_bf16_f32 v99, v102, v103
    v_exp_f32 v104, v104
    v_exp_f32 v105, v105
    v_exp_f32 v106, v106
    v_exp_f32 v107, v107
    v_exp_f32 v108, v108
    v_exp_f32 v109, v109
    v_exp_f32 v110, v110
    v_exp_f32 v111, v111
    v_add_f32 v157, v157, v104
    v_add_f32 v157, v157, v105
    v_add_f32 v157, v157, v106
    v_add_f32 v157, v157, v107
    v_add_f32 v157, v157, v108
    v_add_f32 v157, v157, v109
    v_add_f32 v157, v157, v110
    v_add_f32 v157, v157, v111
    v_cvt_pk_bf16_f32 v100, v104, v105
    v_cvt_pk_bf16_f32 v101, v106, v107
    v_cvt_pk_bf16_f32 v102, v108, v109
    v_cvt_pk_bf16_f32 v103, v110, v111
    s_waitcnt lgkmcnt(0)
    s_waitcnt vmcnt(8)
    s_barrier
    s_setprio 2
    v_mfma_f32_32x32x16_bf16 v[0:15], v[112:115], v[96:99], v[0:15]
    v_mfma_f32_32x32x16_bf16 v[16:31], v[116:119], v[96:99], v[16:31]
    ds_read_b128 v[112:115], v144 offset:8192
    v_mfma_f32_32x32x16_bf16 v[32:47], v[120:123], v[96:99], v[32:47]
    ds_read_b128 v[116:119], v145 offset:8192
    v_mfma_f32_32x32x16_bf16 v[48:63], v[124:127], v[96:99], v[48:63]
    ds_read_b128 v[120:123], v146 offset:8192
    v_mfma_f32_32x32x16_bf16 v[0:15], v[128:131], v[100:103], v[0:15]
    ds_read_b128 v[124:127], v147 offset:8192
    v_mfma_f32_32x32x16_bf16 v[16:31], v[132:135], v[100:103], v[16:31]
    ds_read_b128 v[128:131], v148 offset:8192
    v_mfma_f32_32x32x16_bf16 v[32:47], v[136:139], v[100:103], v[32:47]
    ds_read_b128 v[132:135], v149 offset:8192
    v_mfma_f32_32x32x16_bf16 v[48:63], v[140:143], v[100:103], v[48:63]
    ds_read_b128 v[136:139], v150 offset:8192
    ds_read_b128 v[140:143], v151 offset:8192
    s_setprio 1
    s_bfe_u32 s76, s7, 262168
    s_lshl_b32 s76, s76, 13
    s_add_u32 s76, s76, s47
    s_mul_i32 s77, s33, 40960
    s_add_u32 m0, s77, 0
    s_waitcnt lgkmcnt(7)
    v_mfma_f32_32x32x16_bf16 v[96:111], v[112:115], v[64:67], 0
    buffer_load_dwordx4 v164, s[16:19], s76 offen offset:0 lds
    s_waitcnt lgkmcnt(6)
    v_mfma_f32_32x32x16_bf16 v[96:111], v[116:119], v[68:71], v[96:111]
    ds_read_b64_tr_b16 v[112:113], v152 offset:0
    ds_read_b64_tr_b16 v[114:115], v152 offset:2048
    buffer_load_dwordx4 v165, s[16:19], s76 offen offset:1024 lds
    s_waitcnt lgkmcnt(7)
    v_mfma_f32_32x32x16_bf16 v[96:111], v[120:123], v[72:75], v[96:111]
    ds_read_b64_tr_b16 v[116:117], v153 offset:0
    ds_read_b64_tr_b16 v[118:119], v153 offset:2048
    buffer_load_dwordx4 v166, s[16:19], s76 offen offset:2048 lds
    s_waitcnt lgkmcnt(8)
    v_mfma_f32_32x32x16_bf16 v[96:111], v[124:127], v[76:79], v[96:111]
    ds_read_b64_tr_b16 v[120:121], v154 offset:0
    ds_read_b64_tr_b16 v[122:123], v154 offset:2048
    buffer_load_dwordx4 v167, s[16:19], s76 offen offset:3072 lds
    s_waitcnt lgkmcnt(9)
    v_mfma_f32_32x32x16_bf16 v[96:111], v[128:131], v[80:83], v[96:111]
    ds_read_b64_tr_b16 v[124:125], v155 offset:0
    ds_read_b64_tr_b16 v[126:127], v155 offset:2048
    s_add_u32 m0, s77, 4096
    s_add_u32 s76, s76, 4096
    buffer_load_dwordx4 v164, s[16:19], s76 offen offset:0 lds
    s_waitcnt lgkmcnt(10)
    v_mfma_f32_32x32x16_bf16 v[96:111], v[132:135], v[84:87], v[96:111]
    ds_read_b64_tr_b16 v[128:129], v152 offset:4096
    ds_read_b64_tr_b16 v[130:131], v152 offset:6144
    buffer_load_dwordx4 v165, s[16:19], s76 offen offset:1024 lds
    s_waitcnt lgkmcnt(11)
    v_mfma_f32_32x32x16_bf16 v[96:111], v[136:139], v[88:91], v[96:111]
    ds_read_b64_tr_b16 v[132:133], v153 offset:4096
    ds_read_b64_tr_b16 v[134:135], v153 offset:6144
    buffer_load_dwordx4 v166, s[16:19], s76 offen offset:2048 lds
    s_waitcnt lgkmcnt(12)
    v_mfma_f32_32x32x16_bf16 v[96:111], v[140:143], v[92:95], v[96:111]
    ds_read_b64_tr_b16 v[136:137], v154 offset:4096
    ds_read_b64_tr_b16 v[138:139], v154 offset:6144
    buffer_load_dwordx4 v167, s[16:19], s76 offen offset:3072 lds
    ds_read_b64_tr_b16 v[140:141], v155 offset:4096
    ds_read_b64_tr_b16 v[142:143], v155 offset:6144
    s_setprio 3
    s_nop 5
    v_max3_f32 v160, v96, v97, v98
    v_max3_f32 v161, v99, v100, v101
    v_max3_f32 v160, v160, v102, v103
    v_max3_f32 v161, v161, v104, v105
    v_max3_f32 v160, v160, v106, v107
    v_max3_f32 v161, v161, v108, v109
    v_max3_f32 v160, v160, v110, v111
    v_max_f32 v160, v160, v161
    v_cmp_gt_f32 vcc, v160, v159
    s_nop 0
    s_or_b64 s[52:53], vcc, s[50:51]
    s_cbranch_scc0 L_D4
    s_call_b64 s[38:39], L_slow
L_D4:
    v_exp_f32 v96, v96
    v_exp_f32 v97, v97
    v_exp_f32 v98, v98
    v_exp_f32 v99, v99
    v_exp_f32 v100, v100
    v_exp_f32 v101, v101
    v_exp_f32 v102, v102
    v_exp_f32 v103, v103
    v_add_f32 v157, v157, v96
    v_add_f32 v157, v157, v97
    v_add_f32 v157, v157, v98
    v_add_f32 v157, v157, v99
    v_add_f32 v157, v157, v100
    v_add_f32 v157, v157, v101
    v_add_f32 v157, v157, v102
    v_add_f32 v157, v157, v103
    v_cvt_pk_bf16_f32 v96, v96, v97
    v_cvt_pk_bf16_f32 v97, v98, v99
    v_cvt_pk_bf16_f32 v98, v100, v101
    v_cvt_pk_bf16_f32 v99, v102, v103
    v_exp_f32 v104, v104
    v_exp_f32 v105, v105
    v_exp_f32 v106, v106
    v_exp_f32 v107, v107
    v_exp_f32 v108, v108
    v_exp_f32 v109, v109
    v_exp_f32 v110, v110
    v_exp_f32 v111, v111
    v_add_f32 v157, v157, v104
    v_add_f32 v157, v157, v105
    v_add_f32 v157, v157, v106
    v_add_f32 v157, v157, v107
    v_add_f32 v157, v157, v108
    v_add_f32 v157, v157, v109
    v_add_f32 v157, v157, v110
    v_add_f32 v157, v157, v111
    v_cvt_pk_bf16_f32 v100, v104, v105
    v_cvt_pk_bf16_f32 v101, v106, v107
    v_cvt_pk_bf16_f32 v102, v108, v109
    v_cvt_pk_bf16_f32 v103, v110, v111
    s_waitcnt lgkmcnt(0)
    s_waitcnt vmcnt(8)
    s_barrier
    s_setprio 2
    v_mfma_f32_32x32x16_bf16 v[0:15], v[112:115], v[96:99], v[0:15]
    v_mfma_f32_32x32x16_bf16 v[16:31], v[116:119], v[96:99], v[16:31]
    ds_read_b128 v[112:115], v144 offset:16384
    v_mfma_f32_32x32x16_bf16 v[32:47], v[120:123], v[96:99], v[32:47]
    ds_read_b128 v[116:119], v145 offset:16384
    v_mfma_f32_32x32x16_bf16 v[48:63], v[124:127], v[96:99], v[48:63]
    ds_read_b128 v[120:123], v146 offset:16384
    v_mfma_f32_32x32x16_bf16 v[0:15], v[128:131], v[100:103], v[0:15]
    ds_read_b128 v[124:127], v147 offset:16384
    v_mfma_f32_32x32x16_bf16 v[16:31], v[132:135], v[100:103], v[16:31]
    ds_read_b128 v[128:131], v148 offset:16384
    v_mfma_f32_32x32x16_bf16 v[32:47], v[136:139], v[100:103], v[32:47]
    ds_read_b128 v[132:135], v149 offset:16384
    v_mfma_f32_32x32x16_bf16 v[48:63], v[140:143], v[100:103], v[48:63]
    ds_read_b128 v[136:139], v150 offset:16384
    ds_read_b128 v[140:143], v151 offset:16384
    s_setprio 1
    s_bfe_u32 s76, s7, 262172
    s_lshl_b32 s76, s76, 13
    s_add_u32 s76, s76, s47
    s_mul_i32 s77, s33, 40960
    s_add_u32 m0, s77, 8192
    s_waitcnt lgkmcnt(7)
    v_mfma_f32_32x32x16_bf16 v[96:111], v[112:115], v[64:67], 0
    buffer_load_dwordx4 v164, s[16:19], s76 offen offset:0 lds
    s_waitcnt lgkmcnt(6)
    v_mfma_f32_32x32x16_bf16 v[96:111], v[116:119], v[68:71], v[96:111]
    ds_read_b64_tr_b16 v[112:113], v152 offset:8192
    ds_read_b64_tr_b16 v[114:115], v152 offset:10240
    buffer_load_dwordx4 v165, s[16:19], s76 offen offset:1024 lds
    s_waitcnt lgkmcnt(7)
    v_mfma_f32_32x32x16_bf16 v[96:111], v[120:123], v[72:75], v[96:111]
    ds_read_b64_tr_b16 v[116:117], v153 offset:8192
    ds_read_b64_tr_b16 v[118:119], v153 offset:10240
    buffer_load_dwordx4 v166, s[16:19], s76 offen offset:2048 lds
    s_waitcnt lgkmcnt(8)
    v_mfma_f32_32x32x16_bf16 v[96:111], v[124:127], v[76:79], v[96:111]
    ds_read_b64_tr_b16 v[120:121], v154 offset:8192
    ds_read_b64_tr_b16 v[122:123], v154 offset:10240
    buffer_load_dwordx4 v167, s[16:19], s76 offen offset:3072 lds
    s_waitcnt lgkmcnt(9)
    v_mfma_f32_32x32x16_bf16 v[96:111], v[128:131], v[80:83], v[96:111]
    ds_read_b64_tr_b16 v[124:125], v155 offset:8192
    ds_read_b64_tr_b16 v[126:127], v155 offset:10240
    s_add_u32 m0, s77, 12288
    s_add_u32 s76, s76, 4096
    buffer_load_dwordx4 v164, s[16:19], s76 offen offset:0 lds
    s_waitcnt lgkmcnt(10)
    v_mfma_f32_32x32x16_bf16 v[96:111], v[132:135], v[84:87], v[96:111]
    ds_read_b64_tr_b16 v[128:129], v152 offset:12288
    ds_read_b64_tr_b16 v[130:131], v152 offset:14336
    buffer_load_dwordx4 v165, s[16:19], s76 offen offset:1024 lds
    s_waitcnt lgkmcnt(11)
    v_mfma_f32_32x32x16_bf16 v[96:111], v[136:139], v[88:91], v[96:111]
    ds_read_b64_tr_b16 v[132:133], v153 offset:12288
    ds_read_b64_tr_b16 v[134:135], v153 offset:14336
    buffer_load_dwordx4 v166, s[16:19], s76 offen offset:2048 lds
    s_waitcnt lgkmcnt(12)
    v_mfma_f32_32x32x16_bf16 v[96:111], v[140:143], v[92:95], v[96:111]
    ds_read_b64_tr_b16 v[136:137], v154 offset:12288
    ds_read_b64_tr_b16 v[138:139], v154 offset:14336
    buffer_load_dwordx4 v167, s[16:19], s76 offen offset:3072 lds
    ds_read_b64_tr_b16 v[140:141], v155 offset:12288
    ds_read_b64_tr_b16 v[142:143], v155 offset:14336
    s_setprio 3
    s_nop 5
    v_max3_f32 v160, v96, v97, v98
    v_max3_f32 v161, v99, v100, v101
    v_max3_f32 v160, v160, v102, v103
    v_max3_f32 v161, v161, v104, v105
    v_max3_f32 v160, v160, v106, v107
    v_max3_f32 v161, v161, v108, v109
    v_max3_f32 v160, v160, v110, v111
    v_max_f32 v160, v160, v161
    v_cmp_gt_f32 vcc, v160, v159
    s_nop 0
    s_or_b64 s[52:53], vcc, s[50:51]
    s_cbranch_scc0 L_D5
    s_call_b64 s[38:39], L_slow
L_D5:
    v_exp_f32 v96, v96
    v_exp_f32 v97, v97
    v_exp_f32 v98, v98
    v_exp_f32 v99, v99
    v_exp_f32 v100, v100
    v_exp_f32 v101, v101
    v_exp_f32 v102, v102
    v_exp_f32 v103, v103
    v_add_f32 v157, v157, v96
    v_add_f32 v157, v157, v97
    v_add_f32 v157, v157, v98
    v_add_f32 v157, v157, v99
    v_add_f32 v157, v157, v100
    v_add_f32 v157, v157, v101
    v_add_f32 v157, v157, v102
    v_add_f32 v157, v157, v103
    v_cvt_pk_bf16_f32 v96, v96, v97
    v_cvt_pk_bf16_f32 v97, v98, v99
    v_cvt_pk_bf16_f32 v98, v100, v101
    v_cvt_pk_bf16_f32 v99, v102, v103
    v_exp_f32 v104, v104
    v_exp_f32 v105, v105
    v_exp_f32 v106, v106
    v_exp_f32 v107, v107
    v_exp_f32 v108, v108
    v_exp_f32 v109, v109
    v_exp_f32 v110, v110
    v_exp_f32 v111, v111
    v_add_f32 v157, v157, v104
    v_add_f32 v157, v157, v105
    v_add_f32 v157, v157, v106
    v_add_f32 v157, v157, v107
    v_add_f32 v157, v157, v108
    v_add_f32 v157, v157, v109
    v_add_f32 v157, v157, v110
    v_add_f32 v157, v157, v111
    v_cvt_pk_bf16_f32 v100, v104, v105
    v_cvt_pk_bf16_f32 v101, v106, v107
    v_cvt_pk_bf16_f32 v102, v108, v109
    v_cvt_pk_bf16_f32 v103, v110, v111
    s_waitcnt lgkmcnt(0)
    s_waitcnt vmcnt(8)
    s_barrier
    s_setprio 2
    v_mfma_f32_32x32x16_bf16 v[0:15], v[112:115], v[96:99], v[0:15]
    v_mfma_f32_32x32x16_bf16 v[16:31], v[116:119], v[96:99], v[16:31]
    ds_read_b128 v[112:115], v144 offset:0
    v_mfma_f32_32x32x16_bf16 v[32:47], v[120:123], v[96:99], v[32:47]
    ds_read_b128 v[116:119], v145 offset:0
    v_mfma_f32_32x32x16_bf16 v[48:63], v[124:127], v[96:99], v[48:63]
    ds_read_b128 v[120:123], v146 offset:0
    v_mfma_f32_32x32x16_bf16 v[0:15], v[128:131], v[100:103], v[0:15]
    ds_read_b128 v[124:127], v147 offset:0
    v_mfma_f32_32x32x16_bf16 v[16:31], v[132:135], v[100:103], v[16:31]
    ds_read_b128 v[128:131], v148 offset:0
    v_mfma_f32_32x32x16_bf16 v[32:47], v[136:139], v[100:103], v[32:47]
    ds_read_b128 v[132:135], v149 offset:0
    v_mfma_f32_32x32x16_bf16 v[48:63], v[140:143], v[100:103], v[48:63]
    ds_read_b128 v[136:139], v150 offset:0
    ds_read_b128 v[140:143], v151 offset:0
    s_setprio 1
    s_waitcnt lgkmcnt(7)
    v_mfma_f32_32x32x16_bf16 v[96:111], v[112:115], v[64:67], 0
    s_waitcnt lgkmcnt(6)
    v_mfma_f32_32x32x16_bf16 v[96:111], v[116:119], v[68:71], v[96:111]
    ds_read_b64_tr_b16 v[112:113], v152 offset:0
    ds_read_b64_tr_b16 v[114:115], v152 offset:2048
    s_waitcnt lgkmcnt(7)
    v_mfma_f32_32x32x16_bf16 v[96:111], v[120:123], v[72:75], v[96:111]
    ds_read_b64_tr_b16 v[116:117], v153 offset:0
    ds_read_b64_tr_b16 v[118:119], v153 offset:2048
    s_waitcnt lgkmcnt(8)
    v_mfma_f32_32x32x16_bf16 v[96:111], v[124:127], v[76:79], v[96:111]
    ds_read_b64_tr_b16 v[120:121], v154 offset:0
    ds_read_b64_tr_b16 v[122:123], v154 offset:2048
    s_waitcnt lgkmcnt(9)
    v_mfma_f32_32x32x16_bf16 v[96:111], v[128:131], v[80:83], v[96:111]
    ds_read_b64_tr_b16 v[124:125], v155 offset:0
    ds_read_b64_tr_b16 v[126:127], v155 offset:2048
    s_waitcnt lgkmcnt(10)
    v_mfma_f32_32x32x16_bf16 v[96:111], v[132:135], v[84:87], v[96:111]
    ds_read_b64_tr_b16 v[128:129], v152 offset:4096
    ds_read_b64_tr_b16 v[130:131], v152 offset:6144
    s_waitcnt lgkmcnt(11)
    v_mfma_f32_32x32x16_bf16 v[96:111], v[136:139], v[88:91], v[96:111]
    ds_read_b64_tr_b16 v[132:133], v153 offset:4096
    ds_read_b64_tr_b16 v[134:135], v153 offset:6144
    s_waitcnt lgkmcnt(12)
    v_mfma_f32_32x32x16_bf16 v[96:111], v[140:143], v[92:95], v[96:111]
    ds_read_b64_tr_b16 v[136:137], v154 offset:4096
    ds_read_b64_tr_b16 v[138:139], v154 offset:6144
    ds_read_b64_tr_b16 v[140:141], v155 offset:4096
    ds_read_b64_tr_b16 v[142:143], v155 offset:6144
    s_setprio 3
    s_nop 6
    v_max3_f32 v160, v96, v97, v98
    v_max3_f32 v161, v99, v100, v101
    v_max3_f32 v160, v160, v102, v103
    v_max3_f32 v161, v161, v104, v105
    v_max3_f32 v160, v160, v106, v107
    v_max3_f32 v161, v161, v108, v109
    v_max3_f32 v160, v160, v110, v111
    v_max_f32 v160, v160, v161
    v_cmp_gt_f32 vcc, v160, v159
    s_nop 0
    s_or_b64 s[52:53], vcc, s[50:51]
    s_cbranch_scc0 L_D6
    s_call_b64 s[38:39], L_slow
L_D6:
    v_exp_f32 v96, v96
    v_exp_f32 v97, v97
    v_exp_f32 v98, v98
    v_exp_f32 v99, v99
    v_exp_f32 v100, v100
    v_exp_f32 v101, v101
    v_exp_f32 v102, v102
    v_exp_f32 v103, v103
    v_add_f32 v157, v157, v96
    v_add_f32 v157, v157, v97
    v_add_f32 v157, v157, v98
    v_add_f32 v157, v157, v99
    v_add_f32 v157, v157, v100
    v_add_f32 v157, v157, v101
    v_add_f32 v157, v157, v102
    v_add_f32 v157, v157, v103
    v_cvt_pk_bf16_f32 v96, v96, v97
    v_cvt_pk_bf16_f32 v97, v98, v99
    v_cvt_pk_bf16_f32 v98, v100, v101
    v_cvt_pk_bf16_f32 v99, v102, v103
    v_exp_f32 v104, v104
    v_exp_f32 v105, v105
    v_exp_f32 v106, v106
    v_exp_f32 v107, v107
    v_exp_f32 v108, v108
    v_exp_f32 v109, v109
    v_exp_f32 v110, v110
    v_exp_f32 v111, v111
    v_add_f32 v157, v157, v104
    v_add_f32 v157, v157, v105
    v_add_f32 v157, v157, v106
    v_add_f32 v157, v157, v107
    v_add_f32 v157, v157, v108
    v_add_f32 v157, v157, v109
    v_add_f32 v157, v157, v110
    v_add_f32 v157, v157, v111
    v_cvt_pk_bf16_f32 v100, v104, v105
    v_cvt_pk_bf16_f32 v101, v106, v107
    v_cvt_pk_bf16_f32 v102, v108, v109
    v_cvt_pk_bf16_f32 v103, v110, v111
    s_waitcnt lgkmcnt(0)
    s_waitcnt vmcnt(0)
    s_barrier
    s_setprio 2
    v_mfma_f32_32x32x16_bf16 v[0:15], v[112:115], v[96:99], v[0:15]
    v_mfma_f32_32x32x16_bf16 v[16:31], v[116:119], v[96:99], v[16:31]
    ds_read_b128 v[112:115], v144 offset:8192
    v_mfma_f32_32x32x16_bf16 v[32:47], v[120:123], v[96:99], v[32:47]
    ds_read_b128 v[116:119], v145 offset:8192
    v_mfma_f32_32x32x16_bf16 v[48:63], v[124:127], v[96:99], v[48:63]
    ds_read_b128 v[120:123], v146 offset:8192
    v_mfma_f32_32x32x16_bf16 v[0:15], v[128:131], v[100:103], v[0:15]
    ds_read_b128 v[124:127], v147 offset:8192
    v_mfma_f32_32x32x16_bf16 v[16:31], v[132:135], v[100:103], v[16:31]
    ds_read_b128 v[128:131], v148 offset:8192
    v_mfma_f32_32x32x16_bf16 v[32:47], v[136:139], v[100:103], v[32:47]
    ds_read_b128 v[132:135], v149 offset:8192
    v_mfma_f32_32x32x16_bf16 v[48:63], v[140:143], v[100:103], v[48:63]
    ds_read_b128 v[136:139], v150 offset:8192
    ds_read_b128 v[140:143], v151 offset:8192
    s_setprio 1
    s_waitcnt lgkmcnt(7)
    v_mfma_f32_32x32x16_bf16 v[96:111], v[112:115], v[64:67], 0
    s_waitcnt lgkmcnt(6)
    v_mfma_f32_32x32x16_bf16 v[96:111], v[116:119], v[68:71], v[96:111]
    ds_read_b64_tr_b16 v[112:113], v152 offset:8192
    ds_read_b64_tr_b16 v[114:115], v152 offset:10240
    s_waitcnt lgkmcnt(7)
    v_mfma_f32_32x32x16_bf16 v[96:111], v[120:123], v[72:75], v[96:111]
    ds_read_b64_tr_b16 v[116:117], v153 offset:8192
    ds_read_b64_tr_b16 v[118:119], v153 offset:10240
    s_waitcnt lgkmcnt(8)
    v_mfma_f32_32x32x16_bf16 v[96:111], v[124:127], v[76:79], v[96:111]
    ds_read_b64_tr_b16 v[120:121], v154 offset:8192
    ds_read_b64_tr_b16 v[122:123], v154 offset:10240
    s_waitcnt lgkmcnt(9)
    v_mfma_f32_32x32x16_bf16 v[96:111], v[128:131], v[80:83], v[96:111]
    ds_read_b64_tr_b16 v[124:125], v155 offset:8192
    ds_read_b64_tr_b16 v[126:127], v155 offset:10240
    s_waitcnt lgkmcnt(10)
    v_mfma_f32_32x32x16_bf16 v[96:111], v[132:135], v[84:87], v[96:111]
    ds_read_b64_tr_b16 v[128:129], v152 offset:12288
    ds_read_b64_tr_b16 v[130:131], v152 offset:14336
    s_waitcnt lgkmcnt(11)
    v_mfma_f32_32x32x16_bf16 v[96:111], v[136:139], v[88:91], v[96:111]
    ds_read_b64_tr_b16 v[132:133], v153 offset:12288
    ds_read_b64_tr_b16 v[134:135], v153 offset:14336
    s_waitcnt lgkmcnt(12)
    v_mfma_f32_32x32x16_bf16 v[96:111], v[140:143], v[92:95], v[96:111]
    ds_read_b64_tr_b16 v[136:137], v154 offset:12288
    ds_read_b64_tr_b16 v[138:139], v154 offset:14336
    ds_read_b64_tr_b16 v[140:141], v155 offset:12288
    ds_read_b64_tr_b16 v[142:143], v155 offset:14336
    s_setprio 3
    s_nop 6
    v_max3_f32 v160, v96, v97, v98
    v_max3_f32 v161, v99, v100, v101
    v_max3_f32 v160, v160, v102, v103
    v_max3_f32 v161, v161, v104, v105
    v_max3_f32 v160, v160, v106, v107
    v_max3_f32 v161, v161, v108, v109
    v_max3_f32 v160, v160, v110, v111
    v_max_f32 v160, v160, v161
    v_cmp_gt_f32 vcc, v160, v159
    s_nop 0
    s_or_b64 s[52:53], vcc, s[50:51]
    s_cbranch_scc0 L_D7
    s_call_b64 s[38:39], L_slow
L_D7:
    v_exp_f32 v96, v96
    v_exp_f32 v97, v97
    v_exp_f32 v98, v98
    v_exp_f32 v99, v99
    v_exp_f32 v100, v100
    v_exp_f32 v101, v101
    v_exp_f32 v102, v102
    v_exp_f32 v103, v103
    v_add_f32 v157, v157, v96
    v_add_f32 v157, v157, v97
    v_add_f32 v157, v157, v98
    v_add_f32 v157, v157, v99
    v_add_f32 v157, v157, v100
    v_add_f32 v157, v157, v101
    v_add_f32 v157, v157, v102
    v_add_f32 v157, v157, v103
    v_cvt_pk_bf16_f32 v96, v96, v97
    v_cvt_pk_bf16_f32 v97, v98, v99
    v_cvt_pk_bf16_f32 v98, v100, v101
    v_cvt_pk_bf16_f32 v99, v102, v103
    v_exp_f32 v104, v104
    v_exp_f32 v105, v105
    v_exp_f32 v106, v106
    v_exp_f32 v107, v107
    v_exp_f32 v108, v108
    v_exp_f32 v109, v109
    v_exp_f32 v110, v110
    v_exp_f32 v111, v111
    v_add_f32 v157, v157, v104
    v_add_f32 v157, v157, v105
    v_add_f32 v157, v157, v106
    v_add_f32 v157, v157, v107
    v_add_f32 v157, v157, v108
    v_add_f32 v157, v157, v109
    v_add_f32 v157, v157, v110
    v_add_f32 v157, v157, v111
    v_cvt_pk_bf16_f32 v100, v104, v105
    v_cvt_pk_bf16_f32 v101, v106, v107
    v_cvt_pk_bf16_f32 v102, v108, v109
    v_cvt_pk_bf16_f32 v103, v110, v111
    s_waitcnt lgkmcnt(0)
    v_mfma_f32_32x32x16_bf16 v[0:15], v[112:115], v[96:99], v[0:15]
    v_lshlrev_b32 v64, 4, v163
    s_mul_i32 s76, s33, 40960
    s_add_u32 s3, s34, 1
    s_lshl_b32 s3, s3, 13
    s_cmp_eq_u32 s34, 0
    s_cselect_b32 s3, 0, s3
    v_mfma_f32_32x32x16_bf16 v[16:31], v[116:119], v[96:99], v[16:31]
    s_add_u32 s77, s76, s3
    v_add_u32 v80, s77, v64
    v_and_b32 v81, 31, v163
    v_lshlrev_b32 v81, 3, v81
    s_lshl_b32 s3, s34, 8
    s_add_u32 s3, s3, 6144
    v_mfma_f32_32x32x16_bf16 v[32:47], v[120:123], v[96:99], v[32:47]
    v_add_u32 v81, s3, v81
    v_add_u32 v68, s76, v81
    v_and_b32 v82, 31, v163
    s_lshl_b32 s3, s34, 5
    v_add_u32 v82, s3, v82
    v_cmp_le_u32 vcc, 48, v82
    v_mfma_f32_32x32x16_bf16 v[48:63], v[124:127], v[96:99], v[48:63]
    v_subrev_u32 v83, 48, v82
    v_lshrrev_b32 v84, 5, v163
    v_cndmask_b32 v79, v82, v83, vcc
    v_cndmask_b32 v78, 0, 1, vcc
    v_lshlrev_b32 v84, 8, v84
    s_and_b32 s3, s31, 1
    v_mfma_f32_32x32x16_bf16 v[0:15], v[128:131], v[100:103], v[0:15]
    s_mul_i32 s76, s3, 48
    s_xor_b32 s3, s3, 1
    s_mul_i32 s77, s3, 48
    v_add_u32 v82, s76, v79
    v_lshrrev_b32 v83, 4, v82
    v_lshlrev_b32 v83, 10, v83
    v_mfma_f32_32x32x16_bf16 v[16:31], v[132:135], v[100:103], v[16:31]
    v_and_b32 v82, 15, v82
    v_lshlrev_b32 v82, 4, v82
    v_add3_u32 v72, v82, v83, v84
    s_mul_i32 s3, s33, 6144
    v_mul_u32_u24 v82, 40960, v78
    v_add3_u32 v76, v72, v82, s3
    v_mfma_f32_32x32x16_bf16 v[32:47], v[136:139], v[100:103], v[32:47]
    v_mul_u32_u24 v82, 24576, v78
    v_add_u32 v72, v72, v82
    s_lshl_b32 s3, s32, 4
    s_lshl_b32 s76, s33, 1
    s_add_u32 s3, s3, s76
    s_mul_i32 s3, s3, 3072
    v_mfma_f32_32x32x16_bf16 v[48:63], v[140:143], v[100:103], v[48:63]
    s_mul_i32 s79, s58, 196608
    s_add_u32 s79, s79, s3
    s_add_u32 s79, s79, 0
    s_branch L_merge
L_typeA:
    s_waitcnt vmcnt(0)
    s_barrier
    s_setprio 3
    ds_read_b128 v[112:115], v144 offset:0
    ds_read_b128 v[116:119], v145 offset:0
    ds_read_b128 v[120:123], v146 offset:0
    ds_read_b128 v[124:127], v147 offset:0
    ds_read_b128 v[128:131], v148 offset:0
    ds_read_b128 v[132:135], v149 offset:0
    ds_read_b128 v[136:139], v150 offset:0
    ds_read_b128 v[140:143], v151 offset:0
    s_bfe_u32 s76, s7, 262148
    s_lshl_b32 s76, s76, 13
    s_add_u32 s76, s76, s47
    s_mul_i32 s77, s33, 40960
    s_add_u32 m0, s77, 32768
    s_waitcnt lgkmcnt(7)
    v_mfma_f32_32x32x16_bf16 v[96:111], v[112:115], v[64:67], 0
    buffer_load_dwordx4 v164, s[20:23], s76 offen offset:0 lds
    s_waitcnt lgkmcnt(6)
    v_mfma_f32_32x32x16_bf16 v[96:111], v[116:119], v[68:71], v[96:111]
    ds_read_b64_tr_b16 v[112:113], v152 offset:0
    ds_read_b64_tr_b16 v[114:115], v152 offset:2048
    buffer_load_dwordx4 v164, s[20:23], s76 offen offset:1024 lds
    s_waitcnt lgkmcnt(7)
    v_mfma_f32_32x32x16_bf16 v[96:111], v[120:123], v[72:75], v[96:111]
    ds_read_b64_tr_b16 v[116:117], v153 offset:0
    ds_read_b64_tr_b16 v[118:119], v153 offset:2048
    buffer_load_dwordx4 v164, s[20:23], s76 offen offset:2048 lds
    s_waitcnt lgkmcnt(8)
    v_mfma_f32_32x32x16_bf16 v[96:111], v[124:127], v[76:79], v[96:111]
    ds_read_b64_tr_b16 v[120:121], v154 offset:0
    ds_read_b64_tr_b16 v[122:123], v154 offset:2048
    buffer_load_dwordx4 v164, s[20:23], s76 offen offset:3072 lds
    s_waitcnt lgkmcnt(9)
    v_mfma_f32_32x32x16_bf16 v[96:111], v[128:131], v[80:83], v[96:111]
    ds_read_b64_tr_b16 v[124:125], v155 offset:0
    ds_read_b64_tr_b16 v[126:127], v155 offset:2048
    s_add_u32 m0, s77, 36864
    s_add_u32 s76, s76, 4096
    buffer_load_dwordx4 v164, s[20:23], s76 offen offset:0 lds
    s_waitcnt lgkmcnt(10)
    v_mfma_f32_32x32x16_bf16 v[96:111], v[132:135], v[84:87], v[96:111]
    ds_read_b64_tr_b16 v[128:129], v152 offset:4096
    ds_read_b64_tr_b16 v[130:131], v152 offset:6144
    buffer_load_dwordx4 v164, s[20:23], s76 offen offset:1024 lds
    s_waitcnt lgkmcnt(11)
    v_mfma_f32_32x32x16_bf16 v[96:111], v[136:139], v[88:91], v[96:111]
    ds_read_b64_tr_b16 v[132:133], v153 offset:4096
    ds_read_b64_tr_b16 v[134:135], v153 offset:6144
    buffer_load_dwordx4 v164, s[20:23], s76 offen offset:2048 lds
    s_waitcnt lgkmcnt(12)
    v_mfma_f32_32x32x16_bf16 v[96:111], v[140:143], v[92:95], v[96:111]
    ds_read_b64_tr_b16 v[136:137], v154 offset:4096
    ds_read_b64_tr_b16 v[138:139], v154 offset:6144
    buffer_load_dwordx4 v164, s[20:23], s76 offen offset:3072 lds
    ds_read_b64_tr_b16 v[140:141], v155 offset:4096
    ds_read_b64_tr_b16 v[142:143], v155 offset:6144
    s_setprio 3
    s_nop 5
    v_max3_f32 v160, v96, v97, v98
    v_max3_f32 v161, v99, v100, v101
    v_max3_f32 v160, v160, v102, v103
    v_max3_f32 v161, v161, v104, v105
    v_max3_f32 v160, v160, v106, v107
    v_max3_f32 v161, v161, v108, v109
    v_max3_f32 v160, v160, v110, v111
    v_max_f32 v160, v160, v161
    v_cmp_gt_f32 vcc, v160, v159
    v_cmp_gt_f32 s[52:53], s36, v160
    s_nop 0
    s_or_b64 vcc, vcc, s[52:53]
    s_or_b64 s[52:53], vcc, s[50:51]
    s_cbranch_scc0 L_A0
    s_call_b64 s[38:39], L_slow_first
L_A0:
    v_exp_f32 v96, v96
    v_exp_f32 v97, v97
    v_exp_f32 v98, v98
    v_exp_f32 v99, v99
    v_exp_f32 v100, v100
    v_exp_f32 v101, v101
    v_exp_f32 v102, v102
    v_exp_f32 v103, v103
    v_add_f32 v157, v157, v96
    v_add_f32 v157, v157, v97
    v_add_f32 v157, v157, v98
    v_add_f32 v157, v157, v99
    v_add_f32 v157, v157, v100
    v_add_f32 v157, v157, v101
    v_add_f32 v157, v157, v102
    v_add_f32 v157, v157, v103
    v_cvt_pk_bf16_f32 v96, v96, v97
    v_cvt_pk_bf16_f32 v97, v98, v99
    v_cvt_pk_bf16_f32 v98, v100, v101
    v_cvt_pk_bf16_f32 v99, v102, v103
    v_exp_f32 v104, v104
    v_exp_f32 v105, v105
    v_exp_f32 v106, v106
    v_exp_f32 v107, v107
    v_exp_f32 v108, v108
    v_exp_f32 v109, v109
    v_exp_f32 v110, v110
    v_exp_f32 v111, v111
    v_add_f32 v157, v157, v104
    v_add_f32 v157, v157, v105
    v_add_f32 v157, v157, v106
    v_add_f32 v157, v157, v107
    v_add_f32 v157, v157, v108
    v_add_f32 v157, v157, v109
    v_add_f32 v157, v157, v110
    v_add_f32 v157, v157, v111
    v_cvt_pk_bf16_f32 v100, v104, v105
    v_cvt_pk_bf16_f32 v101, v106, v107
    v_cvt_pk_bf16_f32 v102, v108, v109
    v_cvt_pk_bf16_f32 v103, v110, v111
    s_setprio 0
    s_waitcnt lgkmcnt(14)
    v_mfma_f32_32x32x16_bf16 v[0:15], v[112:115], v[96:99], v[0:15]
    s_waitcnt lgkmcnt(12)
    v_mfma_f32_32x32x16_bf16 v[16:31], v[116:119], v[96:99], v[16:31]
    s_waitcnt lgkmcnt(10)
    v_mfma_f32_32x32x16_bf16 v[32:47], v[120:123], v[96:99], v[32:47]
    s_waitcnt lgkmcnt(8)
    v_mfma_f32_32x32x16_bf16 v[48:63], v[124:127], v[96:99], v[48:63]
    s_waitcnt lgkmcnt(6)
    v_mfma_f32_32x32x16_bf16 v[0:15], v[128:131], v[100:103], v[0:15]
    s_waitcnt lgkmcnt(4)
    v_mfma_f32_32x32x16_bf16 v[16:31], v[132:135], v[100:103], v[16:31]
    s_waitcnt lgkmcnt(2)
    v_mfma_f32_32x32x16_bf16 v[32:47], v[136:139], v[100:103], v[32:47]
    s_waitcnt lgkmcnt(0)
    v_mfma_f32_32x32x16_bf16 v[48:63], v[140:143], v[100:103], v[48:63]
    s_waitcnt vmcnt(0)
    s_barrier
    s_setprio 3
    ds_read_b128 v[112:115], v144 offset:8192
    ds_read_b128 v[116:119], v145 offset:8192
    ds_read_b128 v[120:123], v146 offset:8192
    ds_read_b128 v[124:127], v147 offset:8192
    ds_read_b128 v[128:131], v148 offset:8192
    ds_read_b128 v[132:135], v149 offset:8192
    ds_read_b128 v[136:139], v150 offset:8192
    ds_read_b128 v[140:143], v151 offset:8192
    s_bfe_u32 s76, s7, 262152
    s_lshl_b32 s76, s76, 13
    s_add_u32 s76, s76, s47
    s_mul_i32 s77, s33, 40960
    s_add_u32 m0, s77, 24576
    s_waitcnt lgkmcnt(7)
    v_mfma_f32_32x32x16_bf16 v[96:111], v[112:115], v[64:67], 0
    buffer_load_dwordx4 v164, s[20:23], s76 offen offset:0 lds
    s_waitcnt lgkmcnt(6)
    v_mfma_f32_32x32x16_bf16 v[96:111], v[116:119], v[68:71], v[96:111]
    ds_read_b64_tr_b16 v[112:113], v152 offset:8192
    ds_read_b64_tr_b16 v[114:115], v152 offset:10240
    buffer_load_dwordx4 v164, s[20:23], s76 offen offset:1024 lds
    s_waitcnt lgkmcnt(7)
    v_mfma_f32_32x32x16_bf16 v[96:111], v[120:123], v[72:75], v[96:111]
    ds_read_b64_tr_b16 v[116:117], v153 offset:8192
    ds_read_b64_tr_b16 v[118:119], v153 offset:10240
    buffer_load_dwordx4 v164, s[20:23], s76 offen offset:2048 lds
    s_waitcnt lgkmcnt(8)
    v_mfma_f32_32x32x16_bf16 v[96:111], v[124:127], v[76:79], v[96:111]
    ds_read_b64_tr_b16 v[120:121], v154 offset:8192
    ds_read_b64_tr_b16 v[122:123], v154 offset:10240
    buffer_load_dwordx4 v164, s[20:23], s76 offen offset:3072 lds
    s_waitcnt lgkmcnt(9)
    v_mfma_f32_32x32x16_bf16 v[96:111], v[128:131], v[80:83], v[96:111]
    ds_read_b64_tr_b16 v[124:125], v155 offset:8192
    ds_read_b64_tr_b16 v[126:127], v155 offset:10240
    s_add_u32 m0, s77, 28672
    s_add_u32 s76, s76, 4096
    buffer_load_dwordx4 v164, s[20:23], s76 offen offset:0 lds
    s_waitcnt lgkmcnt(10)
    v_mfma_f32_32x32x16_bf16 v[96:111], v[132:135], v[84:87], v[96:111]
    ds_read_b64_tr_b16 v[128:129], v152 offset:12288
    ds_read_b64_tr_b16 v[130:131], v152 offset:14336
    buffer_load_dwordx4 v164, s[20:23], s76 offen offset:1024 lds
    s_waitcnt lgkmcnt(11)
    v_mfma_f32_32x32x16_bf16 v[96:111], v[136:139], v[88:91], v[96:111]
    ds_read_b64_tr_b16 v[132:133], v153 offset:12288
    ds_read_b64_tr_b16 v[134:135], v153 offset:14336
    buffer_load_dwordx4 v164, s[20:23], s76 offen offset:2048 lds
    s_waitcnt lgkmcnt(12)
    v_mfma_f32_32x32x16_bf16 v[96:111], v[140:143], v[92:95], v[96:111]
    ds_read_b64_tr_b16 v[136:137], v154 offset:12288
    ds_read_b64_tr_b16 v[138:139], v154 offset:14336
    buffer_load_dwordx4 v164, s[20:23], s76 offen offset:3072 lds
    ds_read_b64_tr_b16 v[140:141], v155 offset:12288
    ds_read_b64_tr_b16 v[142:143], v155 offset:14336
    s_setprio 3
    s_nop 5
    v_max3_f32 v160, v96, v97, v98
    v_max3_f32 v161, v99, v100, v101
    v_max3_f32 v160, v160, v102, v103
    v_max3_f32 v161, v161, v104, v105
    v_max3_f32 v160, v160, v106, v107
    v_max3_f32 v161, v161, v108, v109
    v_max3_f32 v160, v160, v110, v111
    v_max_f32 v160, v160, v161
    v_cmp_gt_f32 vcc, v160, v159
    s_nop 0
    s_or_b64 s[52:53], vcc, s[50:51]
    s_cbranch_scc0 L_A1
    s_call_b64 s[38:39], L_slow
L_A1:
    v_exp_f32 v96, v96
    v_exp_f32 v97, v97
    v_exp_f32 v98, v98
    v_exp_f32 v99, v99
    v_exp_f32 v100, v100
    v_exp_f32 v101, v101
    v_exp_f32 v102, v102
    v_exp_f32 v103, v103
    v_add_f32 v157, v157, v96
    v_add_f32 v157, v157, v97
    v_add_f32 v157, v157, v98
    v_add_f32 v157, v157, v99
    v_add_f32 v157, v157, v100
    v_add_f32 v157, v157, v101
    v_add_f32 v157, v157, v102
    v_add_f32 v157, v157, v103
    v_cvt_pk_bf16_f32 v96, v96, v97
    v_cvt_pk_bf16_f32 v97, v98, v99
    v_cvt_pk_bf16_f32 v98, v100, v101
    v_cvt_pk_bf16_f32 v99, v102, v103
    v_exp_f32 v104, v104
    v_exp_f32 v105, v105
    v_exp_f32 v106, v106
    v_exp_f32 v107, v107
    v_exp_f32 v108, v108
    v_exp_f32 v109, v109
    v_exp_f32 v110, v110
    v_exp_f32 v111, v111
    v_add_f32 v157, v157, v104
    v_add_f32 v157, v157, v105
    v_add_f32 v157, v157, v106
    v_add_f32 v157, v157, v107
    v_add_f32 v157, v157, v108
    v_add_f32 v157, v157, v109
    v_add_f32 v157, v157, v110
    v_add_f32 v157, v157, v111
    v_cvt_pk_bf16_f32 v100, v104, v105
    v_cvt_pk_bf16_f32 v101, v106, v107
    v_cvt_pk_bf16_f32 v102, v108, v109
    v_cvt_pk_bf16_f32 v103, v110, v111
    s_setprio 0
    s_waitcnt lgkmcnt(14)
    v_mfma_f32_32x32x16_bf16 v[0:15], v[112:115], v[96:99], v[0:15]
    s_waitcnt lgkmcnt(12)
    v_mfma_f32_32x32x16_bf16 v[16:31], v[116:119], v[96:99], v[16:31]
    s_waitcnt lgkmcnt(10)
    v_mfma_f32_32x32x16_bf16 v[32:47], v[120:123], v[96:99], v[32:47]
    s_waitcnt lgkmcnt(8)
    v_mfma_f32_32x32x16_bf16 v[48:63], v[124:127], v[96:99], v[48:63]
    s_waitcnt lgkmcnt(6)
    v_mfma_f32_32x32x16_bf16 v[0:15], v[128:131], v[100:103], v[0:15]
    s_waitcnt lgkmcnt(4)
    v_mfma_f32_32x32x16_bf16 v[16:31], v[132:135], v[100:103], v[16:31]
    s_waitcnt lgkmcnt(2)
    v_mfma_f32_32x32x16_bf16 v[32:47], v[136:139], v[100:103], v[32:47]
    s_waitcnt lgkmcnt(0)
    v_mfma_f32_32x32x16_bf16 v[48:63], v[140:143], v[100:103], v[48:63]
    s_waitcnt vmcnt(0)
    s_barrier
    s_setprio 3
    ds_read_b128 v[112:115], v144 offset:16384
    ds_read_b128 v[116:119], v145 offset:16384
    ds_read_b128 v[120:123], v146 offset:16384
    ds_read_b128 v[124:127], v147 offset:16384
    ds_read_b128 v[128:131], v148 offset:16384
    ds_read_b128 v[132:135], v149 offset:16384
    ds_read_b128 v[136:139], v150 offset:16384
    ds_read_b128 v[140:143], v151 offset:16384
    s_bfe_u32 s76, s7, 262156
    s_lshl_b32 s76, s76, 13
    s_add_u32 s76, s76, s47
    s_mul_i32 s77, s33, 40960
    s_add_u32 m0, s77, 32768
    s_waitcnt lgkmcnt(7)
    v_mfma_f32_32x32x16_bf16 v[96:111], v[112:115], v[64:67], 0
    buffer_load_dwordx4 v164, s[20:23], s76 offen offset:0 lds
    s_waitcnt lgkmcnt(6)
    v_mfma_f32_32x32x16_bf16 v[96:111], v[116:119], v[68:71], v[96:111]
    ds_read_b64_tr_b16 v[112:113], v152 offset:0
    ds_read_b64_tr_b16 v[114:115], v152 offset:2048
    buffer_load_dwordx4 v164, s[20:23], s76 offen offset:1024 lds
    s_waitcnt lgkmcnt(7)
    v_mfma_f32_32x32x16_bf16 v[96:111], v[120:123], v[72:75], v[96:111]
    ds_read_b64_tr_b16 v[116:117], v153 offset:0
    ds_read_b64_tr_b16 v[118:119], v153 offset:2048
    buffer_load_dwordx4 v164, s[20:23], s76 offen offset:2048 lds
    s_waitcnt lgkmcnt(8)
    v_mfma_f32_32x32x16_bf16 v[96:111], v[124:127], v[76:79], v[96:111]
    ds_read_b64_tr_b16 v[120:121], v154 offset:0
    ds_read_b64_tr_b16 v[122:123], v154 offset:2048
    buffer_load_dwordx4 v164, s[20:23], s76 offen offset:3072 lds
    s_waitcnt lgkmcnt(9)
    v_mfma_f32_32x32x16_bf16 v[96:111], v[128:131], v[80:83], v[96:111]
    ds_read_b64_tr_b16 v[124:125], v155 offset:0
    ds_read_b64_tr_b16 v[126:127], v155 offset:2048
    s_add_u32 m0, s77, 36864
    s_add_u32 s76, s76, 4096
    buffer_load_dwordx4 v164, s[20:23], s76 offen offset:0 lds
    s_waitcnt lgkmcnt(10)
    v_mfma_f32_32x32x16_bf16 v[96:111], v[132:135], v[84:87], v[96:111]
    ds_read_b64_tr_b16 v[128:129], v152 offset:4096
    ds_read_b64_tr_b16 v[130:131], v152 offset:6144
    buffer_load_dwordx4 v164, s[20:23], s76 offen offset:1024 lds
    s_waitcnt lgkmcnt(11)
    v_mfma_f32_32x32x16_bf16 v[96:111], v[136:139], v[88:91], v[96:111]
    ds_read_b64_tr_b16 v[132:133], v153 offset:4096
    ds_read_b64_tr_b16 v[134:135], v153 offset:6144
    buffer_load_dwordx4 v164, s[20:23], s76 offen offset:2048 lds
    s_waitcnt lgkmcnt(12)
    v_mfma_f32_32x32x16_bf16 v[96:111], v[140:143], v[92:95], v[96:111]
    ds_read_b64_tr_b16 v[136:137], v154 offset:4096
    ds_read_b64_tr_b16 v[138:139], v154 offset:6144
    buffer_load_dwordx4 v164, s[20:23], s76 offen offset:3072 lds
    ds_read_b64_tr_b16 v[140:141], v155 offset:4096
    ds_read_b64_tr_b16 v[142:143], v155 offset:6144
    s_setprio 3
    s_nop 5
    v_max3_f32 v160, v96, v97, v98
    v_max3_f32 v161, v99, v100, v101
    v_max3_f32 v160, v160, v102, v103
    v_max3_f32 v161, v161, v104, v105
    v_max3_f32 v160, v160, v106, v107
    v_max3_f32 v161, v161, v108, v109
    v_max3_f32 v160, v160, v110, v111
    v_max_f32 v160, v160, v161
    v_cmp_gt_f32 vcc, v160, v159
    s_nop 0
    s_or_b64 s[52:53], vcc, s[50:51]
    s_cbranch_scc0 L_A2
    s_call_b64 s[38:39], L_slow
L_A2:
    v_exp_f32 v96, v96
    v_exp_f32 v97, v97
    v_exp_f32 v98, v98
    v_exp_f32 v99, v99
    v_exp_f32 v100, v100
    v_exp_f32 v101, v101
    v_exp_f32 v102, v102
    v_exp_f32 v103, v103
    v_add_f32 v157, v157, v96
    v_add_f32 v157, v157, v97
    v_add_f32 v157, v157, v98
    v_add_f32 v157, v157, v99
    v_add_f32 v157, v157, v100
    v_add_f32 v157, v157, v101
    v_add_f32 v157, v157, v102
    v_add_f32 v157, v157, v103
    v_cvt_pk_bf16_f32 v96, v96, v97
    v_cvt_pk_bf16_f32 v97, v98, v99
    v_cvt_pk_bf16_f32 v98, v100, v101
    v_cvt_pk_bf16_f32 v99, v102, v103
    v_exp_f32 v104, v104
    v_exp_f32 v105, v105
    v_exp_f32 v106, v106
    v_exp_f32 v107, v107
    v_exp_f32 v108, v108
    v_exp_f32 v109, v109
    v_exp_f32 v110, v110
    v_exp_f32 v111, v111
    v_add_f32 v157, v157, v104
    v_add_f32 v157, v157, v105
    v_add_f32 v157, v157, v106
    v_add_f32 v157, v157, v107
    v_add_f32 v157, v157, v108
    v_add_f32 v157, v157, v109
    v_add_f32 v157, v157, v110
    v_add_f32 v157, v157, v111
    v_cvt_pk_bf16_f32 v100, v104, v105
    v_cvt_pk_bf16_f32 v101, v106, v107
    v_cvt_pk_bf16_f32 v102, v108, v109
    v_cvt_pk_bf16_f32 v103, v110, v111
    s_setprio 0
    s_waitcnt lgkmcnt(14)
    v_mfma_f32_32x32x16_bf16 v[0:15], v[112:115], v[96:99], v[0:15]
    s_waitcnt lgkmcnt(12)
    v_mfma_f32_32x32x16_bf16 v[16:31], v[116:119], v[96:99], v[16:31]
    s_waitcnt lgkmcnt(10)
    v_mfma_f32_32x32x16_bf16 v[32:47], v[120:123], v[96:99], v[32:47]
    s_waitcnt lgkmcnt(8)
    v_mfma_f32_32x32x16_bf16 v[48:63], v[124:127], v[96:99], v[48:63]
    s_waitcnt lgkmcnt(6)
    v_mfma_f32_32x32x16_bf16 v[0:15], v[128:131], v[100:103], v[0:15]
    s_waitcnt lgkmcnt(4)
    v_mfma_f32_32x32x16_bf16 v[16:31], v[132:135], v[100:103], v[16:31]
    s_waitcnt lgkmcnt(2)
    v_mfma_f32_32x32x16_bf16 v[32:47], v[136:139], v[100:103], v[32:47]
    s_waitcnt lgkmcnt(0)
    v_mfma_f32_32x32x16_bf16 v[48:63], v[140:143], v[100:103], v[48:63]
    s_waitcnt vmcnt(0)
    s_barrier
    s_setprio 3
    ds_read_b128 v[112:115], v144 offset:0
    ds_read_b128 v[116:119], v145 offset:0
    ds_read_b128 v[120:123], v146 offset:0
    ds_read_b128 v[124:127], v147 offset:0
    ds_read_b128 v[128:131], v148 offset:0
    ds_read_b128 v[132:135], v149 offset:0
    ds_read_b128 v[136:139], v150 offset:0
    ds_read_b128 v[140:143], v151 offset:0
    s_bfe_u32 s76, s7, 262160
    s_lshl_b32 s76, s76, 13
    s_add_u32 s76, s76, s47
    s_mul_i32 s77, s33, 40960
    s_add_u32 m0, s77, 24576
    s_waitcnt lgkmcnt(7)
    v_mfma_f32_32x32x16_bf16 v[96:111], v[112:115], v[64:67], 0
    buffer_load_dwordx4 v164, s[20:23], s76 offen offset:0 lds
    s_waitcnt lgkmcnt(6)
    v_mfma_f32_32x32x16_bf16 v[96:111], v[116:119], v[68:71], v[96:111]
    ds_read_b64_tr_b16 v[112:113], v152 offset:8192
    ds_read_b64_tr_b16 v[114:115], v152 offset:10240
    buffer_load_dwordx4 v164, s[20:23], s76 offen offset:1024 lds
    s_waitcnt lgkmcnt(7)
    v_mfma_f32_32x32x16_bf16 v[96:111], v[120:123], v[72:75], v[96:111]
    ds_read_b64_tr_b16 v[116:117], v153 offset:8192
    ds_read_b64_tr_b16 v[118:119], v153 offset:10240
    buffer_load_dwordx4 v164, s[20:23], s76 offen offset:2048 lds
    s_waitcnt lgkmcnt(8)
    v_mfma_f32_32x32x16_bf16 v[96:111], v[124:127], v[76:79], v[96:111]
    ds_read_b64_tr_b16 v[120:121], v154 offset:8192
    ds_read_b64_tr_b16 v[122:123], v154 offset:10240
    buffer_load_dwordx4 v164, s[20:23], s76 offen offset:3072 lds
    s_waitcnt lgkmcnt(9)
    v_mfma_f32_32x32x16_bf16 v[96:111], v[128:131], v[80:83], v[96:111]
    ds_read_b64_tr_b16 v[124:125], v155 offset:8192
    ds_read_b64_tr_b16 v[126:127], v155 offset:10240
    s_add_u32 m0, s77, 28672
    s_add_u32 s76, s76, 4096
    buffer_load_dwordx4 v164, s[20:23], s76 offen offset:0 lds
    s_waitcnt lgkmcnt(10)
    v_mfma_f32_32x32x16_bf16 v[96:111], v[132:135], v[84:87], v[96:111]
    ds_read_b64_tr_b16 v[128:129], v152 offset:12288
    ds_read_b64_tr_b16 v[130:131], v152 offset:14336
    buffer_load_dwordx4 v164, s[20:23], s76 offen offset:1024 lds
    s_waitcnt lgkmcnt(11)
    v_mfma_f32_32x32x16_bf16 v[96:111], v[136:139], v[88:91], v[96:111]
    ds_read_b64_tr_b16 v[132:133], v153 offset:12288
    ds_read_b64_tr_b16 v[134:135], v153 offset:14336
    buffer_load_dwordx4 v164, s[20:23], s76 offen offset:2048 lds
    s_waitcnt lgkmcnt(12)
    v_mfma_f32_32x32x16_bf16 v[96:111], v[140:143], v[92:95], v[96:111]
    ds_read_b64_tr_b16 v[136:137], v154 offset:12288
    ds_read_b64_tr_b16 v[138:139], v154 offset:14336
    buffer_load_dwordx4 v164, s[20:23], s76 offen offset:3072 lds
    ds_read_b64_tr_b16 v[140:141], v155 offset:12288
    ds_read_b64_tr_b16 v[142:143], v155 offset:14336
    s_setprio 3
    s_nop 5
    v_max3_f32 v160, v96, v97, v98
    v_max3_f32 v161, v99, v100, v101
    v_max3_f32 v160, v160, v102, v103
    v_max3_f32 v161, v161, v104, v105
    v_max3_f32 v160, v160, v106, v107
    v_max3_f32 v161, v161, v108, v109
    v_max3_f32 v160, v160, v110, v111
    v_max_f32 v160, v160, v161
    v_cmp_gt_f32 vcc, v160, v159
    s_nop 0
    s_or_b64 s[52:53], vcc, s[50:51]
    s_cbranch_scc0 L_A3
    s_call_b64 s[38:39], L_slow
L_A3:
    v_exp_f32 v96, v96
    v_exp_f32 v97, v97
    v_exp_f32 v98, v98
    v_exp_f32 v99, v99
    v_exp_f32 v100, v100
    v_exp_f32 v101, v101
    v_exp_f32 v102, v102
    v_exp_f32 v103, v103
    v_add_f32 v157, v157, v96
    v_add_f32 v157, v157, v97
    v_add_f32 v157, v157, v98
    v_add_f32 v157, v157, v99
    v_add_f32 v157, v157, v100
    v_add_f32 v157, v157, v101
    v_add_f32 v157, v157, v102
    v_add_f32 v157, v157, v103
    v_cvt_pk_bf16_f32 v96, v96, v97
    v_cvt_pk_bf16_f32 v97, v98, v99
    v_cvt_pk_bf16_f32 v98, v100, v101
    v_cvt_pk_bf16_f32 v99, v102, v103
    v_exp_f32 v104, v104
    v_exp_f32 v105, v105
    v_exp_f32 v106, v106
    v_exp_f32 v107, v107
    v_exp_f32 v108, v108
    v_exp_f32 v109, v109
    v_exp_f32 v110, v110
    v_exp_f32 v111, v111
    v_add_f32 v157, v157, v104
    v_add_f32 v157, v157, v105
    v_add_f32 v157, v157, v106
    v_add_f32 v157, v157, v107
    v_add_f32 v157, v157, v108
    v_add_f32 v157, v157, v109
    v_add_f32 v157, v157, v110
    v_add_f32 v157, v157, v111
    v_cvt_pk_bf16_f32 v100, v104, v105
    v_cvt_pk_bf16_f32 v101, v106, v107
    v_cvt_pk_bf16_f32 v102, v108, v109
    v_cvt_pk_bf16_f32 v103, v110, v111
    s_setprio 0
    s_waitcnt lgkmcnt(14)
    v_mfma_f32_32x32x16_bf16 v[0:15], v[112:115], v[96:99], v[0:15]
    s_waitcnt lgkmcnt(12)
    v_mfma_f32_32x32x16_bf16 v[16:31], v[116:119], v[96:99], v[16:31]
    s_waitcnt lgkmcnt(10)
    v_mfma_f32_32x32x16_bf16 v[32:47], v[120:123], v[96:99], v[32:47]
    s_waitcnt lgkmcnt(8)
    v_mfma_f32_32x32x16_bf16 v[48:63], v[124:127], v[96:99], v[48:63]
    s_waitcnt lgkmcnt(6)
    v_mfma_f32_32x32x16_bf16 v[0:15], v[128:131], v[100:103], v[0:15]
    s_waitcnt lgkmcnt(4)
    v_mfma_f32_32x32x16_bf16 v[16:31], v[132:135], v[100:103], v[16:31]
    s_waitcnt lgkmcnt(2)
    v_mfma_f32_32x32x16_bf16 v[32:47], v[136:139], v[100:103], v[32:47]
    s_waitcnt lgkmcnt(0)
    v_mfma_f32_32x32x16_bf16 v[48:63], v[140:143], v[100:103], v[48:63]
    s_waitcnt vmcnt(0)
    s_barrier
    s_setprio 3
    ds_read_b128 v[112:115], v144 offset:8192
    ds_read_b128 v[116:119], v145 offset:8192
    ds_read_b128 v[120:123], v146 offset:8192
    ds_read_b128 v[124:127], v147 offset:8192
    ds_read_b128 v[128:131], v148 offset:8192
    ds_read_b128 v[132:135], v149 offset:8192
    ds_read_b128 v[136:139], v150 offset:8192
    ds_read_b128 v[140:143], v151 offset:8192
    s_bfe_u32 s76, s7, 262164
    s_lshl_b32 s76, s76, 13
    s_add_u32 s76, s76, s47
    s_mul_i32 s77, s33, 40960
    s_add_u32 m0, s77, 32768
    s_waitcnt lgkmcnt(7)
    v_mfma_f32_32x32x16_bf16 v[96:111], v[112:115], v[64:67], 0
    buffer_load_dwordx4 v164, s[20:23], s76 offen offset:0 lds
    s_waitcnt lgkmcnt(6)
    v_mfma_f32_32x32x16_bf16 v[96:111], v[116:119], v[68:71], v[96:111]
    ds_read_b64_tr_b16 v[112:113], v152 offset:0
    ds_read_b64_tr_b16 v[114:115], v152 offset:2048
    buffer_load_dwordx4 v164, s[20:23], s76 offen offset:1024 lds
    s_waitcnt lgkmcnt(7)
    v_mfma_f32_32x32x16_bf16 v[96:111], v[120:123], v[72:75], v[96:111]
    ds_read_b64_tr_b16 v[116:117], v153 offset:0
    ds_read_b64_tr_b16 v[118:119], v153 offset:2048
    buffer_load_dwordx4 v164, s[20:23], s76 offen offset:2048 lds
    s_waitcnt lgkmcnt(8)
    v_mfma_f32_32x32x16_bf16 v[96:111], v[124:127], v[76:79], v[96:111]
    ds_read_b64_tr_b16 v[120:121], v154 offset:0
    ds_read_b64_tr_b16 v[122:123], v154 offset:2048
    buffer_load_dwordx4 v164, s[20:23], s76 offen offset:3072 lds
    s_waitcnt lgkmcnt(9)
    v_mfma_f32_32x32x16_bf16 v[96:111], v[128:131], v[80:83], v[96:111]
    ds_read_b64_tr_b16 v[124:125], v155 offset:0
    ds_read_b64_tr_b16 v[126:127], v155 offset:2048
    s_add_u32 m0, s77, 36864
    s_add_u32 s76, s76, 4096
    buffer_load_dwordx4 v164, s[20:23], s76 offen offset:0 lds
    s_waitcnt lgkmcnt(10)
    v_mfma_f32_32x32x16_bf16 v[96:111], v[132:135], v[84:87], v[96:111]
    ds_read_b64_tr_b16 v[128:129], v152 offset:4096
    ds_read_b64_tr_b16 v[130:131], v152 offset:6144
    buffer_load_dwordx4 v164, s[20:23], s76 offen offset:1024 lds
    s_waitcnt lgkmcnt(11)
    v_mfma_f32_32x32x16_bf16 v[96:111], v[136:139], v[88:91], v[96:111]
    ds_read_b64_tr_b16 v[132:133], v153 offset:4096
    ds_read_b64_tr_b16 v[134:135], v153 offset:6144
    buffer_load_dwordx4 v164, s[20:23], s76 offen offset:2048 lds
    s_waitcnt lgkmcnt(12)
    v_mfma_f32_32x32x16_bf16 v[96:111], v[140:143], v[92:95], v[96:111]
    ds_read_b64_tr_b16 v[136:137], v154 offset:4096
    ds_read_b64_tr_b16 v[138:139], v154 offset:6144
    buffer_load_dwordx4 v164, s[20:23], s76 offen offset:3072 lds
    ds_read_b64_tr_b16 v[140:141], v155 offset:4096
    ds_read_b64_tr_b16 v[142:143], v155 offset:6144
    s_setprio 3
    s_nop 5
    v_max3_f32 v160, v96, v97, v98
    v_max3_f32 v161, v99, v100, v101
    v_max3_f32 v160, v160, v102, v103
    v_max3_f32 v161, v161, v104, v105
    v_max3_f32 v160, v160, v106, v107
    v_max3_f32 v161, v161, v108, v109
    v_max3_f32 v160, v160, v110, v111
    v_max_f32 v160, v160, v161
    v_cmp_gt_f32 vcc, v160, v159
    s_nop 0
    s_or_b64 s[52:53], vcc, s[50:51]
    s_cbranch_scc0 L_A4
    s_call_b64 s[38:39], L_slow
L_A4:
    v_exp_f32 v96, v96
    v_exp_f32 v97, v97
    v_exp_f32 v98, v98
    v_exp_f32 v99, v99
    v_exp_f32 v100, v100
    v_exp_f32 v101, v101
    v_exp_f32 v102, v102
    v_exp_f32 v103, v103
    v_add_f32 v157, v157, v96
    v_add_f32 v157, v157, v97
    v_add_f32 v157, v157, v98
    v_add_f32 v157, v157, v99
    v_add_f32 v157, v157, v100
    v_add_f32 v157, v157, v101
    v_add_f32 v157, v157, v102
    v_add_f32 v157, v157, v103
    v_cvt_pk_bf16_f32 v96, v96, v97
    v_cvt_pk_bf16_f32 v97, v98, v99
    v_cvt_pk_bf16_f32 v98, v100, v101
    v_cvt_pk_bf16_f32 v99, v102, v103
    v_exp_f32 v104, v104
    v_exp_f32 v105, v105
    v_exp_f32 v106, v106
    v_exp_f32 v107, v107
    v_exp_f32 v108, v108
    v_exp_f32 v109, v109
    v_exp_f32 v110, v110
    v_exp_f32 v111, v111
    v_add_f32 v157, v157, v104
    v_add_f32 v157, v157, v105
    v_add_f32 v157, v157, v106
    v_add_f32 v157, v157, v107
    v_add_f32 v157, v157, v108
    v_add_f32 v157, v157, v109
    v_add_f32 v157, v157, v110
    v_add_f32 v157, v157, v111
    v_cvt_pk_bf16_f32 v100, v104, v105
    v_cvt_pk_bf16_f32 v101, v106, v107
    v_cvt_pk_bf16_f32 v102, v108, v109
    v_cvt_pk_bf16_f32 v103, v110, v111
    s_setprio 0
    s_waitcnt lgkmcnt(14)
    v_mfma_f32_32x32x16_bf16 v[0:15], v[112:115], v[96:99], v[0:15]
    s_waitcnt lgkmcnt(12)
    v_mfma_f32_32x32x16_bf16 v[16:31], v[116:119], v[96:99], v[16:31]
    s_waitcnt lgkmcnt(10)
    v_mfma_f32_32x32x16_bf16 v[32:47], v[120:123], v[96:99], v[32:47]
    s_waitcnt lgkmcnt(8)
    v_mfma_f32_32x32x16_bf16 v[48:63], v[124:127], v[96:99], v[48:63]
    s_waitcnt lgkmcnt(6)
    v_mfma_f32_32x32x16_bf16 v[0:15], v[128:131], v[100:103], v[0:15]
    s_waitcnt lgkmcnt(4)
    v_mfma_f32_32x32x16_bf16 v[16:31], v[132:135], v[100:103], v[16:31]
    s_waitcnt lgkmcnt(2)
    v_mfma_f32_32x32x16_bf16 v[32:47], v[136:139], v[100:103], v[32:47]
    s_waitcnt lgkmcnt(0)
    v_mfma_f32_32x32x16_bf16 v[48:63], v[140:143], v[100:103], v[48:63]
    s_waitcnt vmcnt(0)
    s_barrier
    s_setprio 3
    ds_read_b128 v[112:115], v144 offset:16384
    ds_read_b128 v[116:119], v145 offset:16384
    ds_read_b128 v[120:123], v146 offset:16384
    ds_read_b128 v[124:127], v147 offset:16384
    ds_read_b128 v[128:131], v148 offset:16384
    ds_read_b128 v[132:135], v149 offset:16384
    ds_read_b128 v[136:139], v150 offset:16384
    ds_read_b128 v[140:143], v151 offset:16384
    s_bfe_u32 s76, s7, 262168
    s_lshl_b32 s76, s76, 13
    s_add_u32 s76, s76, s47
    s_mul_i32 s77, s33, 40960
    s_add_u32 m0, s77, 24576
    s_waitcnt lgkmcnt(7)
    v_mfma_f32_32x32x16_bf16 v[96:111], v[112:115], v[64:67], 0
    buffer_load_dwordx4 v164, s[20:23], s76 offen offset:0 lds
    s_waitcnt lgkmcnt(6)
    v_mfma_f32_32x32x16_bf16 v[96:111], v[116:119], v[68:71], v[96:111]
    ds_read_b64_tr_b16 v[112:113], v152 offset:8192
    ds_read_b64_tr_b16 v[114:115], v152 offset:10240
    buffer_load_dwordx4 v164, s[20:23], s76 offen offset:1024 lds
    s_waitcnt lgkmcnt(7)
    v_mfma_f32_32x32x16_bf16 v[96:111], v[120:123], v[72:75], v[96:111]
    ds_read_b64_tr_b16 v[116:117], v153 offset:8192
    ds_read_b64_tr_b16 v[118:119], v153 offset:10240
    buffer_load_dwordx4 v164, s[20:23], s76 offen offset:2048 lds
    s_waitcnt lgkmcnt(8)
    v_mfma_f32_32x32x16_bf16 v[96:111], v[124:127], v[76:79], v[96:111]
    ds_read_b64_tr_b16 v[120:121], v154 offset:8192
    ds_read_b64_tr_b16 v[122:123], v154 offset:10240
    buffer_load_dwordx4 v164, s[20:23], s76 offen offset:3072 lds
    s_waitcnt lgkmcnt(9)
    v_mfma_f32_32x32x16_bf16 v[96:111], v[128:131], v[80:83], v[96:111]
    ds_read_b64_tr_b16 v[124:125], v155 offset:8192
    ds_read_b64_tr_b16 v[126:127], v155 offset:10240
    s_add_u32 m0, s77, 28672
    s_add_u32 s76, s76, 4096
    buffer_load_dwordx4 v164, s[20:23], s76 offen offset:0 lds
    s_waitcnt lgkmcnt(10)
    v_mfma_f32_32x32x16_bf16 v[96:111], v[132:135], v[84:87], v[96:111]
    ds_read_b64_tr_b16 v[128:129], v152 offset:12288
    ds_read_b64_tr_b16 v[130:131], v152 offset:14336
    buffer_load_dwordx4 v164, s[20:23], s76 offen offset:1024 lds
    s_waitcnt lgkmcnt(11)
    v_mfma_f32_32x32x16_bf16 v[96:111], v[136:139], v[88:91], v[96:111]
    ds_read_b64_tr_b16 v[132:133], v153 offset:12288
    ds_read_b64_tr_b16 v[134:135], v153 offset:14336
    buffer_load_dwordx4 v164, s[20:23], s76 offen offset:2048 lds
    s_waitcnt lgkmcnt(12)
    v_mfma_f32_32x32x16_bf16 v[96:111], v[140:143], v[92:95], v[96:111]
    ds_read_b64_tr_b16 v[136:137], v154 offset:12288
    ds_read_b64_tr_b16 v[138:139], v154 offset:14336
    buffer_load_dwordx4 v164, s[20:23], s76 offen offset:3072 lds
    ds_read_b64_tr_b16 v[140:141], v155 offset:12288
    ds_read_b64_tr_b16 v[142:143], v155 offset:14336
    s_setprio 3
    s_nop 5
    v_max3_f32 v160, v96, v97, v98
    v_max3_f32 v161, v99, v100, v101
    v_max3_f32 v160, v160, v102, v103
    v_max3_f32 v161, v161, v104, v105
    v_max3_f32 v160, v160, v106, v107
    v_max3_f32 v161, v161, v108, v109
    v_max3_f32 v160, v160, v110, v111
    v_max_f32 v160, v160, v161
    v_cmp_gt_f32 vcc, v160, v159
    s_nop 0
    s_or_b64 s[52:53], vcc, s[50:51]
    s_cbranch_scc0 L_A5
    s_call_b64 s[38:39], L_slow
L_A5:
    v_exp_f32 v96, v96
    v_exp_f32 v97, v97
    v_exp_f32 v98, v98
    v_exp_f32 v99, v99
    v_exp_f32 v100, v100
    v_exp_f32 v101, v101
    v_exp_f32 v102, v102
    v_exp_f32 v103, v103
    v_add_f32 v157, v157, v96
    v_add_f32 v157, v157, v97
    v_add_f32 v157, v157, v98
    v_add_f32 v157, v157, v99
    v_add_f32 v157, v157, v100
    v_add_f32 v157, v157, v101
    v_add_f32 v157, v157, v102
    v_add_f32 v157, v157, v103
    v_cvt_pk_bf16_f32 v96, v96, v97
    v_cvt_pk_bf16_f32 v97, v98, v99
    v_cvt_pk_bf16_f32 v98, v100, v101
    v_cvt_pk_bf16_f32 v99, v102, v103
    v_exp_f32 v104, v104
    v_exp_f32 v105, v105
    v_exp_f32 v106, v106
    v_exp_f32 v107, v107
    v_exp_f32 v108, v108
    v_exp_f32 v109, v109
    v_exp_f32 v110, v110
    v_exp_f32 v111, v111
    v_add_f32 v157, v157, v104
    v_add_f32 v157, v157, v105
    v_add_f32 v157, v157, v106
    v_add_f32 v157, v157, v107
    v_add_f32 v157, v157, v108
    v_add_f32 v157, v157, v109
    v_add_f32 v157, v157, v110
    v_add_f32 v157, v157, v111
    v_cvt_pk_bf16_f32 v100, v104, v105
    v_cvt_pk_bf16_f32 v101, v106, v107
    v_cvt_pk_bf16_f32 v102, v108, v109
    v_cvt_pk_bf16_f32 v103, v110, v111
    s_setprio 0
    s_waitcnt lgkmcnt(14)
    v_mfma_f32_32x32x16_bf16 v[0:15], v[112:115], v[96:99], v[0:15]
    s_waitcnt lgkmcnt(12)
    v_mfma_f32_32x32x16_bf16 v[16:31], v[116:119], v[96:99], v[16:31]
    s_waitcnt lgkmcnt(10)
    v_mfma_f32_32x32x16_bf16 v[32:47], v[120:123], v[96:99], v[32:47]
    s_waitcnt lgkmcnt(8)
    v_mfma_f32_32x32x16_bf16 v[48:63], v[124:127], v[96:99], v[48:63]
    s_waitcnt lgkmcnt(6)
    v_mfma_f32_32x32x16_bf16 v[0:15], v[128:131], v[100:103], v[0:15]
    s_waitcnt lgkmcnt(4)
    v_mfma_f32_32x32x16_bf16 v[16:31], v[132:135], v[100:103], v[16:31]
    s_waitcnt lgkmcnt(2)
    v_mfma_f32_32x32x16_bf16 v[32:47], v[136:139], v[100:103], v[32:47]
    s_waitcnt lgkmcnt(0)
    v_mfma_f32_32x32x16_bf16 v[48:63], v[140:143], v[100:103], v[48:63]
    s_waitcnt vmcnt(0)
    s_barrier
    s_setprio 3
    ds_read_b128 v[112:115], v144 offset:0
    ds_read_b128 v[116:119], v145 offset:0
    ds_read_b128 v[120:123], v146 offset:0
    ds_read_b128 v[124:127], v147 offset:0
    ds_read_b128 v[128:131], v148 offset:0
    ds_read_b128 v[132:135], v149 offset:0
    ds_read_b128 v[136:139], v150 offset:0
    ds_read_b128 v[140:143], v151 offset:0
    s_bfe_u32 s76, s7, 262172
    s_lshl_b32 s76, s76, 13
    s_add_u32 s76, s76, s47
    s_mul_i32 s77, s33, 40960
    s_add_u32 m0, s77, 32768
    s_waitcnt lgkmcnt(7)
    v_mfma_f32_32x32x16_bf16 v[96:111], v[112:115], v[64:67], 0
    buffer_load_dwordx4 v164, s[20:23], s76 offen offset:0 lds
    s_waitcnt lgkmcnt(6)
    v_mfma_f32_32x32x16_bf16 v[96:111], v[116:119], v[68:71], v[96:111]
    ds_read_b64_tr_b16 v[112:113], v152 offset:0
    ds_read_b64_tr_b16 v[114:115], v152 offset:2048
    buffer_load_dwordx4 v164, s[20:23], s76 offen offset:1024 lds
    s_waitcnt lgkmcnt(7)
    v_mfma_f32_32x32x16_bf16 v[96:111], v[120:123], v[72:75], v[96:111]
    ds_read_b64_tr_b16 v[116:117], v153 offset:0
    ds_read_b64_tr_b16 v[118:119], v153 offset:2048
    buffer_load_dwordx4 v164, s[20:23], s76 offen offset:2048 lds
    s_waitcnt lgkmcnt(8)
    v_mfma_f32_32x32x16_bf16 v[96:111], v[124:127], v[76:79], v[96:111]
    ds_read_b64_tr_b16 v[120:121], v154 offset:0
    ds_read_b64_tr_b16 v[122:123], v154 offset:2048
    buffer_load_dwordx4 v164, s[20:23], s76 offen offset:3072 lds
    s_waitcnt lgkmcnt(9)
    v_mfma_f32_32x32x16_bf16 v[96:111], v[128:131], v[80:83], v[96:111]
    ds_read_b64_tr_b16 v[124:125], v155 offset:0
    ds_read_b64_tr_b16 v[126:127], v155 offset:2048
    s_add_u32 m0, s77, 36864
    s_add_u32 s76, s76, 4096
    buffer_load_dwordx4 v164, s[20:23], s76 offen offset:0 lds
    s_waitcnt lgkmcnt(10)
    v_mfma_f32_32x32x16_bf16 v[96:111], v[132:135], v[84:87], v[96:111]
    ds_read_b64_tr_b16 v[128:129], v152 offset:4096
    ds_read_b64_tr_b16 v[130:131], v152 offset:6144
    buffer_load_dwordx4 v164, s[20:23], s76 offen offset:1024 lds
    s_waitcnt lgkmcnt(11)
    v_mfma_f32_32x32x16_bf16 v[96:111], v[136:139], v[88:91], v[96:111]
    ds_read_b64_tr_b16 v[132:133], v153 offset:4096
    ds_read_b64_tr_b16 v[134:135], v153 offset:6144
    buffer_load_dwordx4 v164, s[20:23], s76 offen offset:2048 lds
    s_waitcnt lgkmcnt(12)
    v_mfma_f32_32x32x16_bf16 v[96:111], v[140:143], v[92:95], v[96:111]
    ds_read_b64_tr_b16 v[136:137], v154 offset:4096
    ds_read_b64_tr_b16 v[138:139], v154 offset:6144
    buffer_load_dwordx4 v164, s[20:23], s76 offen offset:3072 lds
    ds_read_b64_tr_b16 v[140:141], v155 offset:4096
    ds_read_b64_tr_b16 v[142:143], v155 offset:6144
    s_setprio 3
    s_nop 5
    v_max3_f32 v160, v96, v97, v98
    v_max3_f32 v161, v99, v100, v101
    v_max3_f32 v160, v160, v102, v103
    v_max3_f32 v161, v161, v104, v105
    v_max3_f32 v160, v160, v106, v107
    v_max3_f32 v161, v161, v108, v109
    v_max3_f32 v160, v160, v110, v111
    v_max_f32 v160, v160, v161
    v_cmp_gt_f32 vcc, v160, v159
    s_nop 0
    s_or_b64 s[52:53], vcc, s[50:51]
    s_cbranch_scc0 L_A6
    s_call_b64 s[38:39], L_slow
L_A6:
    v_exp_f32 v96, v96
    v_exp_f32 v97, v97
    v_exp_f32 v98, v98
    v_exp_f32 v99, v99
    v_exp_f32 v100, v100
    v_exp_f32 v101, v101
    v_exp_f32 v102, v102
    v_exp_f32 v103, v103
    v_add_f32 v157, v157, v96
    v_add_f32 v157, v157, v97
    v_add_f32 v157, v157, v98
    v_add_f32 v157, v157, v99
    v_add_f32 v157, v157, v100
    v_add_f32 v157, v157, v101
    v_add_f32 v157, v157, v102
    v_add_f32 v157, v157, v103
    v_cvt_pk_bf16_f32 v96, v96, v97
    v_cvt_pk_bf16_f32 v97, v98, v99
    v_cvt_pk_bf16_f32 v98, v100, v101
    v_cvt_pk_bf16_f32 v99, v102, v103
    v_exp_f32 v104, v104
    v_exp_f32 v105, v105
    v_exp_f32 v106, v106
    v_exp_f32 v107, v107
    v_exp_f32 v108, v108
    v_exp_f32 v109, v109
    v_exp_f32 v110, v110
    v_exp_f32 v111, v111
    v_add_f32 v157, v157, v104
    v_add_f32 v157, v157, v105
    v_add_f32 v157, v157, v106
    v_add_f32 v157, v157, v107
    v_add_f32 v157, v157, v108
    v_add_f32 v157, v157, v109
    v_add_f32 v157, v157, v110
    v_add_f32 v157, v157, v111
    v_cvt_pk_bf16_f32 v100, v104, v105
    v_cvt_pk_bf16_f32 v101, v106, v107
    v_cvt_pk_bf16_f32 v102, v108, v109
    v_cvt_pk_bf16_f32 v103, v110, v111
    s_setprio 0
    s_waitcnt lgkmcnt(14)
    v_mfma_f32_32x32x16_bf16 v[0:15], v[112:115], v[96:99], v[0:15]
    s_waitcnt lgkmcnt(12)
    v_mfma_f32_32x32x16_bf16 v[16:31], v[116:119], v[96:99], v[16:31]
    s_waitcnt lgkmcnt(10)
    v_mfma_f32_32x32x16_bf16 v[32:47], v[120:123], v[96:99], v[32:47]
    s_waitcnt lgkmcnt(8)
    v_mfma_f32_32x32x16_bf16 v[48:63], v[124:127], v[96:99], v[48:63]
    s_waitcnt lgkmcnt(6)
    v_mfma_f32_32x32x16_bf16 v[0:15], v[128:131], v[100:103], v[0:15]
    s_waitcnt lgkmcnt(4)
    v_mfma_f32_32x32x16_bf16 v[16:31], v[132:135], v[100:103], v[16:31]
    s_waitcnt lgkmcnt(2)
    v_mfma_f32_32x32x16_bf16 v[32:47], v[136:139], v[100:103], v[32:47]
    s_waitcnt lgkmcnt(0)
    v_mfma_f32_32x32x16_bf16 v[48:63], v[140:143], v[100:103], v[48:63]
    s_waitcnt vmcnt(0)
    s_barrier
    s_setprio 3
    ds_read_b128 v[112:115], v144 offset:8192
    ds_read_b128 v[116:119], v145 offset:8192
    ds_read_b128 v[120:123], v146 offset:8192
    ds_read_b128 v[124:127], v147 offset:8192
    ds_read_b128 v[128:131], v148 offset:8192
    ds_read_b128 v[132:135], v149 offset:8192
    ds_read_b128 v[136:139], v150 offset:8192
    ds_read_b128 v[140:143], v151 offset:8192
    s_waitcnt lgkmcnt(7)
    v_mfma_f32_32x32x16_bf16 v[96:111], v[112:115], v[64:67], 0
    s_waitcnt lgkmcnt(6)
    v_mfma_f32_32x32x16_bf16 v[96:111], v[116:119], v[68:71], v[96:111]
    ds_read_b64_tr_b16 v[112:113], v152 offset:8192
    ds_read_b64_tr_b16 v[114:115], v152 offset:10240
    s_waitcnt lgkmcnt(7)
    v_mfma_f32_32x32x16_bf16 v[96:111], v[120:123], v[72:75], v[96:111]
    ds_read_b64_tr_b16 v[116:117], v153 offset:8192
    ds_read_b64_tr_b16 v[118:119], v153 offset:10240
    s_waitcnt lgkmcnt(8)
    v_mfma_f32_32x32x16_bf16 v[96:111], v[124:127], v[76:79], v[96:111]
    ds_read_b64_tr_b16 v[120:121], v154 offset:8192
    ds_read_b64_tr_b16 v[122:123], v154 offset:10240
    s_waitcnt lgkmcnt(9)
    v_mfma_f32_32x32x16_bf16 v[96:111], v[128:131], v[80:83], v[96:111]
    ds_read_b64_tr_b16 v[124:125], v155 offset:8192
    ds_read_b64_tr_b16 v[126:127], v155 offset:10240
    s_waitcnt lgkmcnt(10)
    v_mfma_f32_32x32x16_bf16 v[96:111], v[132:135], v[84:87], v[96:111]
    ds_read_b64_tr_b16 v[128:129], v152 offset:12288
    ds_read_b64_tr_b16 v[130:131], v152 offset:14336
    s_waitcnt lgkmcnt(11)
    v_mfma_f32_32x32x16_bf16 v[96:111], v[136:139], v[88:91], v[96:111]
    ds_read_b64_tr_b16 v[132:133], v153 offset:12288
    ds_read_b64_tr_b16 v[134:135], v153 offset:14336
    s_waitcnt lgkmcnt(12)
    v_mfma_f32_32x32x16_bf16 v[96:111], v[140:143], v[92:95], v[96:111]
    ds_read_b64_tr_b16 v[136:137], v154 offset:12288
    ds_read_b64_tr_b16 v[138:139], v154 offset:14336
    ds_read_b64_tr_b16 v[140:141], v155 offset:12288
    ds_read_b64_tr_b16 v[142:143], v155 offset:14336
    s_setprio 3
    s_nop 6
    v_max3_f32 v160, v96, v97, v98
    v_max3_f32 v161, v99, v100, v101
    v_max3_f32 v160, v160, v102, v103
    v_max3_f32 v161, v161, v104, v105
    v_max3_f32 v160, v160, v106, v107
    v_max3_f32 v161, v161, v108, v109
    v_max3_f32 v160, v160, v110, v111
    v_max_f32 v160, v160, v161
    v_cmp_gt_f32 vcc, v160, v159
    s_nop 0
    s_or_b64 s[52:53], vcc, s[50:51]
    s_cbranch_scc0 L_A7
    s_call_b64 s[38:39], L_slow
L_A7:
    v_exp_f32 v96, v96
    v_exp_f32 v97, v97
    v_exp_f32 v98, v98
    v_exp_f32 v99, v99
    v_exp_f32 v100, v100
    v_exp_f32 v101, v101
    v_exp_f32 v102, v102
    v_exp_f32 v103, v103
    v_add_f32 v157, v157, v96
    v_add_f32 v157, v157, v97
    v_add_f32 v157, v157, v98
    v_add_f32 v157, v157, v99
    v_add_f32 v157, v157, v100
    v_add_f32 v157, v157, v101
    v_add_f32 v157, v157, v102
    v_add_f32 v157, v157, v103
    v_cvt_pk_bf16_f32 v96, v96, v97
    v_cvt_pk_bf16_f32 v97, v98, v99
    v_cvt_pk_bf16_f32 v98, v100, v101
    v_cvt_pk_bf16_f32 v99, v102, v103
    v_exp_f32 v104, v104
    v_exp_f32 v105, v105
    v_exp_f32 v106, v106
    v_exp_f32 v107, v107
    v_exp_f32 v108, v108
    v_exp_f32 v109, v109
    v_exp_f32 v110, v110
    v_exp_f32 v111, v111
    v_add_f32 v157, v157, v104
    v_add_f32 v157, v157, v105
    v_add_f32 v157, v157, v106
    v_add_f32 v157, v157, v107
    v_add_f32 v157, v157, v108
    v_add_f32 v157, v157, v109
    v_add_f32 v157, v157, v110
    v_add_f32 v157, v157, v111
    v_cvt_pk_bf16_f32 v100, v104, v105
    v_cvt_pk_bf16_f32 v101, v106, v107
    v_cvt_pk_bf16_f32 v102, v108, v109
    v_cvt_pk_bf16_f32 v103, v110, v111
    s_setprio 0
    s_waitcnt lgkmcnt(14)
    v_mfma_f32_32x32x16_bf16 v[0:15], v[112:115], v[96:99], v[0:15]
    s_waitcnt lgkmcnt(12)
    v_mfma_f32_32x32x16_bf16 v[16:31], v[116:119], v[96:99], v[16:31]
    s_waitcnt lgkmcnt(10)
    v_mfma_f32_32x32x16_bf16 v[32:47], v[120:123], v[96:99], v[32:47]
    s_waitcnt lgkmcnt(8)
    v_mfma_f32_32x32x16_bf16 v[48:63], v[124:127], v[96:99], v[48:63]
    s_waitcnt lgkmcnt(6)
    v_mfma_f32_32x32x16_bf16 v[0:15], v[128:131], v[100:103], v[0:15]
    s_waitcnt lgkmcnt(4)
    v_mfma_f32_32x32x16_bf16 v[16:31], v[132:135], v[100:103], v[16:31]
    s_waitcnt lgkmcnt(2)
    v_mfma_f32_32x32x16_bf16 v[32:47], v[136:139], v[100:103], v[32:47]
    s_waitcnt lgkmcnt(0)
    v_mfma_f32_32x32x16_bf16 v[48:63], v[140:143], v[100:103], v[48:63]
    s_setprio 3
    v_lshlrev_b32 v64, 4, v163
    s_mul_i32 s76, s33, 40960
    s_add_u32 s3, s34, 1
    s_lshl_b32 s3, s3, 13
    s_cmp_eq_u32 s34, 0
    s_cselect_b32 s3, 0, s3
    s_add_u32 s77, s76, s3
    v_add_u32 v80, s77, v64
    v_and_b32 v81, 31, v163
    v_lshlrev_b32 v81, 3, v81
    s_lshl_b32 s3, s34, 8
    s_add_u32 s3, s3, 6144
    v_add_u32 v81, s3, v81
    v_add_u32 v68, s76, v81
    v_and_b32 v82, 31, v163
    s_lshl_b32 s3, s34, 5
    v_add_u32 v82, s3, v82
    v_cmp_le_u32 vcc, 48, v82
    v_subrev_u32 v83, 48, v82
    v_lshrrev_b32 v84, 5, v163
    v_cndmask_b32 v79, v82, v83, vcc
    v_cndmask_b32 v78, 0, 1, vcc
    v_lshlrev_b32 v84, 8, v84
    s_and_b32 s3, s31, 1
    s_mul_i32 s76, s3, 48
    s_xor_b32 s3, s3, 1
    s_mul_i32 s77, s3, 48
    v_add_u32 v82, s76, v79
    v_lshrrev_b32 v83, 4, v82
    v_lshlrev_b32 v83, 10, v83
    v_and_b32 v82, 15, v82
    v_lshlrev_b32 v82, 4, v82
    v_add3_u32 v72, v82, v83, v84
    s_mul_i32 s3, s33, 6144
    v_mul_u32_u24 v82, 40960, v78
    v_add3_u32 v76, v72, v82, s3
    v_mul_u32_u24 v82, 24576, v78
    v_add_u32 v72, v72, v82
    s_lshl_b32 s3, s32, 4
    s_lshl_b32 s76, s33, 1
    s_add_u32 s3, s3, s76
    s_mul_i32 s3, s3, 3072
    s_mul_i32 s79, s58, 196608
    s_add_u32 s79, s79, s3
    s_add_u32 s79, s79, 0
    s_cmp_eq_u32 s28, 4
    s_cbranch_scc0 L_merge
    v_and_b32 v73, 31, v163
    v_lshrrev_b32 v74, 5, v163
    v_lshlrev_b32 v74, 2, v74
    v_sub_u32 v73, v73, v74
    v_and_b32 v74, 1, v73
    v_lshlrev_b32 v74, 4, v74
    v_mov_b32 v75, 0x3f80
    v_lshlrev_b32 v75, v74, v75
    v_and_b32 v78, 0x80000004, v73
    v_bfe_u32 v74, v73, 1, 1
    v_cmp_ne_u32 vcc, 0, v78
    v_bfe_u32 v73, v73, 3, 2
    v_lshl_or_b32 v73, v73, 1, v74
    v_cndmask_b32 v73, v73, 8, vcc
    v_cmp_eq_u32 vcc, 0, v73
    v_cmp_eq_u32 s[52:53], 1, v73
    v_cmp_eq_u32 s[76:77], 2, v73
    v_cndmask_b32 v88, 0, v75, vcc
    v_cndmask_b32 v89, 0, v75, s[52:53]
    v_cndmask_b32 v90, 0, v75, s[76:77]
    v_cmp_eq_u32 vcc, 3, v73
    v_cmp_eq_u32 s[52:53], 4, v73
    v_cmp_eq_u32 s[76:77], 5, v73
    v_cndmask_b32 v91, 0, v75, vcc
    v_cndmask_b32 v92, 0, v75, s[52:53]
    v_cndmask_b32 v93, 0, v75, s[76:77]
    v_cmp_eq_u32 vcc, 6, v73
    v_cmp_eq_u32 s[52:53], 7, v73
    s_nop 0
    v_cndmask_b32 v94, 0, v75, vcc
    v_cndmask_b32 v95, 0, v75, s[52:53]
    v_lshlrev_b32 v73, 4, v163
    v_add_u32 v73, 30720, v73
    ds_write_b128 v73, v[88:91]
    ds_write_b128 v73, v[92:95] offset:1024
    s_branch L_merge
L_typeC:
    s_cmp_eq_u32 s28, 8
    s_cbranch_scc0 L_notokld
    buffer_load_dword v164, off, s[16:19], 0 sc1
L_notokld:
    s_barrier
    s_setprio 3
    ds_read_b128 v[112:115], v144 offset:0
    ds_read_b128 v[116:119], v145 offset:0
    ds_read_b128 v[120:123], v146 offset:0
    ds_read_b128 v[124:127], v147 offset:0
    ds_read_b128 v[128:131], v148 offset:0
    ds_read_b128 v[132:135], v149 offset:0
    ds_read_b128 v[136:139], v150 offset:0
    ds_read_b128 v[140:143], v151 offset:0
    v_mov_b32 v0, 0
    v_mov_b32 v1, 0
    v_mov_b32 v2, 0
    v_mov_b32 v3, 0
    v_mov_b32 v4, 0
    v_mov_b32 v5, 0
    v_mov_b32 v6, 0
    v_mov_b32 v7, 0
    v_mov_b32 v8, 0
    v_mov_b32 v9, 0
    v_mov_b32 v10, 0
    v_mov_b32 v11, 0
    v_mov_b32 v12, 0
    v_mov_b32 v13, 0
    v_mov_b32 v14, 0
    v_mov_b32 v15, 0
    v_mov_b32 v16, 0
    v_mov_b32 v17, 0
    v_mov_b32 v18, 0
    v_mov_b32 v19, 0
    v_mov_b32 v20, 0
    v_mov_b32 v21, 0
    v_mov_b32 v22, 0
    v_mov_b32 v23, 0
    v_mov_b32 v24, 0
    v_mov_b32 v25, 0
    v_mov_b32 v26, 0
    v_mov_b32 v27, 0
    v_mov_b32 v28, 0
    v_mov_b32 v29, 0
    v_mov_b32 v30, 0
    v_mov_b32 v31, 0
    v_mov_b32 v32, 0
    v_mov_b32 v33, 0
    v_mov_b32 v34, 0
    v_mov_b32 v35, 0
    v_mov_b32 v36, 0
    v_mov_b32 v37, 0
    v_mov_b32 v38, 0
    v_mov_b32 v39, 0
    v_mov_b32 v40, 0
    v_mov_b32 v41, 0
    v_mov_b32 v42, 0
    v_mov_b32 v43, 0
    v_mov_b32 v44, 0
    v_mov_b32 v45, 0
    v_mov_b32 v46, 0
    v_mov_b32 v47, 0
    v_mov_b32 v48, 0
    v_mov_b32 v49, 0
    v_mov_b32 v50, 0
    v_mov_b32 v51, 0
    v_mov_b32 v52, 0
    v_mov_b32 v53, 0
    v_mov_b32 v54, 0
    v_mov_b32 v55, 0
    v_mov_b32 v56, 0
    v_mov_b32 v57, 0
    v_mov_b32 v58, 0
    v_mov_b32 v59, 0
    v_mov_b32 v60, 0
    v_mov_b32 v61, 0
    v_mov_b32 v62, 0
    v_mov_b32 v63, 0
    s_mov_b32 s37, 1098907648
    s_mov_b32 s36, 3263168512
    s_mov_b64 s[50:51], 0
    v_mov_b32 v156, 0
    v_mov_b32 v159, s37
    v_mov_b32 v157, 0
    s_setprio 1
    s_waitcnt lgkmcnt(7)
    v_mfma_f32_32x32x16_bf16 v[96:111], v[112:115], v[64:67], 0
    s_waitcnt lgkmcnt(6)
    v_mfma_f32_32x32x16_bf16 v[96:111], v[116:119], v[68:71], v[96:111]
    ds_read_b64_tr_b16 v[112:113], v152 offset:0
    ds_read_b64_tr_b16 v[114:115], v152 offset:2048
    s_waitcnt lgkmcnt(7)
    v_mfma_f32_32x32x16_bf16 v[96:111], v[120:123], v[72:75], v[96:111]
    ds_read_b64_tr_b16 v[116:117], v153 offset:0
    ds_read_b64_tr_b16 v[118:119], v153 offset:2048
    s_waitcnt lgkmcnt(8)
    v_mfma_f32_32x32x16_bf16 v[96:111], v[124:127], v[76:79], v[96:111]
    ds_read_b64_tr_b16 v[120:121], v154 offset:0
    ds_read_b64_tr_b16 v[122:123], v154 offset:2048
    s_waitcnt lgkmcnt(9)
    v_mfma_f32_32x32x16_bf16 v[96:111], v[128:131], v[80:83], v[96:111]
    ds_read_b64_tr_b16 v[124:125], v155 offset:0
    ds_read_b64_tr_b16 v[126:127], v155 offset:2048
    s_waitcnt lgkmcnt(10)
    v_mfma_f32_32x32x16_bf16 v[96:111], v[132:135], v[84:87], v[96:111]
    ds_read_b64_tr_b16 v[128:129], v152 offset:4096
    ds_read_b64_tr_b16 v[130:131], v152 offset:6144
    s_waitcnt lgkmcnt(11)
    v_mfma_f32_32x32x16_bf16 v[96:111], v[136:139], v[88:91], v[96:111]
    ds_read_b64_tr_b16 v[132:133], v153 offset:4096
    ds_read_b64_tr_b16 v[134:135], v153 offset:6144
    s_waitcnt lgkmcnt(12)
    v_mfma_f32_32x32x16_bf16 v[96:111], v[140:143], v[92:95], v[96:111]
    ds_read_b64_tr_b16 v[136:137], v154 offset:4096
    ds_read_b64_tr_b16 v[138:139], v154 offset:6144
    ds_read_b64_tr_b16 v[140:141], v155 offset:4096
    ds_read_b64_tr_b16 v[142:143], v155 offset:6144
    s_waitcnt lgkmcnt(0)
    s_barrier
    s_setprio 3
    s_nop 4
    v_max3_f32 v160, v96, v97, v98
    v_max3_f32 v161, v99, v100, v101
    v_max3_f32 v160, v160, v102, v103
    v_max3_f32 v161, v161, v104, v105
    v_max3_f32 v160, v160, v106, v107
    v_max3_f32 v161, v161, v108, v109
    v_max3_f32 v160, v160, v110, v111
    v_max_f32 v160, v160, v161
    v_cmp_gt_f32 vcc, v160, v159
    v_cmp_gt_f32 s[52:53], s36, v160
    s_nop 0
    s_or_b64 vcc, vcc, s[52:53]
    s_or_b64 s[52:53], vcc, s[50:51]
    s_cbranch_scc0 L_C1
    s_call_b64 s[38:39], L_slow_first
L_C1:
    v_exp_f32 v96, v96
    v_exp_f32 v97, v97
    v_exp_f32 v98, v98
    v_exp_f32 v99, v99
    v_exp_f32 v100, v100
    v_exp_f32 v101, v101
    v_exp_f32 v102, v102
    v_exp_f32 v103, v103
    v_add_f32 v157, v157, v96
    v_add_f32 v157, v157, v97
    v_add_f32 v157, v157, v98
    v_add_f32 v157, v157, v99
    v_add_f32 v157, v157, v100
    v_add_f32 v157, v157, v101
    v_add_f32 v157, v157, v102
    v_add_f32 v157, v157, v103
    v_cvt_pk_bf16_f32 v96, v96, v97
    v_cvt_pk_bf16_f32 v97, v98, v99
    v_cvt_pk_bf16_f32 v98, v100, v101
    v_cvt_pk_bf16_f32 v99, v102, v103
    v_exp_f32 v104, v104
    v_exp_f32 v105, v105
    v_exp_f32 v106, v106
    v_exp_f32 v107, v107
    v_exp_f32 v108, v108
    v_exp_f32 v109, v109
    v_exp_f32 v110, v110
    v_exp_f32 v111, v111
    v_add_f32 v157, v157, v104
    v_add_f32 v157, v157, v105
    v_add_f32 v157, v157, v106
    v_add_f32 v157, v157, v107
    v_add_f32 v157, v157, v108
    v_add_f32 v157, v157, v109
    v_add_f32 v157, v157, v110
    v_add_f32 v157, v157, v111
    v_cvt_pk_bf16_f32 v100, v104, v105
    v_cvt_pk_bf16_f32 v101, v106, v107
    v_cvt_pk_bf16_f32 v102, v108, v109
    v_cvt_pk_bf16_f32 v103, v110, v111
    s_setprio 1
    v_mfma_f32_32x32x16_bf16 v[0:15], v[112:115], v[96:99], v[0:15]
    v_mfma_f32_32x32x16_bf16 v[16:31], v[116:119], v[96:99], v[16:31]
    ds_read_b128 v[112:115], v144 offset:8192
    v_mfma_f32_32x32x16_bf16 v[32:47], v[120:123], v[96:99], v[32:47]
    ds_read_b128 v[116:119], v145 offset:8192
    v_mfma_f32_32x32x16_bf16 v[48:63], v[124:127], v[96:99], v[48:63]
    ds_read_b128 v[120:123], v146 offset:8192
    v_mfma_f32_32x32x16_bf16 v[0:15], v[128:131], v[100:103], v[0:15]
    ds_read_b128 v[124:127], v147 offset:8192
    v_mfma_f32_32x32x16_bf16 v[16:31], v[132:135], v[100:103], v[16:31]
    ds_read_b128 v[128:131], v148 offset:8192
    v_mfma_f32_32x32x16_bf16 v[32:47], v[136:139], v[100:103], v[32:47]
    ds_read_b128 v[132:135], v149 offset:8192
    v_mfma_f32_32x32x16_bf16 v[48:63], v[140:143], v[100:103], v[48:63]
    ds_read_b128 v[136:139], v150 offset:8192
    ds_read_b128 v[140:143], v151 offset:8192
    s_setprio 1
    s_waitcnt lgkmcnt(7)
    v_mfma_f32_32x32x16_bf16 v[96:111], v[112:115], v[64:67], 0
    s_waitcnt lgkmcnt(6)
    v_mfma_f32_32x32x16_bf16 v[96:111], v[116:119], v[68:71], v[96:111]
    ds_read_b64_tr_b16 v[112:113], v152 offset:8192
    ds_read_b64_tr_b16 v[114:115], v152 offset:10240
    s_waitcnt lgkmcnt(7)
    v_mfma_f32_32x32x16_bf16 v[96:111], v[120:123], v[72:75], v[96:111]
    ds_read_b64_tr_b16 v[116:117], v153 offset:8192
    ds_read_b64_tr_b16 v[118:119], v153 offset:10240
    s_waitcnt lgkmcnt(8)
    v_mfma_f32_32x32x16_bf16 v[96:111], v[124:127], v[76:79], v[96:111]
    ds_read_b64_tr_b16 v[120:121], v154 offset:8192
    ds_read_b64_tr_b16 v[122:123], v154 offset:10240
    s_waitcnt lgkmcnt(9)
    v_mfma_f32_32x32x16_bf16 v[96:111], v[128:131], v[80:83], v[96:111]
    ds_read_b64_tr_b16 v[124:125], v155 offset:8192
    ds_read_b64_tr_b16 v[126:127], v155 offset:10240
    s_waitcnt lgkmcnt(10)
    v_mfma_f32_32x32x16_bf16 v[96:111], v[132:135], v[84:87], v[96:111]
    ds_read_b64_tr_b16 v[128:129], v152 offset:12288
    ds_read_b64_tr_b16 v[130:131], v152 offset:14336
    s_waitcnt lgkmcnt(11)
    v_mfma_f32_32x32x16_bf16 v[96:111], v[136:139], v[88:91], v[96:111]
    ds_read_b64_tr_b16 v[132:133], v153 offset:12288
    ds_read_b64_tr_b16 v[134:135], v153 offset:14336
    s_waitcnt lgkmcnt(12)
    v_mfma_f32_32x32x16_bf16 v[96:111], v[140:143], v[92:95], v[96:111]
    ds_read_b64_tr_b16 v[136:137], v154 offset:12288
    ds_read_b64_tr_b16 v[138:139], v154 offset:14336
    ds_read_b64_tr_b16 v[140:141], v155 offset:12288
    ds_read_b64_tr_b16 v[142:143], v155 offset:14336
    s_waitcnt lgkmcnt(0)
    s_barrier
    s_setprio 3
    s_cmp_eq_u32 s28, 8
    s_cbranch_scc0 L_nxf_5
    s_waitcnt vmcnt(0)
    v_readfirstlane_b32 s40, v164
    s_getreg_b32 s3, hwreg(HW_REG_XCC_ID, 0, 4)
    s_cmp_eq_u32 s40, 0
    s_cbranch_scc1 L_nxf_5
    s_add_u32 s3, s3, s40
    v_mov_b32 v158, s3
    s_lshl_b32 s3, s58, 5
    s_add_u32 s3, s3, s55
    s_lshl_b32 s3, s3, 2
    s_add_u32 s3, s3, 8585216
    s_mov_b64 exec, 1
    buffer_store_dword v158, off, s[24:27], s3
    s_mov_b64 exec, -1
L_nxf_5:
    v_max3_f32 v160, v96, v97, v98
    v_max3_f32 v161, v99, v100, v101
    v_max3_f32 v160, v160, v102, v103
    v_max3_f32 v161, v161, v104, v105
    v_max3_f32 v160, v160, v106, v107
    v_max3_f32 v161, v161, v108, v109
    v_max3_f32 v160, v160, v110, v111
    v_max_f32 v160, v160, v161
    v_cmp_gt_f32 vcc, v160, v159
    s_nop 0
    s_or_b64 s[52:53], vcc, s[50:51]
    s_cbranch_scc0 L_C2
    s_call_b64 s[38:39], L_slow
L_C2:
    v_exp_f32 v96, v96
    v_exp_f32 v97, v97
    v_exp_f32 v98, v98
    v_exp_f32 v99, v99
    v_exp_f32 v100, v100
    v_exp_f32 v101, v101
    v_exp_f32 v102, v102
    v_exp_f32 v103, v103
    v_add_f32 v157, v157, v96
    v_add_f32 v157, v157, v97
    v_add_f32 v157, v157, v98
    v_add_f32 v157, v157, v99
    v_add_f32 v157, v157, v100
    v_add_f32 v157, v157, v101
    v_add_f32 v157, v157, v102
    v_add_f32 v157, v157, v103
    v_cvt_pk_bf16_f32 v96, v96, v97
    v_cvt_pk_bf16_f32 v97, v98, v99
    v_cvt_pk_bf16_f32 v98, v100, v101
    v_cvt_pk_bf16_f32 v99, v102, v103
    v_exp_f32 v104, v104
    v_exp_f32 v105, v105
    v_exp_f32 v106, v106
    v_exp_f32 v107, v107
    v_exp_f32 v108, v108
    v_exp_f32 v109, v109
    v_exp_f32 v110, v110
    v_exp_f32 v111, v111
    v_add_f32 v157, v157, v104
    v_add_f32 v157, v157, v105
    v_add_f32 v157, v157, v106
    v_add_f32 v157, v157, v107
    v_add_f32 v157, v157, v108
    v_add_f32 v157, v157, v109
    v_add_f32 v157, v157, v110
    v_add_f32 v157, v157, v111
    v_cvt_pk_bf16_f32 v100, v104, v105
    v_cvt_pk_bf16_f32 v101, v106, v107
    v_cvt_pk_bf16_f32 v102, v108, v109
    v_cvt_pk_bf16_f32 v103, v110, v111
    s_setprio 1
    v_mfma_f32_32x32x16_bf16 v[0:15], v[112:115], v[96:99], v[0:15]
    v_mfma_f32_32x32x16_bf16 v[16:31], v[116:119], v[96:99], v[16:31]
    ds_read_b128 v[112:115], v144 offset:16384
    v_mfma_f32_32x32x16_bf16 v[32:47], v[120:123], v[96:99], v[32:47]
    ds_read_b128 v[116:119], v145 offset:16384
    v_mfma_f32_32x32x16_bf16 v[48:63], v[124:127], v[96:99], v[48:63]
    ds_read_b128 v[120:123], v146 offset:16384
    v_mfma_f32_32x32x16_bf16 v[0:15], v[128:131], v[100:103], v[0:15]
    ds_read_b128 v[124:127], v147 offset:16384
    v_mfma_f32_32x32x16_bf16 v[16:31], v[132:135], v[100:103], v[16:31]
    ds_read_b128 v[128:131], v148 offset:16384
    v_mfma_f32_32x32x16_bf16 v[32:47], v[136:139], v[100:103], v[32:47]
    ds_read_b128 v[132:135], v149 offset:16384
    v_mfma_f32_32x32x16_bf16 v[48:63], v[140:143], v[100:103], v[48:63]
    ds_read_b128 v[136:139], v150 offset:16384
    ds_read_b128 v[140:143], v151 offset:16384
    s_setprio 1
    s_waitcnt lgkmcnt(7)
    v_mfma_f32_32x32x16_bf16 v[96:111], v[112:115], v[64:67], 0
    s_waitcnt lgkmcnt(6)
    v_mfma_f32_32x32x16_bf16 v[96:111], v[116:119], v[68:71], v[96:111]
    ds_read_b64_tr_b16 v[112:113], v152 offset:0
    ds_read_b64_tr_b16 v[114:115], v152 offset:2048
    s_waitcnt lgkmcnt(7)
    v_mfma_f32_32x32x16_bf16 v[96:111], v[120:123], v[72:75], v[96:111]
    ds_read_b64_tr_b16 v[116:117], v153 offset:0
    ds_read_b64_tr_b16 v[118:119], v153 offset:2048
    s_waitcnt lgkmcnt(8)
    v_mfma_f32_32x32x16_bf16 v[96:111], v[124:127], v[76:79], v[96:111]
    ds_read_b64_tr_b16 v[120:121], v154 offset:0
    ds_read_b64_tr_b16 v[122:123], v154 offset:2048
    s_waitcnt lgkmcnt(9)
    v_mfma_f32_32x32x16_bf16 v[96:111], v[128:131], v[80:83], v[96:111]
    ds_read_b64_tr_b16 v[124:125], v155 offset:0
    ds_read_b64_tr_b16 v[126:127], v155 offset:2048
    s_waitcnt lgkmcnt(10)
    v_mfma_f32_32x32x16_bf16 v[96:111], v[132:135], v[84:87], v[96:111]
    ds_read_b64_tr_b16 v[128:129], v152 offset:4096
    ds_read_b64_tr_b16 v[130:131], v152 offset:6144
    s_waitcnt lgkmcnt(11)
    v_mfma_f32_32x32x16_bf16 v[96:111], v[136:139], v[88:91], v[96:111]
    ds_read_b64_tr_b16 v[132:133], v153 offset:4096
    ds_read_b64_tr_b16 v[134:135], v153 offset:6144
    s_waitcnt lgkmcnt(12)
    v_mfma_f32_32x32x16_bf16 v[96:111], v[140:143], v[92:95], v[96:111]
    ds_read_b64_tr_b16 v[136:137], v154 offset:4096
    ds_read_b64_tr_b16 v[138:139], v154 offset:6144
    ds_read_b64_tr_b16 v[140:141], v155 offset:4096
    ds_read_b64_tr_b16 v[142:143], v155 offset:6144
    s_waitcnt lgkmcnt(0)
    s_barrier
    s_setprio 3
    s_nop 4
    v_max3_f32 v160, v96, v97, v98
    v_max3_f32 v161, v99, v100, v101
    v_max3_f32 v160, v160, v102, v103
    v_max3_f32 v161, v161, v104, v105
    v_max3_f32 v160, v160, v106, v107
    v_max3_f32 v161, v161, v108, v109
    v_max3_f32 v160, v160, v110, v111
    v_max_f32 v160, v160, v161
    v_cmp_gt_f32 vcc, v160, v159
    s_nop 0
    s_or_b64 s[52:53], vcc, s[50:51]
    s_cbranch_scc0 L_C3
    s_call_b64 s[38:39], L_slow
L_C3:
    v_exp_f32 v96, v96
    v_exp_f32 v97, v97
    v_exp_f32 v98, v98
    v_exp_f32 v99, v99
    v_exp_f32 v100, v100
    v_exp_f32 v101, v101
    v_exp_f32 v102, v102
    v_exp_f32 v103, v103
    v_add_f32 v157, v157, v96
    v_add_f32 v157, v157, v97
    v_add_f32 v157, v157, v98
    v_add_f32 v157, v157, v99
    v_add_f32 v157, v157, v100
    v_add_f32 v157, v157, v101
    v_add_f32 v157, v157, v102
    v_add_f32 v157, v157, v103
    v_cvt_pk_bf16_f32 v96, v96, v97
    v_cvt_pk_bf16_f32 v97, v98, v99
    v_cvt_pk_bf16_f32 v98, v100, v101
    v_cvt_pk_bf16_f32 v99, v102, v103
    v_exp_f32 v104, v104
    v_exp_f32 v105, v105
    v_exp_f32 v106, v106
    v_exp_f32 v107, v107
    v_exp_f32 v108, v108
    v_exp_f32 v109, v109
    v_exp_f32 v110, v110
    v_exp_f32 v111, v111
    v_add_f32 v157, v157, v104
    v_add_f32 v157, v157, v105
    v_add_f32 v157, v157, v106
    v_add_f32 v157, v157, v107
    v_add_f32 v157, v157, v108
    v_add_f32 v157, v157, v109
    v_add_f32 v157, v157, v110
    v_add_f32 v157, v157, v111
    v_cvt_pk_bf16_f32 v100, v104, v105
    v_cvt_pk_bf16_f32 v101, v106, v107
    v_cvt_pk_bf16_f32 v102, v108, v109
    v_cvt_pk_bf16_f32 v103, v110, v111
    s_setprio 1
    v_mfma_f32_32x32x16_bf16 v[0:15], v[112:115], v[96:99], v[0:15]
    v_mfma_f32_32x32x16_bf16 v[16:31], v[116:119], v[96:99], v[16:31]
    ds_read_b128 v[112:115], v144 offset:0
    v_mfma_f32_32x32x16_bf16 v[32:47], v[120:123], v[96:99], v[32:47]
    ds_read_b128 v[116:119], v145 offset:0
    v_mfma_f32_32x32x16_bf16 v[48:63], v[124:127], v[96:99], v[48:63]
    ds_read_b128 v[120:123], v146 offset:0
    v_mfma_f32_32x32x16_bf16 v[0:15], v[128:131], v[100:103], v[0:15]
    ds_read_b128 v[124:127], v147 offset:0
    v_mfma_f32_32x32x16_bf16 v[16:31], v[132:135], v[100:103], v[16:31]
    ds_read_b128 v[128:131], v148 offset:0
    v_mfma_f32_32x32x16_bf16 v[32:47], v[136:139], v[100:103], v[32:47]
    ds_read_b128 v[132:135], v149 offset:0
    v_mfma_f32_32x32x16_bf16 v[48:63], v[140:143], v[100:103], v[48:63]
    ds_read_b128 v[136:139], v150 offset:0
    ds_read_b128 v[140:143], v151 offset:0
    s_setprio 1
    s_waitcnt lgkmcnt(7)
    v_mfma_f32_32x32x16_bf16 v[96:111], v[112:115], v[64:67], 0
    s_waitcnt lgkmcnt(6)
    v_mfma_f32_32x32x16_bf16 v[96:111], v[116:119], v[68:71], v[96:111]
    ds_read_b64_tr_b16 v[112:113], v152 offset:8192
    ds_read_b64_tr_b16 v[114:115], v152 offset:10240
    s_waitcnt lgkmcnt(7)
    v_mfma_f32_32x32x16_bf16 v[96:111], v[120:123], v[72:75], v[96:111]
    ds_read_b64_tr_b16 v[116:117], v153 offset:8192
    ds_read_b64_tr_b16 v[118:119], v153 offset:10240
    s_waitcnt lgkmcnt(8)
    v_mfma_f32_32x32x16_bf16 v[96:111], v[124:127], v[76:79], v[96:111]
    ds_read_b64_tr_b16 v[120:121], v154 offset:8192
    ds_read_b64_tr_b16 v[122:123], v154 offset:10240
    s_waitcnt lgkmcnt(9)
    v_mfma_f32_32x32x16_bf16 v[96:111], v[128:131], v[80:83], v[96:111]
    ds_read_b64_tr_b16 v[124:125], v155 offset:8192
    ds_read_b64_tr_b16 v[126:127], v155 offset:10240
    s_waitcnt lgkmcnt(10)
    v_mfma_f32_32x32x16_bf16 v[96:111], v[132:135], v[84:87], v[96:111]
    ds_read_b64_tr_b16 v[128:129], v152 offset:12288
    ds_read_b64_tr_b16 v[130:131], v152 offset:14336
    s_waitcnt lgkmcnt(11)
    v_mfma_f32_32x32x16_bf16 v[96:111], v[136:139], v[88:91], v[96:111]
    ds_read_b64_tr_b16 v[132:133], v153 offset:12288
    ds_read_b64_tr_b16 v[134:135], v153 offset:14336
    s_waitcnt lgkmcnt(12)
    v_mfma_f32_32x32x16_bf16 v[96:111], v[140:143], v[92:95], v[96:111]
    ds_read_b64_tr_b16 v[136:137], v154 offset:12288
    ds_read_b64_tr_b16 v[138:139], v154 offset:14336
    ds_read_b64_tr_b16 v[140:141], v155 offset:12288
    ds_read_b64_tr_b16 v[142:143], v155 offset:14336
    s_waitcnt lgkmcnt(0)
    s_barrier
    s_setprio 3
    s_nop 4
    v_max3_f32 v160, v96, v97, v98
    v_max3_f32 v161, v99, v100, v101
    v_max3_f32 v160, v160, v102, v103
    v_max3_f32 v161, v161, v104, v105
    v_max3_f32 v160, v160, v106, v107
    v_max3_f32 v161, v161, v108, v109
    v_max3_f32 v160, v160, v110, v111
    v_max_f32 v160, v160, v161
    v_cmp_gt_f32 vcc, v160, v159
    s_nop 0
    s_or_b64 s[52:53], vcc, s[50:51]
    s_cbranch_scc0 L_C4
    s_call_b64 s[38:39], L_slow
L_C4:
    v_exp_f32 v96, v96
    v_exp_f32 v97, v97
    v_exp_f32 v98, v98
    v_exp_f32 v99, v99
    v_exp_f32 v100, v100
    v_exp_f32 v101, v101
    v_exp_f32 v102, v102
    v_exp_f32 v103, v103
    v_add_f32 v157, v157, v96
    v_add_f32 v157, v157, v97
    v_add_f32 v157, v157, v98
    v_add_f32 v157, v157, v99
    v_add_f32 v157, v157, v100
    v_add_f32 v157, v157, v101
    v_add_f32 v157, v157, v102
    v_add_f32 v157, v157, v103
    v_cvt_pk_bf16_f32 v96, v96, v97
    v_cvt_pk_bf16_f32 v97, v98, v99
    v_cvt_pk_bf16_f32 v98, v100, v101
    v_cvt_pk_bf16_f32 v99, v102, v103
    v_exp_f32 v104, v104
    v_exp_f32 v105, v105
    v_exp_f32 v106, v106
    v_exp_f32 v107, v107
    v_exp_f32 v108, v108
    v_exp_f32 v109, v109
    v_exp_f32 v110, v110
    v_exp_f32 v111, v111
    v_add_f32 v157, v157, v104
    v_add_f32 v157, v157, v105
    v_add_f32 v157, v157, v106
    v_add_f32 v157, v157, v107
    v_add_f32 v157, v157, v108
    v_add_f32 v157, v157, v109
    v_add_f32 v157, v157, v110
    v_add_f32 v157, v157, v111
    v_cvt_pk_bf16_f32 v100, v104, v105
    v_cvt_pk_bf16_f32 v101, v106, v107
    v_cvt_pk_bf16_f32 v102, v108, v109
    v_cvt_pk_bf16_f32 v103, v110, v111
    s_setprio 1
    v_mfma_f32_32x32x16_bf16 v[0:15], v[112:115], v[96:99], v[0:15]
    v_mfma_f32_32x32x16_bf16 v[16:31], v[116:119], v[96:99], v[16:31]
    ds_read_b128 v[112:115], v144 offset:8192
    v_mfma_f32_32x32x16_bf16 v[32:47], v[120:123], v[96:99], v[32:47]
    ds_read_b128 v[116:119], v145 offset:8192
    v_mfma_f32_32x32x16_bf16 v[48:63], v[124:127], v[96:99], v[48:63]
    ds_read_b128 v[120:123], v146 offset:8192
    v_mfma_f32_32x32x16_bf16 v[0:15], v[128:131], v[100:103], v[0:15]
    ds_read_b128 v[124:127], v147 offset:8192
    v_mfma_f32_32x32x16_bf16 v[16:31], v[132:135], v[100:103], v[16:31]
    ds_read_b128 v[128:131], v148 offset:8192
    v_mfma_f32_32x32x16_bf16 v[32:47], v[136:139], v[100:103], v[32:47]
    ds_read_b128 v[132:135], v149 offset:8192
    v_mfma_f32_32x32x16_bf16 v[48:63], v[140:143], v[100:103], v[48:63]
    ds_read_b128 v[136:139], v150 offset:8192
    ds_read_b128 v[140:143], v151 offset:8192
    s_setprio 1
    s_waitcnt lgkmcnt(7)
    v_mfma_f32_32x32x16_bf16 v[96:111], v[112:115], v[64:67], 0
    s_waitcnt lgkmcnt(6)
    v_mfma_f32_32x32x16_bf16 v[96:111], v[116:119], v[68:71], v[96:111]
    ds_read_b64_tr_b16 v[112:113], v152 offset:0
    ds_read_b64_tr_b16 v[114:115], v152 offset:2048
    s_waitcnt lgkmcnt(7)
    v_mfma_f32_32x32x16_bf16 v[96:111], v[120:123], v[72:75], v[96:111]
    ds_read_b64_tr_b16 v[116:117], v153 offset:0
    ds_read_b64_tr_b16 v[118:119], v153 offset:2048
    s_waitcnt lgkmcnt(8)
    v_mfma_f32_32x32x16_bf16 v[96:111], v[124:127], v[76:79], v[96:111]
    ds_read_b64_tr_b16 v[120:121], v154 offset:0
    ds_read_b64_tr_b16 v[122:123], v154 offset:2048
    s_waitcnt lgkmcnt(9)
    v_mfma_f32_32x32x16_bf16 v[96:111], v[128:131], v[80:83], v[96:111]
    ds_read_b64_tr_b16 v[124:125], v155 offset:0
    ds_read_b64_tr_b16 v[126:127], v155 offset:2048
    s_waitcnt lgkmcnt(10)
    v_mfma_f32_32x32x16_bf16 v[96:111], v[132:135], v[84:87], v[96:111]
    ds_read_b64_tr_b16 v[128:129], v152 offset:4096
    ds_read_b64_tr_b16 v[130:131], v152 offset:6144
    s_waitcnt lgkmcnt(11)
    v_mfma_f32_32x32x16_bf16 v[96:111], v[136:139], v[88:91], v[96:111]
    ds_read_b64_tr_b16 v[132:133], v153 offset:4096
    ds_read_b64_tr_b16 v[134:135], v153 offset:6144
    s_waitcnt lgkmcnt(12)
    v_mfma_f32_32x32x16_bf16 v[96:111], v[140:143], v[92:95], v[96:111]
    ds_read_b64_tr_b16 v[136:137], v154 offset:4096
    ds_read_b64_tr_b16 v[138:139], v154 offset:6144
    ds_read_b64_tr_b16 v[140:141], v155 offset:4096
    ds_read_b64_tr_b16 v[142:143], v155 offset:6144
    s_waitcnt lgkmcnt(0)
    s_barrier
    s_setprio 3
    s_nop 4
    v_max3_f32 v160, v96, v97, v98
    v_max3_f32 v161, v99, v100, v101
    v_max3_f32 v160, v160, v102, v103
    v_max3_f32 v161, v161, v104, v105
    v_max3_f32 v160, v160, v106, v107
    v_max3_f32 v161, v161, v108, v109
    v_max3_f32 v160, v160, v110, v111
    v_max_f32 v160, v160, v161
    v_cmp_gt_f32 vcc, v160, v159
    s_nop 0
    s_or_b64 s[52:53], vcc, s[50:51]
    s_cbranch_scc0 L_C5
    s_call_b64 s[38:39], L_slow
L_C5:
    v_exp_f32 v96, v96
    v_exp_f32 v97, v97
    v_exp_f32 v98, v98
    v_exp_f32 v99, v99
    v_exp_f32 v100, v100
    v_exp_f32 v101, v101
    v_exp_f32 v102, v102
    v_exp_f32 v103, v103
    v_add_f32 v157, v157, v96
    v_add_f32 v157, v157, v97
    v_add_f32 v157, v157, v98
    v_add_f32 v157, v157, v99
    v_add_f32 v157, v157, v100
    v_add_f32 v157, v157, v101
    v_add_f32 v157, v157, v102
    v_add_f32 v157, v157, v103
    v_cvt_pk_bf16_f32 v96, v96, v97
    v_cvt_pk_bf16_f32 v97, v98, v99
    v_cvt_pk_bf16_f32 v98, v100, v101
    v_cvt_pk_bf16_f32 v99, v102, v103
    v_exp_f32 v104, v104
    v_exp_f32 v105, v105
    v_exp_f32 v106, v106
    v_exp_f32 v107, v107
    v_exp_f32 v108, v108
    v_exp_f32 v109, v109
    v_exp_f32 v110, v110
    v_exp_f32 v111, v111
    v_add_f32 v157, v157, v104
    v_add_f32 v157, v157, v105
    v_add_f32 v157, v157, v106
    v_add_f32 v157, v157, v107
    v_add_f32 v157, v157, v108
    v_add_f32 v157, v157, v109
    v_add_f32 v157, v157, v110
    v_add_f32 v157, v157, v111
    v_cvt_pk_bf16_f32 v100, v104, v105
    v_cvt_pk_bf16_f32 v101, v106, v107
    v_cvt_pk_bf16_f32 v102, v108, v109
    v_cvt_pk_bf16_f32 v103, v110, v111
    s_setprio 1
    v_mfma_f32_32x32x16_bf16 v[0:15], v[112:115], v[96:99], v[0:15]
    v_mfma_f32_32x32x16_bf16 v[16:31], v[116:119], v[96:99], v[16:31]
    ds_read_b128 v[112:115], v144 offset:16384
    v_mfma_f32_32x32x16_bf16 v[32:47], v[120:123], v[96:99], v[32:47]
    ds_read_b128 v[116:119], v145 offset:16384
    v_mfma_f32_32x32x16_bf16 v[48:63], v[124:127], v[96:99], v[48:63]
    ds_read_b128 v[120:123], v146 offset:16384
    v_mfma_f32_32x32x16_bf16 v[0:15], v[128:131], v[100:103], v[0:15]
    ds_read_b128 v[124:127], v147 offset:16384
    v_mfma_f32_32x32x16_bf16 v[16:31], v[132:135], v[100:103], v[16:31]
    ds_read_b128 v[128:131], v148 offset:16384
    v_mfma_f32_32x32x16_bf16 v[32:47], v[136:139], v[100:103], v[32:47]
    ds_read_b128 v[132:135], v149 offset:16384
    v_mfma_f32_32x32x16_bf16 v[48:63], v[140:143], v[100:103], v[48:63]
    ds_read_b128 v[136:139], v150 offset:16384
    ds_read_b128 v[140:143], v151 offset:16384
    s_setprio 1
    s_waitcnt lgkmcnt(7)
    v_mfma_f32_32x32x16_bf16 v[96:111], v[112:115], v[64:67], 0
    s_waitcnt lgkmcnt(6)
    v_mfma_f32_32x32x16_bf16 v[96:111], v[116:119], v[68:71], v[96:111]
    ds_read_b64_tr_b16 v[112:113], v152 offset:8192
    ds_read_b64_tr_b16 v[114:115], v152 offset:10240
    s_waitcnt lgkmcnt(7)
    v_mfma_f32_32x32x16_bf16 v[96:111], v[120:123], v[72:75], v[96:111]
    ds_read_b64_tr_b16 v[116:117], v153 offset:8192
    ds_read_b64_tr_b16 v[118:119], v153 offset:10240
    s_waitcnt lgkmcnt(8)
    v_mfma_f32_32x32x16_bf16 v[96:111], v[124:127], v[76:79], v[96:111]
    ds_read_b64_tr_b16 v[120:121], v154 offset:8192
    ds_read_b64_tr_b16 v[122:123], v154 offset:10240
    s_waitcnt lgkmcnt(9)
    v_mfma_f32_32x32x16_bf16 v[96:111], v[128:131], v[80:83], v[96:111]
    ds_read_b64_tr_b16 v[124:125], v155 offset:8192
    ds_read_b64_tr_b16 v[126:127], v155 offset:10240
    s_waitcnt lgkmcnt(10)
    v_mfma_f32_32x32x16_bf16 v[96:111], v[132:135], v[84:87], v[96:111]
    ds_read_b64_tr_b16 v[128:129], v152 offset:12288
    ds_read_b64_tr_b16 v[130:131], v152 offset:14336
    s_waitcnt lgkmcnt(11)
    v_mfma_f32_32x32x16_bf16 v[96:111], v[136:139], v[88:91], v[96:111]
    ds_read_b64_tr_b16 v[132:133], v153 offset:12288
    ds_read_b64_tr_b16 v[134:135], v153 offset:14336
    s_waitcnt lgkmcnt(12)
    v_mfma_f32_32x32x16_bf16 v[96:111], v[140:143], v[92:95], v[96:111]
    ds_read_b64_tr_b16 v[136:137], v154 offset:12288
    ds_read_b64_tr_b16 v[138:139], v154 offset:14336
    ds_read_b64_tr_b16 v[140:141], v155 offset:12288
    ds_read_b64_tr_b16 v[142:143], v155 offset:14336
    s_waitcnt lgkmcnt(0)
    s_barrier
    s_setprio 3
    s_cmp_eq_u32 s28, 8
    s_cbranch_scc0 L_nw_6
    s_lshl_b32 s3, s58, 7
    s_add_u32 s3, s3, 8388608
    v_and_b32 v158, 15, v163
    v_lshlrev_b32 v158, 3, v158
    buffer_load_dwordx2 v[166:167], v158, s[24:27], s3 offen
L_nw_6:
    s_cmp_eq_u32 s28, 8
    s_cbranch_scc0 L_nx_7
    s_lshl_b32 s3, s58, 7
    s_add_u32 s3, s3, 8585216
    v_and_b32 v158, 7, v163
    v_lshlrev_b32 v158, 2, v158
    buffer_load_dword v158, v158, s[24:27], s3 offen sc1
L_nx_7:
    v_max3_f32 v160, v96, v97, v98
    v_max3_f32 v161, v99, v100, v101
    v_max3_f32 v160, v160, v102, v103
    v_max3_f32 v161, v161, v104, v105
    v_max3_f32 v160, v160, v106, v107
    v_max3_f32 v161, v161, v108, v109
    v_max3_f32 v160, v160, v110, v111
    v_max_f32 v160, v160, v161
    v_cmp_gt_f32 vcc, v160, v159
    s_nop 0
    s_or_b64 s[52:53], vcc, s[50:51]
    s_cbranch_scc0 L_C6
    s_call_b64 s[38:39], L_slow
L_C6:
    v_exp_f32 v96, v96
    v_exp_f32 v97, v97
    v_exp_f32 v98, v98
    v_exp_f32 v99, v99
    v_exp_f32 v100, v100
    v_exp_f32 v101, v101
    v_exp_f32 v102, v102
    v_exp_f32 v103, v103
    v_add_f32 v157, v157, v96
    v_add_f32 v157, v157, v97
    v_add_f32 v157, v157, v98
    v_add_f32 v157, v157, v99
    v_add_f32 v157, v157, v100
    v_add_f32 v157, v157, v101
    v_add_f32 v157, v157, v102
    v_add_f32 v157, v157, v103
    v_cvt_pk_bf16_f32 v96, v96, v97
    v_cvt_pk_bf16_f32 v97, v98, v99
    v_cvt_pk_bf16_f32 v98, v100, v101
    v_cvt_pk_bf16_f32 v99, v102, v103
    v_exp_f32 v104, v104
    v_exp_f32 v105, v105
    v_exp_f32 v106, v106
    v_exp_f32 v107, v107
    v_exp_f32 v108, v108
    v_exp_f32 v109, v109
    v_exp_f32 v110, v110
    v_exp_f32 v111, v111
    v_add_f32 v157, v157, v104
    v_add_f32 v157, v157, v105
    v_add_f32 v157, v157, v106
    v_add_f32 v157, v157, v107
    v_add_f32 v157, v157, v108
    v_add_f32 v157, v157, v109
    v_add_f32 v157, v157, v110
    v_add_f32 v157, v157, v111
    v_cvt_pk_bf16_f32 v100, v104, v105
    v_cvt_pk_bf16_f32 v101, v106, v107
    v_cvt_pk_bf16_f32 v102, v108, v109
    v_cvt_pk_bf16_f32 v103, v110, v111
    s_setprio 1
    v_mfma_f32_32x32x16_bf16 v[0:15], v[112:115], v[96:99], v[0:15]
    v_mfma_f32_32x32x16_bf16 v[16:31], v[116:119], v[96:99], v[16:31]
    ds_read_b128 v[112:115], v144 offset:0
    v_mfma_f32_32x32x16_bf16 v[32:47], v[120:123], v[96:99], v[32:47]
    ds_read_b128 v[116:119], v145 offset:0
    v_mfma_f32_32x32x16_bf16 v[48:63], v[124:127], v[96:99], v[48:63]
    ds_read_b128 v[120:123], v146 offset:0
    v_mfma_f32_32x32x16_bf16 v[0:15], v[128:131], v[100:103], v[0:15]
    ds_read_b128 v[124:127], v147 offset:0
    v_mfma_f32_32x32x16_bf16 v[16:31], v[132:135], v[100:103], v[16:31]
    ds_read_b128 v[128:131], v148 offset:0
    v_mfma_f32_32x32x16_bf16 v[32:47], v[136:139], v[100:103], v[32:47]
    ds_read_b128 v[132:135], v149 offset:0
    v_mfma_f32_32x32x16_bf16 v[48:63], v[140:143], v[100:103], v[48:63]
    ds_read_b128 v[136:139], v150 offset:0
    ds_read_b128 v[140:143], v151 offset:0
    s_lshl_b32 s3, 1, s33
    s_and_b32 s3, s3, 1
    s_cbranch_scc0 L_npf_8
    s_add_u32 s3, s45, 0
    buffer_load_dwordx2 v[166:167], v165, s[12:15], s3 offen
    s_add_u32 s3, s45, 65536
    buffer_load_dwordx2 v[166:167], v165, s[12:15], s3 offen
L_npf_8:
    s_setprio 1
    s_waitcnt lgkmcnt(7)
    v_mfma_f32_32x32x16_bf16 v[96:111], v[112:115], v[64:67], 0
    s_waitcnt lgkmcnt(6)
    v_mfma_f32_32x32x16_bf16 v[96:111], v[116:119], v[68:71], v[96:111]
    ds_read_b64_tr_b16 v[112:113], v152 offset:0
    ds_read_b64_tr_b16 v[114:115], v152 offset:2048
    s_waitcnt lgkmcnt(7)
    v_mfma_f32_32x32x16_bf16 v[96:111], v[120:123], v[72:75], v[96:111]
    ds_read_b64_tr_b16 v[116:117], v153 offset:0
    ds_read_b64_tr_b16 v[118:119], v153 offset:2048
    s_waitcnt lgkmcnt(8)
    v_mfma_f32_32x32x16_bf16 v[96:111], v[124:127], v[76:79], v[96:111]
    ds_read_b64_tr_b16 v[120:121], v154 offset:0
    ds_read_b64_tr_b16 v[122:123], v154 offset:2048
    s_waitcnt lgkmcnt(9)
    v_mfma_f32_32x32x16_bf16 v[96:111], v[128:131], v[80:83], v[96:111]
    ds_read_b64_tr_b16 v[124:125], v155 offset:0
    ds_read_b64_tr_b16 v[126:127], v155 offset:2048
    s_waitcnt lgkmcnt(10)
    v_mfma_f32_32x32x16_bf16 v[96:111], v[132:135], v[84:87], v[96:111]
    ds_read_b64_tr_b16 v[128:129], v152 offset:4096
    ds_read_b64_tr_b16 v[130:131], v152 offset:6144
    s_waitcnt lgkmcnt(11)
    v_mfma_f32_32x32x16_bf16 v[96:111], v[136:139], v[88:91], v[96:111]
    ds_read_b64_tr_b16 v[132:133], v153 offset:4096
    ds_read_b64_tr_b16 v[134:135], v153 offset:6144
    s_waitcnt lgkmcnt(12)
    v_mfma_f32_32x32x16_bf16 v[96:111], v[140:143], v[92:95], v[96:111]
    ds_read_b64_tr_b16 v[136:137], v154 offset:4096
    ds_read_b64_tr_b16 v[138:139], v154 offset:6144
    ds_read_b64_tr_b16 v[140:141], v155 offset:4096
    ds_read_b64_tr_b16 v[142:143], v155 offset:6144
    s_waitcnt lgkmcnt(0)
    s_barrier
    s_setprio 3
    s_nop 4
    v_max3_f32 v160, v96, v97, v98
    v_max3_f32 v161, v99, v100, v101
    v_max3_f32 v160, v160, v102, v103
    v_max3_f32 v161, v161, v104, v105
    v_max3_f32 v160, v160, v106, v107
    v_max3_f32 v161, v161, v108, v109
    v_max3_f32 v160, v160, v110, v111
    v_max_f32 v160, v160, v161
    v_cmp_gt_f32 vcc, v160, v159
    s_nop 0
    s_or_b64 s[52:53], vcc, s[50:51]
    s_cbranch_scc0 L_C7
    s_call_b64 s[38:39], L_slow
L_C7:
    v_exp_f32 v96, v96
    v_exp_f32 v97, v97
    v_exp_f32 v98, v98
    v_exp_f32 v99, v99
    v_exp_f32 v100, v100
    v_exp_f32 v101, v101
    v_exp_f32 v102, v102
    v_exp_f32 v103, v103
    v_add_f32 v157, v157, v96
    v_add_f32 v157, v157, v97
    v_add_f32 v157, v157, v98
    v_add_f32 v157, v157, v99
    v_add_f32 v157, v157, v100
    v_add_f32 v157, v157, v101
    v_add_f32 v157, v157, v102
    v_add_f32 v157, v157, v103
    v_cvt_pk_bf16_f32 v96, v96, v97
    v_cvt_pk_bf16_f32 v97, v98, v99
    v_cvt_pk_bf16_f32 v98, v100, v101
    v_cvt_pk_bf16_f32 v99, v102, v103
    v_exp_f32 v104, v104
    v_exp_f32 v105, v105
    v_exp_f32 v106, v106
    v_exp_f32 v107, v107
    v_exp_f32 v108, v108
    v_exp_f32 v109, v109
    v_exp_f32 v110, v110
    v_exp_f32 v111, v111
    v_add_f32 v157, v157, v104
    v_add_f32 v157, v157, v105
    v_add_f32 v157, v157, v106
    v_add_f32 v157, v157, v107
    v_add_f32 v157, v157, v108
    v_add_f32 v157, v157, v109
    v_add_f32 v157, v157, v110
    v_add_f32 v157, v157, v111
    v_cvt_pk_bf16_f32 v100, v104, v105
    v_cvt_pk_bf16_f32 v101, v106, v107
    v_cvt_pk_bf16_f32 v102, v108, v109
    v_cvt_pk_bf16_f32 v103, v110, v111
    s_setprio 1
    v_mfma_f32_32x32x16_bf16 v[0:15], v[112:115], v[96:99], v[0:15]
    v_mfma_f32_32x32x16_bf16 v[16:31], v[116:119], v[96:99], v[16:31]
    ds_read_b128 v[112:115], v144 offset:8192
    v_mfma_f32_32x32x16_bf16 v[32:47], v[120:123], v[96:99], v[32:47]
    ds_read_b128 v[116:119], v145 offset:8192
    v_mfma_f32_32x32x16_bf16 v[48:63], v[124:127], v[96:99], v[48:63]
    ds_read_b128 v[120:123], v146 offset:8192
    v_mfma_f32_32x32x16_bf16 v[0:15], v[128:131], v[100:103], v[0:15]
    ds_read_b128 v[124:127], v147 offset:8192
    v_mfma_f32_32x32x16_bf16 v[16:31], v[132:135], v[100:103], v[16:31]
    ds_read_b128 v[128:131], v148 offset:8192
    v_mfma_f32_32x32x16_bf16 v[32:47], v[136:139], v[100:103], v[32:47]
    ds_read_b128 v[132:135], v149 offset:8192
    v_mfma_f32_32x32x16_bf16 v[48:63], v[140:143], v[100:103], v[48:63]
    ds_read_b128 v[136:139], v150 offset:8192
    ds_read_b128 v[140:143], v151 offset:8192
    s_lshl_b32 s3, 1, s33
    s_and_b32 s3, s3, 2
    s_cbranch_scc0 L_npf_9
    s_add_u32 s3, s45, 0
    buffer_load_dwordx2 v[166:167], v165, s[12:15], s3 offen
    s_add_u32 s3, s45, 65536
    buffer_load_dwordx2 v[166:167], v165, s[12:15], s3 offen
L_npf_9:
    s_setprio 1
    s_waitcnt lgkmcnt(7)
    v_mfma_f32_32x32x16_bf16 v[96:111], v[112:115], v[64:67], 0
    s_waitcnt lgkmcnt(6)
    v_mfma_f32_32x32x16_bf16 v[96:111], v[116:119], v[68:71], v[96:111]
    ds_read_b64_tr_b16 v[112:113], v152 offset:8192
    ds_read_b64_tr_b16 v[114:115], v152 offset:10240
    s_waitcnt lgkmcnt(7)
    v_mfma_f32_32x32x16_bf16 v[96:111], v[120:123], v[72:75], v[96:111]
    ds_read_b64_tr_b16 v[116:117], v153 offset:8192
    ds_read_b64_tr_b16 v[118:119], v153 offset:10240
    s_waitcnt lgkmcnt(8)
    v_mfma_f32_32x32x16_bf16 v[96:111], v[124:127], v[76:79], v[96:111]
    ds_read_b64_tr_b16 v[120:121], v154 offset:8192
    ds_read_b64_tr_b16 v[122:123], v154 offset:10240
    s_waitcnt lgkmcnt(9)
    v_mfma_f32_32x32x16_bf16 v[96:111], v[128:131], v[80:83], v[96:111]
    ds_read_b64_tr_b16 v[124:125], v155 offset:8192
    ds_read_b64_tr_b16 v[126:127], v155 offset:10240
    s_waitcnt lgkmcnt(10)
    v_mfma_f32_32x32x16_bf16 v[96:111], v[132:135], v[84:87], v[96:111]
    ds_read_b64_tr_b16 v[128:129], v152 offset:12288
    ds_read_b64_tr_b16 v[130:131], v152 offset:14336
    s_waitcnt lgkmcnt(11)
    v_mfma_f32_32x32x16_bf16 v[96:111], v[136:139], v[88:91], v[96:111]
    ds_read_b64_tr_b16 v[132:133], v153 offset:12288
    ds_read_b64_tr_b16 v[134:135], v153 offset:14336
    s_waitcnt lgkmcnt(12)
    v_mfma_f32_32x32x16_bf16 v[96:111], v[140:143], v[92:95], v[96:111]
    ds_read_b64_tr_b16 v[136:137], v154 offset:12288
    ds_read_b64_tr_b16 v[138:139], v154 offset:14336
    ds_read_b64_tr_b16 v[140:141], v155 offset:12288
    ds_read_b64_tr_b16 v[142:143], v155 offset:14336
    s_waitcnt lgkmcnt(0)
    s_setprio 3
    s_lshl_b32 s3, 1, s33
    s_and_b32 s3, s3, 12
    s_cbranch_scc0 L_npf_10
    s_add_u32 s3, s45, 0
    buffer_load_dwordx2 v[166:167], v165, s[12:15], s3 offen
    s_add_u32 s3, s45, 65536
    buffer_load_dwordx2 v[166:167], v165, s[12:15], s3 offen
L_npf_10:
    v_max3_f32 v160, v96, v97, v98
    v_max3_f32 v161, v99, v100, v101
    v_max3_f32 v160, v160, v102, v103
    v_max3_f32 v161, v161, v104, v105
    v_max3_f32 v160, v160, v106, v107
    v_max3_f32 v161, v161, v108, v109
    v_max3_f32 v160, v160, v110, v111
    v_max_f32 v160, v160, v161
    v_cmp_gt_f32 vcc, v160, v159
    s_nop 0
    s_or_b64 s[52:53], vcc, s[50:51]
    s_cbranch_scc0 L_C8
    s_call_b64 s[38:39], L_slow
L_C8:
    v_exp_f32 v96, v96
    v_exp_f32 v97, v97
    v_exp_f32 v98, v98
    v_exp_f32 v99, v99
    v_exp_f32 v100, v100
    v_exp_f32 v101, v101
    v_exp_f32 v102, v102
    v_exp_f32 v103, v103
    v_add_f32 v157, v157, v96
    v_add_f32 v157, v157, v97
    v_add_f32 v157, v157, v98
    v_add_f32 v157, v157, v99
    v_add_f32 v157, v157, v100
    v_add_f32 v157, v157, v101
    v_add_f32 v157, v157, v102
    v_add_f32 v157, v157, v103
    v_cvt_pk_bf16_f32 v96, v96, v97
    v_cvt_pk_bf16_f32 v97, v98, v99
    v_cvt_pk_bf16_f32 v98, v100, v101
    v_cvt_pk_bf16_f32 v99, v102, v103
    v_exp_f32 v104, v104
    v_exp_f32 v105, v105
    v_exp_f32 v106, v106
    v_exp_f32 v107, v107
    v_exp_f32 v108, v108
    v_exp_f32 v109, v109
    v_exp_f32 v110, v110
    v_exp_f32 v111, v111
    v_add_f32 v157, v157, v104
    v_add_f32 v157, v157, v105
    v_add_f32 v157, v157, v106
    v_add_f32 v157, v157, v107
    v_add_f32 v157, v157, v108
    v_add_f32 v157, v157, v109
    v_add_f32 v157, v157, v110
    v_add_f32 v157, v157, v111
    v_cvt_pk_bf16_f32 v100, v104, v105
    v_cvt_pk_bf16_f32 v101, v106, v107
    v_cvt_pk_bf16_f32 v102, v108, v109
    v_cvt_pk_bf16_f32 v103, v110, v111
    s_setprio 1
    v_mfma_f32_32x32x16_bf16 v[0:15], v[112:115], v[96:99], v[0:15]
    v_lshlrev_b32 v64, 4, v163
    s_mul_i32 s76, s33, 40960
    s_add_u32 s3, s34, 1
    s_lshl_b32 s3, s3, 13
    s_cmp_eq_u32 s34, 0
    s_cselect_b32 s3, 0, s3
    v_mfma_f32_32x32x16_bf16 v[16:31], v[116:119], v[96:99], v[16:31]
    s_add_u32 s77, s76, s3
    v_add_u32 v80, s77, v64
    v_and_b32 v81, 31, v163
    v_lshlrev_b32 v81, 3, v81
    s_lshl_b32 s3, s34, 8
    s_add_u32 s3, s3, 6144
    v_mfma_f32_32x32x16_bf16 v[32:47], v[120:123], v[96:99], v[32:47]
    v_add_u32 v81, s3, v81
    v_add_u32 v68, s76, v81
    v_and_b32 v82, 31, v163
    s_lshl_b32 s3, s34, 5
    v_add_u32 v82, s3, v82
    v_cmp_le_u32 vcc, 48, v82
    v_mfma_f32_32x32x16_bf16 v[48:63], v[124:127], v[96:99], v[48:63]
    v_subrev_u32 v83, 48, v82
    v_lshrrev_b32 v84, 5, v163
    v_cndmask_b32 v79, v82, v83, vcc
    v_cndmask_b32 v78, 0, 1, vcc
    v_lshlrev_b32 v84, 8, v84
    s_and_b32 s3, s31, 1
    v_mfma_f32_32x32x16_bf16 v[0:15], v[128:131], v[100:103], v[0:15]
    s_mul_i32 s76, s3, 48
    s_xor_b32 s3, s3, 1
    s_mul_i32 s77, s3, 48
    v_add_u32 v82, s76, v79
    v_lshrrev_b32 v83, 4, v82
    v_lshlrev_b32 v83, 10, v83
    v_mfma_f32_32x32x16_bf16 v[16:31], v[132:135], v[100:103], v[16:31]
    v_and_b32 v82, 15, v82
    v_lshlrev_b32 v82, 4, v82
    v_add3_u32 v72, v82, v83, v84
    s_mul_i32 s3, s33, 6144
    v_mul_u32_u24 v82, 40960, v78
    v_add3_u32 v76, v72, v82, s3
    v_mfma_f32_32x32x16_bf16 v[32:47], v[136:139], v[100:103], v[32:47]
    v_mul_u32_u24 v82, 24576, v78
    v_add_u32 v72, v72, v82
    s_lshl_b32 s3, s32, 4
    s_lshl_b32 s76, s33, 1
    s_add_u32 s3, s3, s76
    s_mul_i32 s3, s3, 3072
    v_mfma_f32_32x32x16_bf16 v[48:63], v[140:143], v[100:103], v[48:63]
    s_mul_i32 s79, s58, 196608
    s_add_u32 s79, s79, s3
    s_add_u32 s79, s79, 0
L_merge:
    v_mov_b32 v160, v157
    v_mov_b32 v161, v157
    s_nop 1
    v_permlane32_swap_b32 v160, v161
    v_add_f32 v157, v160, v161
    v_cvt_pk_bf16_f32 v16, v16, v17
    v_cvt_pk_bf16_f32 v17, v18, v19
    v_cvt_pk_bf16_f32 v18, v20, v21
    v_cvt_pk_bf16_f32 v19, v22, v23
    v_cvt_pk_bf16_f32 v20, v24, v25
    v_cvt_pk_bf16_f32 v21, v26, v27
    v_cvt_pk_bf16_f32 v22, v28, v29
    v_cvt_pk_bf16_f32 v23, v30, v31
    ds_write_b128 v80, v[16:19] offset:0
    ds_write_b128 v80, v[20:23] offset:1024
    v_cvt_pk_bf16_f32 v32, v32, v33
    v_cvt_pk_bf16_f32 v33, v34, v35
    v_cvt_pk_bf16_f32 v34, v36, v37
    v_cvt_pk_bf16_f32 v35, v38, v39
    v_cvt_pk_bf16_f32 v36, v40, v41
    v_cvt_pk_bf16_f32 v37, v42, v43
    v_cvt_pk_bf16_f32 v38, v44, v45
    v_cvt_pk_bf16_f32 v39, v46, v47
    ds_write_b128 v80, v[32:35] offset:2048
    ds_write_b128 v80, v[36:39] offset:3072
    v_cvt_pk_bf16_f32 v48, v48, v49
    v_cvt_pk_bf16_f32 v49, v50, v51
    v_cvt_pk_bf16_f32 v50, v52, v53
    v_cvt_pk_bf16_f32 v51, v54, v55
    v_cvt_pk_bf16_f32 v52, v56, v57
    v_cvt_pk_bf16_f32 v53, v58, v59
    v_cvt_pk_bf16_f32 v54, v60, v61
    v_cvt_pk_bf16_f32 v55, v62, v63
    ds_write_b128 v80, v[48:51] offset:4096
    ds_write_b128 v80, v[52:55] offset:5120
    ds_write_b64 v68, v[156:157]
    s_sub_u32 s3, s33, 1
    s_and_b32 s3, s3, 3
    s_mul_i32 s76, s3, 40960
    v_add_u32 v65, s76, v81
    s_add_u32 s3, s34, 1
    s_lshl_b32 s3, s3, 13
    s_cmp_eq_u32 s34, 0
    s_cselect_b32 s3, 0, s3
    s_add_u32 s76, s76, s3
    v_add_u32 v69, s76, v64
    s_sub_u32 s3, s33, 2
    s_and_b32 s3, s3, 3
    s_mul_i32 s76, s3, 40960
    v_add_u32 v66, s76, v81
    s_add_u32 s3, s34, 1
    s_lshl_b32 s3, s3, 13
    s_cmp_eq_u32 s34, 0
    s_cselect_b32 s3, 0, s3
    s_add_u32 s76, s76, s3
    v_add_u32 v70, s76, v64
    s_sub_u32 s3, s33, 3
    s_and_b32 s3, s3, 3
    s_mul_i32 s76, s3, 40960
    v_add_u32 v67, s76, v81
    s_add_u32 s3, s34, 1
    s_lshl_b32 s3, s3, 13
    s_cmp_eq_u32 s34, 0
    s_cselect_b32 s3, 0, s3
    s_add_u32 s76, s76, s3
    v_add_u32 v71, s76, v64
    v_mov_b32 v73, 6912
    v_add_u32 v74, 30720, v64
    s_cmp_eq_u32 s28, 8
    s_cbranch_scc0 L_notokw
    s_mov_b32 s75, 0
L_tokchk:
    s_waitcnt vmcnt(0)
    v_readfirstlane_b32 s40, v164
    s_nop 0
    s_cmp_lg_u32 s40, 0
    s_cbranch_scc1 L_tokok
    v_mov_b32 v75, 0
    buffer_load_dword v164, v75, s[16:19], 0 offen sc1
    s_add_u32 s75, s75, 1
    s_cmp_lt_u32 s75, 262144
    s_cbranch_scc1 L_tokchk
L_tokok:
    s_getreg_b32 s3, hwreg(HW_REG_XCC_ID, 0, 4)
    s_add_u32 s3, s3, s40
    v_cmp_eq_u32 vcc, s3, v158
    v_mov_b32 v160, s40
    s_and_b32 s3, vcc_lo, 0xff
    s_cmp_eq_u32 s3, 0xff
    s_cselect_b32 s3, 1, 0
    v_mov_b32 v161, s3
    ds_write_b64 v73, v[160:161]
L_notokw:
    s_waitcnt lgkmcnt(0)
    s_barrier
    s_setprio 0
    ds_read_b64 v[140:141], v73
    ds_read_b64 v[114:115], v65
    ds_read_b64 v[116:117], v66
    ds_read_b64 v[118:119], v67
    ds_read_b128 v[88:91], v74 offset:0
    ds_read_b128 v[92:95], v74 offset:1024
    ds_read_b128 v[16:19], v69 offset:0
    ds_read_b128 v[20:23], v69 offset:1024
    ds_read_b128 v[32:35], v70 offset:2048
    ds_read_b128 v[36:39], v70 offset:3072
    ds_read_b128 v[48:51], v71 offset:4096
    ds_read_b128 v[52:55], v71 offset:5120
    s_waitcnt lgkmcnt(6)
    v_xor_b32 v120, v156, v114
    v_xor_b32 v121, v156, v116
    v_xor_b32 v122, v156, v118
    v_or3_b32 v120, v120, v121, v122
    v_readfirstlane_b32 s40, v140
    v_readfirstlane_b32 s5, v141
    v_cmp_ne_u32 vcc, 0, v120
    s_nop 0
    s_cmp_lg_u64 vcc, 0
    s_cbranch_scc1 L_mrg_gen
    v_add_f32 v130, v157, v115
    v_add_f32 v131, v117, v119
    v_add_f32 v130, v130, v131
    v_rcp_f32 v122, v130
    s_waitcnt lgkmcnt(4)
    v_mfma_f32_32x32x16_bf16 v[0:15], v[88:91], v[16:19], v[0:15]
    v_mfma_f32_32x32x16_bf16 v[0:15], v[92:95], v[20:23], v[0:15]
    s_waitcnt lgkmcnt(2)
    v_mfma_f32_32x32x16_bf16 v[0:15], v[88:91], v[32:35], v[0:15]
    v_mfma_f32_32x32x16_bf16 v[0:15], v[92:95], v[36:39], v[0:15]
    s_waitcnt lgkmcnt(0)
    v_mfma_f32_32x32x16_bf16 v[0:15], v[88:91], v[48:51], v[0:15]
    v_mfma_f32_32x32x16_bf16 v[0:15], v[92:95], v[52:55], v[0:15]
    s_nop 11
    v_mul_f32 v0, v0, v122
    v_mul_f32 v1, v1, v122
    v_mul_f32 v2, v2, v122
    v_mul_f32 v3, v3, v122
    v_mul_f32 v4, v4, v122
    v_mul_f32 v5, v5, v122
    v_mul_f32 v6, v6, v122
    v_mul_f32 v7, v7, v122
    v_mul_f32 v8, v8, v122
    v_mul_f32 v9, v9, v122
    v_mul_f32 v10, v10, v122
    v_mul_f32 v11, v11, v122
    v_mul_f32 v12, v12, v122
    v_mul_f32 v13, v13, v122
    v_mul_f32 v14, v14, v122
    v_mul_f32 v15, v15, v122
L_mrg_cvt:
    v_cvt_pk_bf16_f32 v132, v0, v1
    v_cvt_pk_bf16_f32 v133, v2, v3
    v_cvt_pk_bf16_f32 v134, v4, v5
    v_cvt_pk_bf16_f32 v135, v6, v7
    v_cvt_pk_bf16_f32 v136, v8, v9
    v_cvt_pk_bf16_f32 v137, v10, v11
    v_cvt_pk_bf16_f32 v138, v12, v13
    v_cvt_pk_bf16_f32 v139, v14, v15
    v_permlane32_swap_b32 v132, v134
    v_permlane32_swap_b32 v133, v135
    v_permlane32_swap_b32 v136, v138
    v_permlane32_swap_b32 v137, v139
    s_cmp_eq_u32 s5, 1
    s_cbranch_scc0 L_ost_g
    buffer_store_dwordx4 v[132:135], v72, s[24:27], s79 offen offset:0
    buffer_store_dwordx4 v[136:139], v72, s[24:27], s79 offen offset:512
    s_branch L_ost_done
L_ost_g:
    buffer_store_dwordx4 v[132:135], v72, s[24:27], s79 offen offset:0 sc1
    buffer_store_dwordx4 v[136:139], v72, s[24:27], s79 offen offset:512 sc1
L_ost_done:
    s_barrier
    s_getreg_b32 s39, hwreg(HW_REG_XCC_ID, 0, 4)
    s_add_u32 s39, s39, s40
    s_lshl_b32 s38, s58, 7
    s_lshl_b32 s3, s55, 2
    s_add_u32 s3, s3, s38
    s_add_u32 s60, s3, 8388608
    s_add_u32 s61, s3, 8454144
    v_mov_b32 v160, 0
    v_mov_b32 v161, s39
    v_mov_b32 v162, s40
    ds_write_b128 v76, v[132:135] offset:0
    ds_write_b128 v76, v[136:139] offset:512
    s_mov_b32 s8, s68
    s_mov_b32 s9, s69
    s_mov_b32 s10, 1572864
    s_mov_b32 s11, 0x00020000
    s_cmp_eq_u32 s29, 0
    s_cselect_b32 s12, s56, s66
    s_cselect_b32 s13, s57, s67
    s_mov_b32 s14, 8388608
    s_mov_b32 s15, 0x00020000
    s_lshl_b32 s45, s30, 21
    s_lshl_b32 s3, s55, 8
    s_add_u32 s45, s45, s3
    s_lshl_b32 s74, s32, 2
    v_lshrrev_b32 v152, 4, v163
    v_and_b32 v153, 15, v163
    v_lshlrev_b32 v154, 2, v152
    v_xor_b32 v154, v154, v153
    v_lshlrev_b32 v154, 4, v154
    v_lshlrev_b32 v152, 11, v152
    v_add_u32 v150, v152, v154
    v_xor_b32 v151, 32, v150
    s_lshl_b32 s41, s33, 15
    s_add_u32 s45, s45, s41
    s_lshl_b32 s43, s33, 12
    s_mul_i32 s46, s58, 196608
    s_add_u32 s46, s46, 0
    s_cmp_ge_u32 s28, 8
    s_cbranch_scc1 L_t_compute
    s_cmp_ge_u32 s28, 4
    s_cbranch_scc1 L_t_oload
    s_add_u32 s3, s74, 0
    s_and_b32 s3, s3, 15
    s_lshl_b32 s76, s3, 17
    s_add_u32 s76, s76, s45
    s_add_u32 m0, s43, 24576
    s_nop 0
    buffer_load_dwordx4 v150, s[12:15], s76 offen lds
    s_add_u32 s76, s76, 8192
    s_add_u32 m0, s43, 25600
    s_nop 0
    buffer_load_dwordx4 v150, s[12:15], s76 offen lds
    s_add_u32 s76, s76, 8192
    s_add_u32 m0, s43, 26624
    s_nop 0
    buffer_load_dwordx4 v151, s[12:15], s76 offen lds
    s_add_u32 s76, s76, 8192
    s_add_u32 m0, s43, 27648
    s_nop 0
    buffer_load_dwordx4 v151, s[12:15], s76 offen lds
    s_add_u32 s3, s74, 1
    s_and_b32 s3, s3, 15
    s_lshl_b32 s76, s3, 17
    s_add_u32 s76, s76, s45
    s_add_u32 m0, s43, 65536
    s_nop 0
    buffer_load_dwordx4 v150, s[12:15], s76 offen lds
    s_add_u32 s76, s76, 8192
    s_add_u32 m0, s43, 66560
    s_nop 0
    buffer_load_dwordx4 v150, s[12:15], s76 offen lds
    s_add_u32 s76, s76, 8192
    s_add_u32 m0, s43, 67584
    s_nop 0
    buffer_load_dwordx4 v151, s[12:15], s76 offen lds
    s_add_u32 s76, s76, 8192
    s_add_u32 m0, s43, 68608
    s_nop 0
    buffer_load_dwordx4 v151, s[12:15], s76 offen lds
    s_add_u32 s3, s74, 2
    s_and_b32 s3, s3, 15
    s_lshl_b32 s76, s3, 17
    s_add_u32 s76, s76, s45
    s_add_u32 m0, s43, 106496
    s_nop 0
    buffer_load_dwordx4 v150, s[12:15], s76 offen lds
    s_add_u32 s76, s76, 8192
    s_add_u32 m0, s43, 107520
    s_nop 0
    buffer_load_dwordx4 v150, s[12:15], s76 offen lds
    s_add_u32 s76, s76, 8192
    s_add_u32 m0, s43, 108544
    s_nop 0
    buffer_load_dwordx4 v151, s[12:15], s76 offen lds
    s_add_u32 s76, s76, 8192
    s_add_u32 m0, s43, 109568
    s_nop 0
    buffer_load_dwordx4 v151, s[12:15], s76 offen lds
    s_waitcnt vmcnt(12) lgkmcnt(0)
    s_barrier
    s_add_u32 s3, s74, 3
    s_and_b32 s3, s3, 15
    s_lshl_b32 s76, s3, 17
    s_add_u32 s76, s76, s45
    s_add_u32 m0, s43, 147456
    s_nop 0
    buffer_load_dwordx4 v150, s[12:15], s76 offen lds
    s_add_u32 s76, s76, 8192
    s_add_u32 m0, s43, 148480
    s_nop 0
    buffer_load_dwordx4 v150, s[12:15], s76 offen lds
    s_add_u32 s76, s76, 8192
    s_add_u32 m0, s43, 149504
    s_nop 0
    buffer_load_dwordx4 v151, s[12:15], s76 offen lds
    s_add_u32 s76, s76, 8192
    s_add_u32 m0, s43, 150528
    s_nop 0
    buffer_load_dwordx4 v151, s[12:15], s76 offen lds
    s_add_u32 s3, s74, 4
    s_and_b32 s3, s3, 15
    s_lshl_b32 s76, s3, 17
    s_add_u32 s76, s76, s45
    s_add_u32 m0, s43, 122880
    s_nop 0
    buffer_load_dwordx4 v150, s[12:15], s76 offen lds
    s_add_u32 s76, s76, 8192
    s_add_u32 m0, s43, 123904
    s_nop 0
    buffer_load_dwordx4 v150, s[12:15], s76 offen lds
    s_add_u32 s76, s76, 8192
    s_add_u32 m0, s43, 124928
    s_nop 0
    buffer_load_dwordx4 v151, s[12:15], s76 offen lds
    s_add_u32 s76, s76, 8192
    s_add_u32 m0, s43, 125952
    s_nop 0
    buffer_load_dwordx4 v151, s[12:15], s76 offen lds
    s_barrier
    s_waitcnt vmcnt(16)
    s_barrier
    s_waitcnt vmcnt(12)
    s_barrier
    s_waitcnt vmcnt(8)
    s_barrier
    s_add_u32 s3, s74, 5
    s_and_b32 s3, s3, 15
    s_lshl_b32 s76, s3, 17
    s_add_u32 s76, s76, s45
    s_add_u32 m0, s43, 24576
    s_nop 0
    buffer_load_dwordx4 v150, s[12:15], s76 offen lds
    s_add_u32 s76, s76, 8192
    s_add_u32 m0, s43, 25600
    s_nop 0
    buffer_load_dwordx4 v150, s[12:15], s76 offen lds
    s_add_u32 s76, s76, 8192
    s_add_u32 m0, s43, 26624
    s_nop 0
    buffer_load_dwordx4 v151, s[12:15], s76 offen lds
    s_add_u32 s76, s76, 8192
    s_add_u32 m0, s43, 27648
    s_nop 0
    buffer_load_dwordx4 v151, s[12:15], s76 offen lds
    s_waitcnt vmcnt(8)
    s_barrier
    s_add_u32 s3, s74, 6
    s_and_b32 s3, s3, 15
    s_lshl_b32 s76, s3, 17
    s_add_u32 s76, s76, s45
    s_add_u32 m0, s43, 65536
    s_nop 0
    buffer_load_dwordx4 v150, s[12:15], s76 offen lds
    s_add_u32 s76, s76, 8192
    s_add_u32 m0, s43, 66560
    s_nop 0
    buffer_load_dwordx4 v150, s[12:15], s76 offen lds
    s_add_u32 s76, s76, 8192
    s_add_u32 m0, s43, 67584
    s_nop 0
    buffer_load_dwordx4 v151, s[12:15], s76 offen lds
    s_add_u32 s76, s76, 8192
    s_add_u32 m0, s43, 68608
    s_nop 0
    buffer_load_dwordx4 v151, s[12:15], s76 offen lds
    s_waitcnt vmcnt(8)
    s_barrier
    s_add_u32 s3, s74, 7
    s_and_b32 s3, s3, 15
    s_lshl_b32 s76, s3, 17
    s_add_u32 s76, s76, s45
    s_add_u32 m0, s43, 106496
    s_nop 0
    buffer_load_dwordx4 v150, s[12:15], s76 offen lds
    s_add_u32 s76, s76, 8192
    s_add_u32 m0, s43, 107520
    s_nop 0
    buffer_load_dwordx4 v150, s[12:15], s76 offen lds
    s_add_u32 s76, s76, 8192
    s_add_u32 m0, s43, 108544
    s_nop 0
    buffer_load_dwordx4 v151, s[12:15], s76 offen lds
    s_add_u32 s76, s76, 8192
    s_add_u32 m0, s43, 109568
    s_nop 0
    buffer_load_dwordx4 v151, s[12:15], s76 offen lds
    s_waitcnt vmcnt(8)
    s_barrier
    s_add_u32 s3, s74, 8
    s_and_b32 s3, s3, 15
    s_lshl_b32 s76, s3, 17
    s_add_u32 s76, s76, s45
    s_add_u32 m0, s43, 147456
    s_nop 0
    buffer_load_dwordx4 v150, s[12:15], s76 offen lds
    s_add_u32 s76, s76, 8192
    s_add_u32 m0, s43, 148480
    s_nop 0
    buffer_load_dwordx4 v150, s[12:15], s76 offen lds
    s_add_u32 s76, s76, 8192
    s_add_u32 m0, s43, 149504
    s_nop 0
    buffer_load_dwordx4 v151, s[12:15], s76 offen lds
    s_add_u32 s76, s76, 8192
    s_add_u32 m0, s43, 150528
    s_nop 0
    buffer_load_dwordx4 v151, s[12:15], s76 offen lds
    s_waitcnt vmcnt(8)
    s_barrier
    s_add_u32 s3, s74, 9
    s_and_b32 s3, s3, 15
    s_lshl_b32 s76, s3, 17
    s_add_u32 s76, s76, s45
    s_add_u32 m0, s43, 122880
    s_nop 0
    buffer_load_dwordx4 v150, s[12:15], s76 offen lds
    s_add_u32 s76, s76, 8192
    s_add_u32 m0, s43, 123904
    s_nop 0
    buffer_load_dwordx4 v150, s[12:15], s76 offen lds
    s_add_u32 s76, s76, 8192
    s_add_u32 m0, s43, 124928
    s_nop 0
    buffer_load_dwordx4 v151, s[12:15], s76 offen lds
    s_add_u32 s76, s76, 8192
    s_add_u32 m0, s43, 125952
    s_nop 0
    buffer_load_dwordx4 v151, s[12:15], s76 offen lds
    s_waitcnt vmcnt(8)
    s_barrier
    s_add_u32 s3, s74, 10
    s_and_b32 s3, s3, 15
    s_lshl_b32 s76, s3, 17
    s_add_u32 s76, s76, s45
    s_add_u32 m0, s43, 24576
    s_nop 0
    buffer_load_dwordx4 v150, s[12:15], s76 offen lds
    s_add_u32 s76, s76, 8192
    s_add_u32 m0, s43, 25600
    s_nop 0
    buffer_load_dwordx4 v150, s[12:15], s76 offen lds
    s_add_u32 s76, s76, 8192
    s_add_u32 m0, s43, 26624
    s_nop 0
    buffer_load_dwordx4 v151, s[12:15], s76 offen lds
    s_add_u32 s76, s76, 8192
    s_add_u32 m0, s43, 27648
    s_nop 0
    buffer_load_dwordx4 v151, s[12:15], s76 offen lds
    s_waitcnt vmcnt(8)
    s_barrier
    s_add_u32 s3, s74, 11
    s_and_b32 s3, s3, 15
    s_lshl_b32 s76, s3, 17
    s_add_u32 s76, s76, s45
    s_add_u32 m0, s43, 65536
    s_nop 0
    buffer_load_dwordx4 v150, s[12:15], s76 offen lds
    s_add_u32 s76, s76, 8192
    s_add_u32 m0, s43, 66560
    s_nop 0
    buffer_load_dwordx4 v150, s[12:15], s76 offen lds
    s_add_u32 s76, s76, 8192
    s_add_u32 m0, s43, 67584
    s_nop 0
    buffer_load_dwordx4 v151, s[12:15], s76 offen lds
    s_add_u32 s76, s76, 8192
    s_add_u32 m0, s43, 68608
    s_nop 0
    buffer_load_dwordx4 v151, s[12:15], s76 offen lds
    s_waitcnt vmcnt(8)
    s_barrier
    s_add_u32 s3, s74, 12
    s_and_b32 s3, s3, 15
    s_lshl_b32 s76, s3, 17
    s_add_u32 s76, s76, s45
    s_add_u32 m0, s43, 106496
    s_nop 0
    buffer_load_dwordx4 v150, s[12:15], s76 offen lds
    s_add_u32 s76, s76, 8192
    s_add_u32 m0, s43, 107520
    s_nop 0
    buffer_load_dwordx4 v150, s[12:15], s76 offen lds
    s_add_u32 s76, s76, 8192
    s_add_u32 m0, s43, 108544
    s_nop 0
    buffer_load_dwordx4 v151, s[12:15], s76 offen lds
    s_add_u32 s76, s76, 8192
    s_add_u32 m0, s43, 109568
    s_nop 0
    buffer_load_dwordx4 v151, s[12:15], s76 offen lds
    s_waitcnt vmcnt(8)
    s_barrier
    s_add_u32 s3, s74, 13
    s_and_b32 s3, s3, 15
    s_lshl_b32 s76, s3, 17
    s_add_u32 s76, s76, s45
    s_add_u32 m0, s43, 147456
    s_nop 0
    buffer_load_dwordx4 v150, s[12:15], s76 offen lds
    s_add_u32 s76, s76, 8192
    s_add_u32 m0, s43, 148480
    s_nop 0
    buffer_load_dwordx4 v150, s[12:15], s76 offen lds
    s_add_u32 s76, s76, 8192
    s_add_u32 m0, s43, 149504
    s_nop 0
    buffer_load_dwordx4 v151, s[12:15], s76 offen lds
    s_add_u32 s76, s76, 8192
    s_add_u32 m0, s43, 150528
    s_nop 0
    buffer_load_dwordx4 v151, s[12:15], s76 offen lds
    s_waitcnt vmcnt(8)
    s_barrier
    s_add_u32 s3, s74, 14
    s_and_b32 s3, s3, 15
    s_lshl_b32 s76, s3, 17
    s_add_u32 s76, s76, s45
    s_add_u32 m0, s43, 122880
    s_nop 0
    buffer_load_dwordx4 v150, s[12:15], s76 offen lds
    s_add_u32 s76, s76, 8192
    s_add_u32 m0, s43, 123904
    s_nop 0
    buffer_load_dwordx4 v150, s[12:15], s76 offen lds
    s_add_u32 s76, s76, 8192
    s_add_u32 m0, s43, 124928
    s_nop 0
    buffer_load_dwordx4 v151, s[12:15], s76 offen lds
    s_add_u32 s76, s76, 8192
    s_add_u32 m0, s43, 125952
    s_nop 0
    buffer_load_dwordx4 v151, s[12:15], s76 offen lds
    s_waitcnt vmcnt(8)
    s_barrier
    s_add_u32 s3, s74, 15
    s_and_b32 s3, s3, 15
    s_lshl_b32 s76, s3, 17
    s_add_u32 s76, s76, s45
    s_add_u32 m0, s43, 24576
    s_nop 0
    buffer_load_dwordx4 v150, s[12:15], s76 offen lds
    s_add_u32 s76, s76, 8192
    s_add_u32 m0, s43, 25600
    s_nop 0
    buffer_load_dwordx4 v150, s[12:15], s76 offen lds
    s_add_u32 s76, s76, 8192
    s_add_u32 m0, s43, 26624
    s_nop 0
    buffer_load_dwordx4 v151, s[12:15], s76 offen lds
    s_add_u32 s76, s76, 8192
    s_add_u32 m0, s43, 27648
    s_nop 0
    buffer_load_dwordx4 v151, s[12:15], s76 offen lds
    s_waitcnt vmcnt(8)
    s_barrier
    s_waitcnt vmcnt(4)
    s_barrier
    s_waitcnt vmcnt(0)
    s_barrier
    s_branch L_t_join
L_t_oload:
    s_cmp_eq_u32 s28, 7
    s_cbranch_scc1 L_t_poll
    v_lshlrev_b32 v115, 4, v163
    s_sub_u32 s63, s28, 4
    s_lshl_b32 s63, s63, 12
    s_add_u32 s46, s46, s63
    s_sub_u32 s62, s46, s63
    s_and_b32 s3, s31, 1
    s_xor_b32 s3, s3, 1
    s_mul_i32 s3, s3, 3072
    s_sub_u32 s76, s28, 4
    s_mov_b32 s65, 6144
    s_cmp_eq_u32 s76, 0
    s_cselect_b32 s64, 0, 2048
    s_cselect_b32 s65, 1024, s65
    s_cmp_eq_u32 s76, 2
    s_cselect_b32 s64, 7168, s64
    s_cselect_b32 s65, 8192, s65
    s_add_u32 s64, s64, s3
    s_add_u32 s65, s65, s3
    s_waitcnt vmcnt(0) lgkmcnt(0)
    s_barrier
    s_barrier
    s_add_u32 s3, s74, 0
    s_and_b32 s3, s3, 15
    s_mul_i32 s76, s3, 12288
    s_add_u32 s76, s76, s62
    s_add_u32 m0, s64, 0
    s_add_u32 s77, s76, s64
    buffer_load_dwordx4 v115, s[24:27], s77 offen sc1 lds
    s_add_u32 m0, s65, 0
    s_add_u32 s77, s76, s65
    buffer_load_dwordx4 v115, s[24:27], s77 offen sc1 lds
    s_add_u32 s3, s74, 1
    s_and_b32 s3, s3, 15
    s_mul_i32 s76, s3, 12288
    s_add_u32 s76, s76, s62
    s_add_u32 m0, s64, 12288
    s_add_u32 s77, s76, s64
    buffer_load_dwordx4 v115, s[24:27], s77 offen sc1 lds
    s_add_u32 m0, s65, 12288
    s_add_u32 s77, s76, s65
    buffer_load_dwordx4 v115, s[24:27], s77 offen sc1 lds
    s_add_u32 s3, s74, 2
    s_and_b32 s3, s3, 15
    s_mul_i32 s76, s3, 12288
    s_add_u32 s76, s76, s62
    s_add_u32 m0, s64, 40960
    s_add_u32 s77, s76, s64
    buffer_load_dwordx4 v115, s[24:27], s77 offen sc1 lds
    s_add_u32 m0, s65, 40960
    s_add_u32 s77, s76, s65
    buffer_load_dwordx4 v115, s[24:27], s77 offen sc1 lds
    s_add_u32 s3, s74, 3
    s_and_b32 s3, s3, 15
    s_mul_i32 s76, s3, 12288
    s_add_u32 s76, s76, s62
    s_add_u32 m0, s64, 53248
    s_add_u32 s77, s76, s64
    buffer_load_dwordx4 v115, s[24:27], s77 offen sc1 lds
    s_add_u32 m0, s65, 53248
    s_add_u32 s77, s76, s65
    buffer_load_dwordx4 v115, s[24:27], s77 offen sc1 lds
    s_waitcnt vmcnt(6)
    s_barrier
    s_waitcnt vmcnt(4)
    s_barrier
    s_add_u32 s3, s74, 4
    s_and_b32 s3, s3, 15
    s_mul_i32 s76, s3, 12288
    s_add_u32 s76, s76, s46
    s_add_u32 m0, s63, 81920
    s_nop 0
    buffer_load_dwordx4 v115, s[24:27], s76 offen offset:0 sc1 lds
    buffer_load_dwordx4 v115, s[24:27], s76 offen offset:1024 sc1 lds
    buffer_load_dwordx4 v115, s[24:27], s76 offen offset:2048 sc1 lds
    buffer_load_dwordx4 v115, s[24:27], s76 offen offset:3072 sc1 lds
    s_waitcnt vmcnt(6)
    s_barrier
    s_add_u32 s3, s74, 5
    s_and_b32 s3, s3, 15
    s_mul_i32 s76, s3, 12288
    s_add_u32 s76, s76, s46
    s_add_u32 m0, s63, 0
    s_nop 0
    buffer_load_dwordx4 v115, s[24:27], s76 offen offset:0 sc1 lds
    buffer_load_dwordx4 v115, s[24:27], s76 offen offset:1024 sc1 lds
    buffer_load_dwordx4 v115, s[24:27], s76 offen offset:2048 sc1 lds
    buffer_load_dwordx4 v115, s[24:27], s76 offen offset:3072 sc1 lds
    s_waitcnt vmcnt(8)
    s_barrier
    s_add_u32 s3, s74, 6
    s_and_b32 s3, s3, 15
    s_mul_i32 s76, s3, 12288
    s_add_u32 s76, s76, s46
    s_add_u32 m0, s63, 12288
    s_nop 0
    buffer_load_dwordx4 v115, s[24:27], s76 offen offset:0 sc1 lds
    buffer_load_dwordx4 v115, s[24:27], s76 offen offset:1024 sc1 lds
    buffer_load_dwordx4 v115, s[24:27], s76 offen offset:2048 sc1 lds
    buffer_load_dwordx4 v115, s[24:27], s76 offen offset:3072 sc1 lds
    s_waitcnt vmcnt(8)
    s_barrier
    s_add_u32 s3, s74, 7
    s_and_b32 s3, s3, 15
    s_mul_i32 s76, s3, 12288
    s_add_u32 s76, s76, s46
    s_add_u32 m0, s63, 40960
    s_nop 0
    buffer_load_dwordx4 v115, s[24:27], s76 offen offset:0 sc1 lds
    buffer_load_dwordx4 v115, s[24:27], s76 offen offset:1024 sc1 lds
    buffer_load_dwordx4 v115, s[24:27], s76 offen offset:2048 sc1 lds
    buffer_load_dwordx4 v115, s[24:27], s76 offen offset:3072 sc1 lds
    s_waitcnt vmcnt(8)
    s_barrier
    s_add_u32 s3, s74, 8
    s_and_b32 s3, s3, 15
    s_mul_i32 s76, s3, 12288
    s_add_u32 s76, s76, s46
    s_add_u32 m0, s63, 53248
    s_nop 0
    buffer_load_dwordx4 v115, s[24:27], s76 offen offset:0 sc1 lds
    buffer_load_dwordx4 v115, s[24:27], s76 offen offset:1024 sc1 lds
    buffer_load_dwordx4 v115, s[24:27], s76 offen offset:2048 sc1 lds
    buffer_load_dwordx4 v115, s[24:27], s76 offen offset:3072 sc1 lds
    s_waitcnt vmcnt(8)
    s_barrier
    s_add_u32 s3, s74, 9
    s_and_b32 s3, s3, 15
    s_mul_i32 s76, s3, 12288
    s_add_u32 s76, s76, s46
    s_add_u32 m0, s63, 81920
    s_nop 0
    buffer_load_dwordx4 v115, s[24:27], s76 offen offset:0 sc1 lds
    buffer_load_dwordx4 v115, s[24:27], s76 offen offset:1024 sc1 lds
    buffer_load_dwordx4 v115, s[24:27], s76 offen offset:2048 sc1 lds
    buffer_load_dwordx4 v115, s[24:27], s76 offen offset:3072 sc1 lds
    s_waitcnt vmcnt(8)
    s_barrier
    s_add_u32 s3, s74, 10
    s_and_b32 s3, s3, 15
    s_mul_i32 s76, s3, 12288
    s_add_u32 s76, s76, s46
    s_add_u32 m0, s63, 0
    s_nop 0
    buffer_load_dwordx4 v115, s[24:27], s76 offen offset:0 sc1 lds
    buffer_load_dwordx4 v115, s[24:27], s76 offen offset:1024 sc1 lds
    buffer_load_dwordx4 v115, s[24:27], s76 offen offset:2048 sc1 lds
    buffer_load_dwordx4 v115, s[24:27], s76 offen offset:3072 sc1 lds
    s_waitcnt vmcnt(8)
    s_barrier
    s_add_u32 s3, s74, 11
    s_and_b32 s3, s3, 15
    s_mul_i32 s76, s3, 12288
    s_add_u32 s76, s76, s46
    s_add_u32 m0, s63, 12288
    s_nop 0
    buffer_load_dwordx4 v115, s[24:27], s76 offen offset:0 sc1 lds
    buffer_load_dwordx4 v115, s[24:27], s76 offen offset:1024 sc1 lds
    buffer_load_dwordx4 v115, s[24:27], s76 offen offset:2048 sc1 lds
    buffer_load_dwordx4 v115, s[24:27], s76 offen offset:3072 sc1 lds
    s_waitcnt vmcnt(8)
    s_barrier
    s_add_u32 s3, s74, 12
    s_and_b32 s3, s3, 15
    s_mul_i32 s76, s3, 12288
    s_add_u32 s76, s76, s46
    s_add_u32 m0, s63, 40960
    s_nop 0
    buffer_load_dwordx4 v115, s[24:27], s76 offen offset:0 sc1 lds
    buffer_load_dwordx4 v115, s[24:27], s76 offen offset:1024 sc1 lds
    buffer_load_dwordx4 v115, s[24:27], s76 offen offset:2048 sc1 lds
    buffer_load_dwordx4 v115, s[24:27], s76 offen offset:3072 sc1 lds
    s_waitcnt vmcnt(8)
    s_barrier
    s_add_u32 s3, s74, 13
    s_and_b32 s3, s3, 15
    s_mul_i32 s76, s3, 12288
    s_add_u32 s76, s76, s46
    s_add_u32 m0, s63, 53248
    s_nop 0
    buffer_load_dwordx4 v115, s[24:27], s76 offen offset:0 sc1 lds
    buffer_load_dwordx4 v115, s[24:27], s76 offen offset:1024 sc1 lds
    buffer_load_dwordx4 v115, s[24:27], s76 offen offset:2048 sc1 lds
    buffer_load_dwordx4 v115, s[24:27], s76 offen offset:3072 sc1 lds
    s_waitcnt vmcnt(8)
    s_barrier
    s_add_u32 s3, s74, 14
    s_and_b32 s3, s3, 15
    s_mul_i32 s76, s3, 12288
    s_add_u32 s76, s76, s46
    s_add_u32 m0, s63, 81920
    s_nop 0
    buffer_load_dwordx4 v115, s[24:27], s76 offen offset:0 sc1 lds
    buffer_load_dwordx4 v115, s[24:27], s76 offen offset:1024 sc1 lds
    buffer_load_dwordx4 v115, s[24:27], s76 offen offset:2048 sc1 lds
    buffer_load_dwordx4 v115, s[24:27], s76 offen offset:3072 sc1 lds
    s_waitcnt vmcnt(8)
    s_barrier
    s_add_u32 s3, s74, 15
    s_and_b32 s3, s3, 15
    s_mul_i32 s76, s3, 12288
    s_add_u32 s76, s76, s46
    s_add_u32 m0, s63, 0
    s_nop 0
    buffer_load_dwordx4 v115, s[24:27], s76 offen offset:0 sc1 lds
    buffer_load_dwordx4 v115, s[24:27], s76 offen offset:1024 sc1 lds
    buffer_load_dwordx4 v115, s[24:27], s76 offen offset:2048 sc1 lds
    buffer_load_dwordx4 v115, s[24:27], s76 offen offset:3072 sc1 lds
    s_waitcnt vmcnt(8)
    s_barrier
    s_waitcnt vmcnt(4)
    s_barrier
    s_waitcnt vmcnt(0)
    s_barrier
    s_branch L_t_join
L_t_poll:
    v_and_b32 v118, 7, v163
    v_lshlrev_b32 v118, 2, v118
    v_mov_b32 v116, 0
    v_mov_b32 v117, 0
    s_add_u32 s65, s38, 8454144
    s_add_u32 s64, s38, 8388608
    s_waitcnt vmcnt(0) lgkmcnt(0)
    s_barrier
    s_add_u32 s3, s32, 0
    s_and_b32 s3, s3, 3
    s_lshl_b32 s62, 0x11, s3
    s_xor_b32 s3, s55, 4
    s_lshl_b32 s62, 1, s3
    buffer_load_dword v116, v118, s[24:27], s64 offen sc1
    s_mov_b32 s75, 0
L_pp:
    s_waitcnt vmcnt(0)
    v_cmp_eq_u32 vcc, s39, v116
    s_nop 0
    s_and_b32 s77, vcc_lo, s62
    s_cmp_eq_u32 s77, s62
    s_cbranch_scc1 L_pp_ok
    buffer_load_dword v116, v118, s[24:27], s64 offen sc1
    s_add_u32 s75, s75, 1
    s_cmp_lt_u32 s75, 4
    s_cbranch_scc1 L_pp
    s_mov_b32 s75, 0
L_og0:
    buffer_load_dword v116, v118, s[24:27], s64 offen sc1
    s_waitcnt vmcnt(0)
    v_cmp_eq_u32 vcc, s39, v116
    s_nop 0
    s_and_b32 s77, vcc_lo, s62
    s_cmp_eq_u32 s77, s62
    s_cbranch_scc1 L_og0_ok
    s_add_u32 s75, s75, 1
    s_and_b32 s3, s75, 7
    s_cbranch_scc1 L_og0_nog
    s_mov_b64 exec, 1
    buffer_store_dword v162, v160, s[24:27], s61 offen sc1
    s_mov_b64 exec, -1
    buffer_load_dword v117, v118, s[24:27], s65 offen sc1
    s_waitcnt vmcnt(0)
    v_cmp_eq_u32 vcc, s40, v117
    s_nop 0
    s_and_b32 s77, vcc_lo, s62
    s_cmp_eq_u32 s77, s62
    s_cbranch_scc1 L_og0_ok
L_og0_nog:
    s_cmp_lt_u32 s75, 262144
    s_cbranch_scc1 L_og0
L_og0_ok:
L_pp_ok:
    s_barrier
    buffer_load_dword v116, v118, s[24:27], s64 offen sc1
    s_barrier
    s_add_u32 s3, s32, 1
    s_and_b32 s3, s3, 3
    s_lshl_b32 s62, 0x11, s3
    v_cmp_eq_u32 vcc, s39, v116
    s_nop 0
    s_and_b32 s77, vcc_lo, s62
    s_cmp_eq_u32 s77, s62
    s_cbranch_scc1 L_og1_ok
    s_waitcnt vmcnt(0)
    v_cmp_eq_u32 vcc, s39, v116
    s_nop 0
    s_and_b32 s77, vcc_lo, s62
    s_cmp_eq_u32 s77, s62
    s_cbranch_scc1 L_og1_ok
    s_mov_b32 s75, 0
L_og1:
    buffer_load_dword v116, v118, s[24:27], s64 offen sc1
    s_waitcnt vmcnt(0)
    v_cmp_eq_u32 vcc, s39, v116
    s_nop 0
    s_and_b32 s77, vcc_lo, s62
    s_cmp_eq_u32 s77, s62
    s_cbranch_scc1 L_og1_ok
    s_add_u32 s75, s75, 1
    s_and_b32 s3, s75, 7
    s_cbranch_scc1 L_og1_nog
    s_mov_b64 exec, 1
    buffer_store_dword v162, v160, s[24:27], s61 offen sc1
    s_mov_b64 exec, -1
    buffer_load_dword v117, v118, s[24:27], s65 offen sc1
    s_waitcnt vmcnt(0)
    v_cmp_eq_u32 vcc, s40, v117
    s_nop 0
    s_and_b32 s77, vcc_lo, s62
    s_cmp_eq_u32 s77, s62
    s_cbranch_scc1 L_og1_ok
L_og1_nog:
    s_cmp_lt_u32 s75, 262144
    s_cbranch_scc1 L_og1
L_og1_ok:
    s_barrier
    s_barrier
    s_barrier
    buffer_load_dword v116, v118, s[24:27], s64 offen sc1
    s_barrier
    s_add_u32 s3, s32, 2
    s_and_b32 s3, s3, 3
    s_lshl_b32 s62, 0x11, s3
    v_cmp_eq_u32 vcc, s39, v116
    s_nop 0
    s_and_b32 s77, vcc_lo, s62
    s_cmp_eq_u32 s77, s62
    s_cbranch_scc1 L_og2_ok
    s_waitcnt vmcnt(0)
    v_cmp_eq_u32 vcc, s39, v116
    s_nop 0
    s_and_b32 s77, vcc_lo, s62
    s_cmp_eq_u32 s77, s62
    s_cbranch_scc1 L_og2_ok
    s_mov_b32 s75, 0
L_og2:
    buffer_load_dword v116, v118, s[24:27], s64 offen sc1
    s_waitcnt vmcnt(0)
    v_cmp_eq_u32 vcc, s39, v116
    s_nop 0
    s_and_b32 s77, vcc_lo, s62
    s_cmp_eq_u32 s77, s62
    s_cbranch_scc1 L_og2_ok
    s_add_u32 s75, s75, 1
    s_and_b32 s3, s75, 7
    s_cbranch_scc1 L_og2_nog
    s_mov_b64 exec, 1
    buffer_store_dword v162, v160, s[24:27], s61 offen sc1
    s_mov_b64 exec, -1
    buffer_load_dword v117, v118, s[24:27], s65 offen sc1
    s_waitcnt vmcnt(0)
    v_cmp_eq_u32 vcc, s40, v117
    s_nop 0
    s_and_b32 s77, vcc_lo, s62
    s_cmp_eq_u32 s77, s62
    s_cbranch_scc1 L_og2_ok
L_og2_nog:
    s_cmp_lt_u32 s75, 262144
    s_cbranch_scc1 L_og2
L_og2_ok:
    s_barrier
    s_barrier
    s_barrier
    buffer_load_dword v116, v118, s[24:27], s64 offen sc1
    s_barrier
    s_add_u32 s3, s32, 3
    s_and_b32 s3, s3, 3
    s_lshl_b32 s62, 0x11, s3
    v_cmp_eq_u32 vcc, s39, v116
    s_nop 0
    s_and_b32 s77, vcc_lo, s62
    s_cmp_eq_u32 s77, s62
    s_cbranch_scc1 L_og3_ok
    s_waitcnt vmcnt(0)
    v_cmp_eq_u32 vcc, s39, v116
    s_nop 0
    s_and_b32 s77, vcc_lo, s62
    s_cmp_eq_u32 s77, s62
    s_cbranch_scc1 L_og3_ok
    s_mov_b32 s75, 0
L_og3:
    buffer_load_dword v116, v118, s[24:27], s64 offen sc1
    s_waitcnt vmcnt(0)
    v_cmp_eq_u32 vcc, s39, v116
    s_nop 0
    s_and_b32 s77, vcc_lo, s62
    s_cmp_eq_u32 s77, s62
    s_cbranch_scc1 L_og3_ok
    s_add_u32 s75, s75, 1
    s_and_b32 s3, s75, 7
    s_cbranch_scc1 L_og3_nog
    s_mov_b64 exec, 1
    buffer_store_dword v162, v160, s[24:27], s61 offen sc1
    s_mov_b64 exec, -1
    buffer_load_dword v117, v118, s[24:27], s65 offen sc1
    s_waitcnt vmcnt(0)
    v_cmp_eq_u32 vcc, s40, v117
    s_nop 0
    s_and_b32 s77, vcc_lo, s62
    s_cmp_eq_u32 s77, s62
    s_cbranch_scc1 L_og3_ok
L_og3_nog:
    s_cmp_lt_u32 s75, 262144
    s_cbranch_scc1 L_og3
L_og3_ok:
    s_barrier
    s_barrier
    s_barrier
    s_barrier
    s_barrier
    s_barrier
    s_barrier
    s_lshl_b32 s3, s59, 2
    s_add_u32 s3, s3, s30
    s_lshl_b32 s76, s3, 7
    s_add_u32 s76, s76, 8519680
    v_and_b32 v118, 3, v163
    v_lshlrev_b32 v118, 2, v118
    s_lshl_b32 s62, 1, s30
    s_xor_b32 s62, s62, 15
    s_mov_b32 s75, 0
    buffer_load_dword v124, v118, s[24:27], s76 offen sc1
L_spin_b:
    s_waitcnt vmcnt(0)
    v_cmp_eq_u32 vcc, s40, v124
    s_nop 0
    s_and_b32 s77, vcc_lo, s62
    s_cmp_eq_u32 s77, s62
    s_cbranch_scc1 L_t_join
    buffer_load_dword v124, v118, s[24:27], s76 offen sc1
    s_add_u32 s75, s75, 1
    s_cmp_lt_u32 s75, 262144
    s_cbranch_scc1 L_spin_b
    s_branch L_t_join
L_t_compute:
    s_waitcnt vmcnt(0) lgkmcnt(0)
    s_barrier
    s_cmp_eq_u32 s28, 8
    s_cbranch_scc0 L_noflag
    s_mov_b64 exec, 1
    buffer_store_dword v161, v160, s[24:27], s60 offen
    s_mov_b64 exec, -1
L_noflag:
    v_lshrrev_b32 v116, 5, v163
    v_lshlrev_b32 v116, 3, v116
    v_bfe_u32 v117, v163, 2, 2
    v_add_u32 v116, v116, v117
    v_lshlrev_b32 v116, 8, v116
    v_bfe_u32 v118, v163, 4, 1
    v_lshlrev_b32 v118, 5, v118
    v_add_u32 v116, v116, v118
    v_and_b32 v118, 3, v163
    v_lshlrev_b32 v118, 3, v118
    v_add_u32 v116, v116, v118
    v_xor_b32 v118, s33, v117
    v_lshlrev_b32 v118, 6, v118
    v_add_u32 v112, v116, v118
    v_lshlrev_b32 v113, 4, v163
    v_lshrrev_b32 v116, 4, v163
    v_lshlrev_b32 v118, 3, v116
    v_bfe_u32 v117, v163, 2, 2
    v_add_u32 v118, v118, v117
    v_lshlrev_b32 v118, 8, v118
    v_and_b32 v116, 1, v116
    v_lshlrev_b32 v116, 5, v116
    v_add_u32 v118, v118, v116
    v_and_b32 v116, 3, v163
    v_lshlrev_b32 v116, 3, v116
    v_add_u32 v118, v118, v116
    v_xor_b32 v117, s33, v117
    v_lshlrev_b32 v117, 6, v117
    v_add_u32 v112, v118, v117
    v_xor_b32 v123, 32, v112
    v_add_u32 v124, 0x10000, v123
    v_add_u32 v125, 122880, v123
    v_add_u32 v120, 0x10000, v112
    v_add_u32 v121, 122880, v112
    v_add_u32 v122, 81920, v113
    v_mov_b32 v0, 0
    v_mov_b32 v1, 0
    v_mov_b32 v2, 0
    v_mov_b32 v3, 0
    v_mov_b32 v4, 0
    v_mov_b32 v5, 0
    v_mov_b32 v6, 0
    v_mov_b32 v7, 0
    v_mov_b32 v8, 0
    v_mov_b32 v9, 0
    v_mov_b32 v10, 0
    v_mov_b32 v11, 0
    v_mov_b32 v12, 0
    v_mov_b32 v13, 0
    v_mov_b32 v14, 0
    v_mov_b32 v15, 0
    v_mov_b32 v16, 0
    v_mov_b32 v17, 0
    v_mov_b32 v18, 0
    v_mov_b32 v19, 0
    v_mov_b32 v20, 0
    v_mov_b32 v21, 0
    v_mov_b32 v22, 0
    v_mov_b32 v23, 0
    v_mov_b32 v24, 0
    v_mov_b32 v25, 0
    v_mov_b32 v26, 0
    v_mov_b32 v27, 0
    v_mov_b32 v28, 0
    v_mov_b32 v29, 0
    v_mov_b32 v30, 0
    v_mov_b32 v31, 0
    v_mov_b32 v32, 0
    v_mov_b32 v33, 0
    v_mov_b32 v34, 0
    v_mov_b32 v35, 0
    v_mov_b32 v36, 0
    v_mov_b32 v37, 0
    v_mov_b32 v38, 0
    v_mov_b32 v39, 0
    v_mov_b32 v40, 0
    v_mov_b32 v41, 0
    v_mov_b32 v42, 0
    v_mov_b32 v43, 0
    v_mov_b32 v44, 0
    v_mov_b32 v45, 0
    v_mov_b32 v46, 0
    v_mov_b32 v47, 0
    v_lshlrev_b32 v117, 4, v163
    v_add_u32 v116, 94208, v117
    s_lshl_b32 s3, s59, 2
    s_add_u32 s3, s3, s33
    s_lshl_b32 s72, s3, 7
    s_lshl_b32 s3, s3, 2
    s_add_u32 s3, s3, s30
    s_mul_i32 s70, s3, 6144
    s_add_u32 s70, s70, 16777216
    s_add_u32 s71, s70, 4096
    s_lshl_b32 s3, s30, 2
    s_add_u32 s72, s72, s3
    s_add_u32 s72, s72, 8519680
    s_barrier
    s_barrier
    ds_read_b64_tr_b16 v[48:49], v112 offset:24576
    ds_read_b64_tr_b16 v[50:51], v112 offset:25600
    ds_read_b64_tr_b16 v[52:53], v123 offset:24576
    ds_read_b64_tr_b16 v[54:55], v123 offset:25600
    ds_read_b128 v[56:59], v113 offset:0
    ds_read_b128 v[60:63], v113 offset:1024
    ds_read_b128 v[64:67], v113 offset:2048
    ds_read_b128 v[68:71], v113 offset:3072
    ds_read_b128 v[72:75], v113 offset:4096
    ds_read_b128 v[76:79], v113 offset:5120
    s_waitcnt lgkmcnt(5)
    v_mfma_f32_16x16x32_bf16 v[0:3], v[48:51], v[56:59], v[0:3]
    ds_read_b64_tr_b16 v[80:81], v112 offset:32768
    v_mfma_f32_16x16x32_bf16 v[4:7], v[52:55], v[56:59], v[4:7]
    ds_read_b64_tr_b16 v[82:83], v112 offset:33792
    s_waitcnt lgkmcnt(6)
    v_mfma_f32_16x16x32_bf16 v[8:11], v[48:51], v[60:63], v[8:11]
    ds_read_b64_tr_b16 v[84:85], v123 offset:32768
    v_mfma_f32_16x16x32_bf16 v[12:15], v[52:55], v[60:63], v[12:15]
    ds_read_b64_tr_b16 v[86:87], v123 offset:33792
    s_waitcnt lgkmcnt(7)
    v_mfma_f32_16x16x32_bf16 v[16:19], v[48:51], v[64:67], v[16:19]
    ds_read_b128 v[88:91], v113 offset:6144
    v_mfma_f32_16x16x32_bf16 v[20:23], v[52:55], v[64:67], v[20:23]
    ds_read_b128 v[92:95], v113 offset:7168
    s_waitcnt lgkmcnt(8)
    v_mfma_f32_16x16x32_bf16 v[24:27], v[48:51], v[68:71], v[24:27]
    ds_read_b128 v[96:99], v113 offset:8192
    v_mfma_f32_16x16x32_bf16 v[28:31], v[52:55], v[68:71], v[28:31]
    ds_read_b128 v[100:103], v113 offset:9216
    s_waitcnt lgkmcnt(9)
    v_mfma_f32_16x16x32_bf16 v[32:35], v[48:51], v[72:75], v[32:35]
    ds_read_b128 v[104:107], v113 offset:10240
    v_mfma_f32_16x16x32_bf16 v[36:39], v[52:55], v[72:75], v[36:39]
    ds_read_b128 v[108:111], v113 offset:11264
    s_waitcnt lgkmcnt(10)
    v_mfma_f32_16x16x32_bf16 v[40:43], v[48:51], v[76:79], v[40:43]
    v_mfma_f32_16x16x32_bf16 v[44:47], v[52:55], v[76:79], v[44:47]
    s_barrier
    s_waitcnt lgkmcnt(5)
    v_mfma_f32_16x16x32_bf16 v[0:3], v[80:83], v[88:91], v[0:3]
    ds_read_b64_tr_b16 v[48:49], v120 offset:0
    v_mfma_f32_16x16x32_bf16 v[4:7], v[84:87], v[88:91], v[4:7]
    ds_read_b64_tr_b16 v[50:51], v120 offset:1024
    s_waitcnt lgkmcnt(6)
    v_mfma_f32_16x16x32_bf16 v[8:11], v[80:83], v[92:95], v[8:11]
    ds_read_b64_tr_b16 v[52:53], v124 offset:0
    v_mfma_f32_16x16x32_bf16 v[12:15], v[84:87], v[92:95], v[12:15]
    ds_read_b64_tr_b16 v[54:55], v124 offset:1024
    s_waitcnt lgkmcnt(7)
    v_mfma_f32_16x16x32_bf16 v[16:19], v[80:83], v[96:99], v[16:19]
    ds_read_b128 v[56:59], v113 offset:12288
    v_mfma_f32_16x16x32_bf16 v[20:23], v[84:87], v[96:99], v[20:23]
    ds_read_b128 v[60:63], v113 offset:13312
    s_waitcnt lgkmcnt(8)
    v_mfma_f32_16x16x32_bf16 v[24:27], v[80:83], v[100:103], v[24:27]
    ds_read_b128 v[64:67], v113 offset:14336
    v_mfma_f32_16x16x32_bf16 v[28:31], v[84:87], v[100:103], v[28:31]
    ds_read_b128 v[68:71], v113 offset:15360
    s_waitcnt lgkmcnt(9)
    v_mfma_f32_16x16x32_bf16 v[32:35], v[80:83], v[104:107], v[32:35]
    ds_read_b128 v[72:75], v113 offset:16384
    v_mfma_f32_16x16x32_bf16 v[36:39], v[84:87], v[104:107], v[36:39]
    ds_read_b128 v[76:79], v113 offset:17408
    s_waitcnt lgkmcnt(10)
    v_mfma_f32_16x16x32_bf16 v[40:43], v[80:83], v[108:111], v[40:43]
    v_mfma_f32_16x16x32_bf16 v[44:47], v[84:87], v[108:111], v[44:47]
    s_waitcnt lgkmcnt(5)
    v_mfma_f32_16x16x32_bf16 v[0:3], v[48:51], v[56:59], v[0:3]
    ds_read_b64_tr_b16 v[80:81], v120 offset:8192
    v_mfma_f32_16x16x32_bf16 v[4:7], v[52:55], v[56:59], v[4:7]
    ds_read_b64_tr_b16 v[82:83], v120 offset:9216
    s_waitcnt lgkmcnt(6)
    v_mfma_f32_16x16x32_bf16 v[8:11], v[48:51], v[60:63], v[8:11]
    ds_read_b64_tr_b16 v[84:85], v124 offset:8192
    v_mfma_f32_16x16x32_bf16 v[12:15], v[52:55], v[60:63], v[12:15]
    ds_read_b64_tr_b16 v[86:87], v124 offset:9216
    s_waitcnt lgkmcnt(7)
    v_mfma_f32_16x16x32_bf16 v[16:19], v[48:51], v[64:67], v[16:19]
    ds_read_b128 v[88:91], v113 offset:18432
    v_mfma_f32_16x16x32_bf16 v[20:23], v[52:55], v[64:67], v[20:23]
    ds_read_b128 v[92:95], v113 offset:19456
    s_waitcnt lgkmcnt(8)
    v_mfma_f32_16x16x32_bf16 v[24:27], v[48:51], v[68:71], v[24:27]
    ds_read_b128 v[96:99], v113 offset:20480
    v_mfma_f32_16x16x32_bf16 v[28:31], v[52:55], v[68:71], v[28:31]
    ds_read_b128 v[100:103], v113 offset:21504
    s_waitcnt lgkmcnt(9)
    v_mfma_f32_16x16x32_bf16 v[32:35], v[48:51], v[72:75], v[32:35]
    ds_read_b128 v[104:107], v113 offset:22528
    v_mfma_f32_16x16x32_bf16 v[36:39], v[52:55], v[72:75], v[36:39]
    ds_read_b128 v[108:111], v113 offset:23552
    s_waitcnt lgkmcnt(10)
    v_mfma_f32_16x16x32_bf16 v[40:43], v[48:51], v[76:79], v[40:43]
    v_mfma_f32_16x16x32_bf16 v[44:47], v[52:55], v[76:79], v[44:47]
    s_barrier
    s_waitcnt lgkmcnt(5)
    v_mfma_f32_16x16x32_bf16 v[0:3], v[80:83], v[88:91], v[0:3]
    ds_read_b64_tr_b16 v[48:49], v120 offset:40960
    v_mfma_f32_16x16x32_bf16 v[4:7], v[84:87], v[88:91], v[4:7]
    ds_read_b64_tr_b16 v[50:51], v120 offset:41984
    s_waitcnt lgkmcnt(6)
    v_mfma_f32_16x16x32_bf16 v[8:11], v[80:83], v[92:95], v[8:11]
    ds_read_b64_tr_b16 v[52:53], v124 offset:40960
    v_mfma_f32_16x16x32_bf16 v[12:15], v[84:87], v[92:95], v[12:15]
    ds_read_b64_tr_b16 v[54:55], v124 offset:41984
    s_waitcnt lgkmcnt(7)
    v_mfma_f32_16x16x32_bf16 v[16:19], v[80:83], v[96:99], v[16:19]
    ds_read_b128 v[56:59], v113 offset:40960
    v_mfma_f32_16x16x32_bf16 v[20:23], v[84:87], v[96:99], v[20:23]
    ds_read_b128 v[60:63], v113 offset:41984
    s_waitcnt lgkmcnt(8)
    v_mfma_f32_16x16x32_bf16 v[24:27], v[80:83], v[100:103], v[24:27]
    ds_read_b128 v[64:67], v113 offset:43008
    v_mfma_f32_16x16x32_bf16 v[28:31], v[84:87], v[100:103], v[28:31]
    ds_read_b128 v[68:71], v113 offset:44032
    s_waitcnt lgkmcnt(9)
    v_mfma_f32_16x16x32_bf16 v[32:35], v[80:83], v[104:107], v[32:35]
    ds_read_b128 v[72:75], v113 offset:45056
    v_mfma_f32_16x16x32_bf16 v[36:39], v[84:87], v[104:107], v[36:39]
    ds_read_b128 v[76:79], v113 offset:46080
    s_waitcnt lgkmcnt(10)
    v_mfma_f32_16x16x32_bf16 v[40:43], v[80:83], v[108:111], v[40:43]
    v_mfma_f32_16x16x32_bf16 v[44:47], v[84:87], v[108:111], v[44:47]
    s_waitcnt lgkmcnt(5)
    v_mfma_f32_16x16x32_bf16 v[0:3], v[48:51], v[56:59], v[0:3]
    ds_read_b64_tr_b16 v[80:81], v120 offset:49152
    v_mfma_f32_16x16x32_bf16 v[4:7], v[52:55], v[56:59], v[4:7]
    ds_read_b64_tr_b16 v[82:83], v120 offset:50176
    s_waitcnt lgkmcnt(6)
    v_mfma_f32_16x16x32_bf16 v[8:11], v[48:51], v[60:63], v[8:11]
    ds_read_b64_tr_b16 v[84:85], v124 offset:49152
    v_mfma_f32_16x16x32_bf16 v[12:15], v[52:55], v[60:63], v[12:15]
    ds_read_b64_tr_b16 v[86:87], v124 offset:50176
    s_waitcnt lgkmcnt(7)
    v_mfma_f32_16x16x32_bf16 v[16:19], v[48:51], v[64:67], v[16:19]
    ds_read_b128 v[88:91], v113 offset:47104
    v_mfma_f32_16x16x32_bf16 v[20:23], v[52:55], v[64:67], v[20:23]
    ds_read_b128 v[92:95], v113 offset:48128
    s_waitcnt lgkmcnt(8)
    v_mfma_f32_16x16x32_bf16 v[24:27], v[48:51], v[68:71], v[24:27]
    ds_read_b128 v[96:99], v113 offset:49152
    v_mfma_f32_16x16x32_bf16 v[28:31], v[52:55], v[68:71], v[28:31]
    ds_read_b128 v[100:103], v113 offset:50176
    s_waitcnt lgkmcnt(9)
    v_mfma_f32_16x16x32_bf16 v[32:35], v[48:51], v[72:75], v[32:35]
    ds_read_b128 v[104:107], v113 offset:51200
    v_mfma_f32_16x16x32_bf16 v[36:39], v[52:55], v[72:75], v[36:39]
    ds_read_b128 v[108:111], v113 offset:52224
    s_waitcnt lgkmcnt(10)
    v_mfma_f32_16x16x32_bf16 v[40:43], v[48:51], v[76:79], v[40:43]
    v_mfma_f32_16x16x32_bf16 v[44:47], v[52:55], v[76:79], v[44:47]
    s_barrier
    s_waitcnt lgkmcnt(5)
    v_mfma_f32_16x16x32_bf16 v[0:3], v[80:83], v[88:91], v[0:3]
    ds_read_b64_tr_b16 v[48:49], v121 offset:24576
    v_mfma_f32_16x16x32_bf16 v[4:7], v[84:87], v[88:91], v[4:7]
    ds_read_b64_tr_b16 v[50:51], v121 offset:25600
    s_waitcnt lgkmcnt(6)
    v_mfma_f32_16x16x32_bf16 v[8:11], v[80:83], v[92:95], v[8:11]
    ds_read_b64_tr_b16 v[52:53], v125 offset:24576
    v_mfma_f32_16x16x32_bf16 v[12:15], v[84:87], v[92:95], v[12:15]
    ds_read_b64_tr_b16 v[54:55], v125 offset:25600
    s_waitcnt lgkmcnt(7)
    v_mfma_f32_16x16x32_bf16 v[16:19], v[80:83], v[96:99], v[16:19]
    ds_read_b128 v[56:59], v113 offset:53248
    v_mfma_f32_16x16x32_bf16 v[20:23], v[84:87], v[96:99], v[20:23]
    ds_read_b128 v[60:63], v113 offset:54272
    s_waitcnt lgkmcnt(8)
    v_mfma_f32_16x16x32_bf16 v[24:27], v[80:83], v[100:103], v[24:27]
    ds_read_b128 v[64:67], v113 offset:55296
    v_mfma_f32_16x16x32_bf16 v[28:31], v[84:87], v[100:103], v[28:31]
    ds_read_b128 v[68:71], v113 offset:56320
    s_waitcnt lgkmcnt(9)
    v_mfma_f32_16x16x32_bf16 v[32:35], v[80:83], v[104:107], v[32:35]
    ds_read_b128 v[72:75], v113 offset:57344
    v_mfma_f32_16x16x32_bf16 v[36:39], v[84:87], v[104:107], v[36:39]
    ds_read_b128 v[76:79], v113 offset:58368
    s_waitcnt lgkmcnt(10)
    v_mfma_f32_16x16x32_bf16 v[40:43], v[80:83], v[108:111], v[40:43]
    v_mfma_f32_16x16x32_bf16 v[44:47], v[84:87], v[108:111], v[44:47]
    s_waitcnt lgkmcnt(5)
    v_mfma_f32_16x16x32_bf16 v[0:3], v[48:51], v[56:59], v[0:3]
    ds_read_b64_tr_b16 v[80:81], v121 offset:32768
    v_mfma_f32_16x16x32_bf16 v[4:7], v[52:55], v[56:59], v[4:7]
    ds_read_b64_tr_b16 v[82:83], v121 offset:33792
    s_waitcnt lgkmcnt(6)
    v_mfma_f32_16x16x32_bf16 v[8:11], v[48:51], v[60:63], v[8:11]
    ds_read_b64_tr_b16 v[84:85], v125 offset:32768
    v_mfma_f32_16x16x32_bf16 v[12:15], v[52:55], v[60:63], v[12:15]
    ds_read_b64_tr_b16 v[86:87], v125 offset:33792
    s_waitcnt lgkmcnt(7)
    v_mfma_f32_16x16x32_bf16 v[16:19], v[48:51], v[64:67], v[16:19]
    ds_read_b128 v[88:91], v113 offset:59392
    v_mfma_f32_16x16x32_bf16 v[20:23], v[52:55], v[64:67], v[20:23]
    ds_read_b128 v[92:95], v113 offset:60416
    s_waitcnt lgkmcnt(8)
    v_mfma_f32_16x16x32_bf16 v[24:27], v[48:51], v[68:71], v[24:27]
    ds_read_b128 v[96:99], v113 offset:61440
    v_mfma_f32_16x16x32_bf16 v[28:31], v[52:55], v[68:71], v[28:31]
    ds_read_b128 v[100:103], v113 offset:62464
    s_waitcnt lgkmcnt(9)
    v_mfma_f32_16x16x32_bf16 v[32:35], v[48:51], v[72:75], v[32:35]
    ds_read_b128 v[104:107], v113 offset:63488
    v_mfma_f32_16x16x32_bf16 v[36:39], v[52:55], v[72:75], v[36:39]
    ds_read_b128 v[108:111], v113 offset:64512
    s_waitcnt lgkmcnt(10)
    v_mfma_f32_16x16x32_bf16 v[40:43], v[48:51], v[76:79], v[40:43]
    v_mfma_f32_16x16x32_bf16 v[44:47], v[52:55], v[76:79], v[44:47]
    s_barrier
    s_waitcnt lgkmcnt(5)
    v_mfma_f32_16x16x32_bf16 v[0:3], v[80:83], v[88:91], v[0:3]
    ds_read_b64_tr_b16 v[48:49], v121 offset:0
    v_mfma_f32_16x16x32_bf16 v[4:7], v[84:87], v[88:91], v[4:7]
    ds_read_b64_tr_b16 v[50:51], v121 offset:1024
    s_waitcnt lgkmcnt(6)
    v_mfma_f32_16x16x32_bf16 v[8:11], v[80:83], v[92:95], v[8:11]
    ds_read_b64_tr_b16 v[52:53], v125 offset:0
    v_mfma_f32_16x16x32_bf16 v[12:15], v[84:87], v[92:95], v[12:15]
    ds_read_b64_tr_b16 v[54:55], v125 offset:1024
    s_waitcnt lgkmcnt(7)
    v_mfma_f32_16x16x32_bf16 v[16:19], v[80:83], v[96:99], v[16:19]
    ds_read_b128 v[56:59], v122 offset:0
    v_mfma_f32_16x16x32_bf16 v[20:23], v[84:87], v[96:99], v[20:23]
    ds_read_b128 v[60:63], v122 offset:1024
    s_waitcnt lgkmcnt(8)
    v_mfma_f32_16x16x32_bf16 v[24:27], v[80:83], v[100:103], v[24:27]
    ds_read_b128 v[64:67], v122 offset:2048
    v_mfma_f32_16x16x32_bf16 v[28:31], v[84:87], v[100:103], v[28:31]
    ds_read_b128 v[68:71], v122 offset:3072
    s_waitcnt lgkmcnt(9)
    v_mfma_f32_16x16x32_bf16 v[32:35], v[80:83], v[104:107], v[32:35]
    ds_read_b128 v[72:75], v122 offset:4096
    v_mfma_f32_16x16x32_bf16 v[36:39], v[84:87], v[104:107], v[36:39]
    ds_read_b128 v[76:79], v122 offset:5120
    s_waitcnt lgkmcnt(10)
    v_mfma_f32_16x16x32_bf16 v[40:43], v[80:83], v[108:111], v[40:43]
    v_mfma_f32_16x16x32_bf16 v[44:47], v[84:87], v[108:111], v[44:47]
    s_waitcnt lgkmcnt(5)
    v_mfma_f32_16x16x32_bf16 v[0:3], v[48:51], v[56:59], v[0:3]
    ds_read_b64_tr_b16 v[80:81], v121 offset:8192
    v_mfma_f32_16x16x32_bf16 v[4:7], v[52:55], v[56:59], v[4:7]
    ds_read_b64_tr_b16 v[82:83], v121 offset:9216
    s_waitcnt lgkmcnt(6)
    v_mfma_f32_16x16x32_bf16 v[8:11], v[48:51], v[60:63], v[8:11]
    ds_read_b64_tr_b16 v[84:85], v125 offset:8192
    v_mfma_f32_16x16x32_bf16 v[12:15], v[52:55], v[60:63], v[12:15]
    ds_read_b64_tr_b16 v[86:87], v125 offset:9216
    s_waitcnt lgkmcnt(7)
    v_mfma_f32_16x16x32_bf16 v[16:19], v[48:51], v[64:67], v[16:19]
    ds_read_b128 v[88:91], v122 offset:6144
    v_mfma_f32_16x16x32_bf16 v[20:23], v[52:55], v[64:67], v[20:23]
    ds_read_b128 v[92:95], v122 offset:7168
    s_waitcnt lgkmcnt(8)
    v_mfma_f32_16x16x32_bf16 v[24:27], v[48:51], v[68:71], v[24:27]
    ds_read_b128 v[96:99], v122 offset:8192
    v_mfma_f32_16x16x32_bf16 v[28:31], v[52:55], v[68:71], v[28:31]
    ds_read_b128 v[100:103], v122 offset:9216
    s_waitcnt lgkmcnt(9)
    v_mfma_f32_16x16x32_bf16 v[32:35], v[48:51], v[72:75], v[32:35]
    ds_read_b128 v[104:107], v122 offset:10240
    v_mfma_f32_16x16x32_bf16 v[36:39], v[52:55], v[72:75], v[36:39]
    ds_read_b128 v[108:111], v122 offset:11264
    s_waitcnt lgkmcnt(10)
    v_mfma_f32_16x16x32_bf16 v[40:43], v[48:51], v[76:79], v[40:43]
    v_mfma_f32_16x16x32_bf16 v[44:47], v[52:55], v[76:79], v[44:47]
    s_barrier
    s_waitcnt lgkmcnt(5)
    v_mfma_f32_16x16x32_bf16 v[0:3], v[80:83], v[88:91], v[0:3]
    ds_read_b64_tr_b16 v[48:49], v112 offset:24576
    v_mfma_f32_16x16x32_bf16 v[4:7], v[84:87], v[88:91], v[4:7]
    ds_read_b64_tr_b16 v[50:51], v112 offset:25600
    s_waitcnt lgkmcnt(6)
    v_mfma_f32_16x16x32_bf16 v[8:11], v[80:83], v[92:95], v[8:11]
    ds_read_b64_tr_b16 v[52:53], v123 offset:24576
    v_mfma_f32_16x16x32_bf16 v[12:15], v[84:87], v[92:95], v[12:15]
    ds_read_b64_tr_b16 v[54:55], v123 offset:25600
    s_waitcnt lgkmcnt(7)
    v_mfma_f32_16x16x32_bf16 v[16:19], v[80:83], v[96:99], v[16:19]
    ds_read_b128 v[56:59], v113 offset:0
    v_mfma_f32_16x16x32_bf16 v[20:23], v[84:87], v[96:99], v[20:23]
    ds_read_b128 v[60:63], v113 offset:1024
    s_waitcnt lgkmcnt(8)
    v_mfma_f32_16x16x32_bf16 v[24:27], v[80:83], v[100:103], v[24:27]
    ds_read_b128 v[64:67], v113 offset:2048
    v_mfma_f32_16x16x32_bf16 v[28:31], v[84:87], v[100:103], v[28:31]
    ds_read_b128 v[68:71], v113 offset:3072
    s_waitcnt lgkmcnt(9)
    v_mfma_f32_16x16x32_bf16 v[32:35], v[80:83], v[104:107], v[32:35]
    ds_read_b128 v[72:75], v113 offset:4096
    v_mfma_f32_16x16x32_bf16 v[36:39], v[84:87], v[104:107], v[36:39]
    ds_read_b128 v[76:79], v113 offset:5120
    s_waitcnt lgkmcnt(10)
    v_mfma_f32_16x16x32_bf16 v[40:43], v[80:83], v[108:111], v[40:43]
    v_mfma_f32_16x16x32_bf16 v[44:47], v[84:87], v[108:111], v[44:47]
    s_waitcnt lgkmcnt(5)
    v_mfma_f32_16x16x32_bf16 v[0:3], v[48:51], v[56:59], v[0:3]
    ds_read_b64_tr_b16 v[80:81], v112 offset:32768
    v_mfma_f32_16x16x32_bf16 v[4:7], v[52:55], v[56:59], v[4:7]
    ds_read_b64_tr_b16 v[82:83], v112 offset:33792
    s_waitcnt lgkmcnt(6)
    v_mfma_f32_16x16x32_bf16 v[8:11], v[48:51], v[60:63], v[8:11]
    ds_read_b64_tr_b16 v[84:85], v123 offset:32768
    v_mfma_f32_16x16x32_bf16 v[12:15], v[52:55], v[60:63], v[12:15]
    ds_read_b64_tr_b16 v[86:87], v123 offset:33792
    s_waitcnt lgkmcnt(7)
    v_mfma_f32_16x16x32_bf16 v[16:19], v[48:51], v[64:67], v[16:19]
    ds_read_b128 v[88:91], v113 offset:6144
    v_mfma_f32_16x16x32_bf16 v[20:23], v[52:55], v[64:67], v[20:23]
    ds_read_b128 v[92:95], v113 offset:7168
    s_waitcnt lgkmcnt(8)
    v_mfma_f32_16x16x32_bf16 v[24:27], v[48:51], v[68:71], v[24:27]
    ds_read_b128 v[96:99], v113 offset:8192
    v_mfma_f32_16x16x32_bf16 v[28:31], v[52:55], v[68:71], v[28:31]
    ds_read_b128 v[100:103], v113 offset:9216
    s_waitcnt lgkmcnt(9)
    v_mfma_f32_16x16x32_bf16 v[32:35], v[48:51], v[72:75], v[32:35]
    ds_read_b128 v[104:107], v113 offset:10240
    v_mfma_f32_16x16x32_bf16 v[36:39], v[52:55], v[72:75], v[36:39]
    ds_read_b128 v[108:111], v113 offset:11264
    s_waitcnt lgkmcnt(10)
    v_mfma_f32_16x16x32_bf16 v[40:43], v[48:51], v[76:79], v[40:43]
    v_mfma_f32_16x16x32_bf16 v[44:47], v[52:55], v[76:79], v[44:47]
    s_barrier
    s_waitcnt lgkmcnt(5)
    v_mfma_f32_16x16x32_bf16 v[0:3], v[80:83], v[88:91], v[0:3]
    ds_read_b64_tr_b16 v[48:49], v120 offset:0
    v_mfma_f32_16x16x32_bf16 v[4:7], v[84:87], v[88:91], v[4:7]
    ds_read_b64_tr_b16 v[50:51], v120 offset:1024
    s_waitcnt lgkmcnt(6)
    v_mfma_f32_16x16x32_bf16 v[8:11], v[80:83], v[92:95], v[8:11]
    ds_read_b64_tr_b16 v[52:53], v124 offset:0
    v_mfma_f32_16x16x32_bf16 v[12:15], v[84:87], v[92:95], v[12:15]
    ds_read_b64_tr_b16 v[54:55], v124 offset:1024
    s_waitcnt lgkmcnt(7)
    v_mfma_f32_16x16x32_bf16 v[16:19], v[80:83], v[96:99], v[16:19]
    ds_read_b128 v[56:59], v113 offset:12288
    v_mfma_f32_16x16x32_bf16 v[20:23], v[84:87], v[96:99], v[20:23]
    ds_read_b128 v[60:63], v113 offset:13312
    s_waitcnt lgkmcnt(8)
    v_mfma_f32_16x16x32_bf16 v[24:27], v[80:83], v[100:103], v[24:27]
    ds_read_b128 v[64:67], v113 offset:14336
    v_mfma_f32_16x16x32_bf16 v[28:31], v[84:87], v[100:103], v[28:31]
    ds_read_b128 v[68:71], v113 offset:15360
    s_waitcnt lgkmcnt(9)
    v_mfma_f32_16x16x32_bf16 v[32:35], v[80:83], v[104:107], v[32:35]
    ds_read_b128 v[72:75], v113 offset:16384
    v_mfma_f32_16x16x32_bf16 v[36:39], v[84:87], v[104:107], v[36:39]
    ds_read_b128 v[76:79], v113 offset:17408
    s_waitcnt lgkmcnt(10)
    v_mfma_f32_16x16x32_bf16 v[40:43], v[80:83], v[108:111], v[40:43]
    v_mfma_f32_16x16x32_bf16 v[44:47], v[84:87], v[108:111], v[44:47]
    s_waitcnt lgkmcnt(5)
    v_mfma_f32_16x16x32_bf16 v[0:3], v[48:51], v[56:59], v[0:3]
    ds_read_b64_tr_b16 v[80:81], v120 offset:8192
    v_mfma_f32_16x16x32_bf16 v[4:7], v[52:55], v[56:59], v[4:7]
    ds_read_b64_tr_b16 v[82:83], v120 offset:9216
    s_waitcnt lgkmcnt(6)
    v_mfma_f32_16x16x32_bf16 v[8:11], v[48:51], v[60:63], v[8:11]
    ds_read_b64_tr_b16 v[84:85], v124 offset:8192
    v_mfma_f32_16x16x32_bf16 v[12:15], v[52:55], v[60:63], v[12:15]
    ds_read_b64_tr_b16 v[86:87], v124 offset:9216
    s_waitcnt lgkmcnt(7)
    v_mfma_f32_16x16x32_bf16 v[16:19], v[48:51], v[64:67], v[16:19]
    ds_read_b128 v[88:91], v113 offset:18432
    v_mfma_f32_16x16x32_bf16 v[20:23], v[52:55], v[64:67], v[20:23]
    ds_read_b128 v[92:95], v113 offset:19456
    s_waitcnt lgkmcnt(8)
    v_mfma_f32_16x16x32_bf16 v[24:27], v[48:51], v[68:71], v[24:27]
    ds_read_b128 v[96:99], v113 offset:20480
    v_mfma_f32_16x16x32_bf16 v[28:31], v[52:55], v[68:71], v[28:31]
    ds_read_b128 v[100:103], v113 offset:21504
    s_waitcnt lgkmcnt(9)
    v_mfma_f32_16x16x32_bf16 v[32:35], v[48:51], v[72:75], v[32:35]
    ds_read_b128 v[104:107], v113 offset:22528
    v_mfma_f32_16x16x32_bf16 v[36:39], v[52:55], v[72:75], v[36:39]
    ds_read_b128 v[108:111], v113 offset:23552
    s_waitcnt lgkmcnt(10)
    v_mfma_f32_16x16x32_bf16 v[40:43], v[48:51], v[76:79], v[40:43]
    v_mfma_f32_16x16x32_bf16 v[44:47], v[52:55], v[76:79], v[44:47]
    s_barrier
    s_waitcnt lgkmcnt(5)
    v_mfma_f32_16x16x32_bf16 v[0:3], v[80:83], v[88:91], v[0:3]
    ds_read_b64_tr_b16 v[48:49], v120 offset:40960
    v_mfma_f32_16x16x32_bf16 v[4:7], v[84:87], v[88:91], v[4:7]
    ds_read_b64_tr_b16 v[50:51], v120 offset:41984
    s_waitcnt lgkmcnt(6)
    v_mfma_f32_16x16x32_bf16 v[8:11], v[80:83], v[92:95], v[8:11]
    ds_read_b64_tr_b16 v[52:53], v124 offset:40960
    v_mfma_f32_16x16x32_bf16 v[12:15], v[84:87], v[92:95], v[12:15]
    ds_read_b64_tr_b16 v[54:55], v124 offset:41984
    s_waitcnt lgkmcnt(7)
    v_mfma_f32_16x16x32_bf16 v[16:19], v[80:83], v[96:99], v[16:19]
    ds_read_b128 v[56:59], v113 offset:40960
    v_mfma_f32_16x16x32_bf16 v[20:23], v[84:87], v[96:99], v[20:23]
    ds_read_b128 v[60:63], v113 offset:41984
    s_waitcnt lgkmcnt(8)
    v_mfma_f32_16x16x32_bf16 v[24:27], v[80:83], v[100:103], v[24:27]
    ds_read_b128 v[64:67], v113 offset:43008
    v_mfma_f32_16x16x32_bf16 v[28:31], v[84:87], v[100:103], v[28:31]
    ds_read_b128 v[68:71], v113 offset:44032
    s_waitcnt lgkmcnt(9)
    v_mfma_f32_16x16x32_bf16 v[32:35], v[80:83], v[104:107], v[32:35]
    ds_read_b128 v[72:75], v113 offset:45056
    v_mfma_f32_16x16x32_bf16 v[36:39], v[84:87], v[104:107], v[36:39]
    ds_read_b128 v[76:79], v113 offset:46080
    s_waitcnt lgkmcnt(10)
    v_mfma_f32_16x16x32_bf16 v[40:43], v[80:83], v[108:111], v[40:43]
    v_mfma_f32_16x16x32_bf16 v[44:47], v[84:87], v[108:111], v[44:47]
    s_waitcnt lgkmcnt(5)
    v_mfma_f32_16x16x32_bf16 v[0:3], v[48:51], v[56:59], v[0:3]
    ds_read_b64_tr_b16 v[80:81], v120 offset:49152
    v_mfma_f32_16x16x32_bf16 v[4:7], v[52:55], v[56:59], v[4:7]
    ds_read_b64_tr_b16 v[82:83], v120 offset:50176
    s_waitcnt lgkmcnt(6)
    v_mfma_f32_16x16x32_bf16 v[8:11], v[48:51], v[60:63], v[8:11]
    ds_read_b64_tr_b16 v[84:85], v124 offset:49152
    v_mfma_f32_16x16x32_bf16 v[12:15], v[52:55], v[60:63], v[12:15]
    ds_read_b64_tr_b16 v[86:87], v124 offset:50176
    s_waitcnt lgkmcnt(7)
    v_mfma_f32_16x16x32_bf16 v[16:19], v[48:51], v[64:67], v[16:19]
    ds_read_b128 v[88:91], v113 offset:47104
    v_mfma_f32_16x16x32_bf16 v[20:23], v[52:55], v[64:67], v[20:23]
    ds_read_b128 v[92:95], v113 offset:48128
    s_waitcnt lgkmcnt(8)
    v_mfma_f32_16x16x32_bf16 v[24:27], v[48:51], v[68:71], v[24:27]
    ds_read_b128 v[96:99], v113 offset:49152
    v_mfma_f32_16x16x32_bf16 v[28:31], v[52:55], v[68:71], v[28:31]
    ds_read_b128 v[100:103], v113 offset:50176
    s_waitcnt lgkmcnt(9)
    v_mfma_f32_16x16x32_bf16 v[32:35], v[48:51], v[72:75], v[32:35]
    ds_read_b128 v[104:107], v113 offset:51200
    v_mfma_f32_16x16x32_bf16 v[36:39], v[52:55], v[72:75], v[36:39]
    ds_read_b128 v[108:111], v113 offset:52224
    s_waitcnt lgkmcnt(10)
    v_mfma_f32_16x16x32_bf16 v[40:43], v[48:51], v[76:79], v[40:43]
    v_mfma_f32_16x16x32_bf16 v[44:47], v[52:55], v[76:79], v[44:47]
    s_barrier
    s_waitcnt lgkmcnt(5)
    v_mfma_f32_16x16x32_bf16 v[0:3], v[80:83], v[88:91], v[0:3]
    ds_read_b64_tr_b16 v[48:49], v121 offset:24576
    v_mfma_f32_16x16x32_bf16 v[4:7], v[84:87], v[88:91], v[4:7]
    ds_read_b64_tr_b16 v[50:51], v121 offset:25600
    s_waitcnt lgkmcnt(6)
    v_mfma_f32_16x16x32_bf16 v[8:11], v[80:83], v[92:95], v[8:11]
    ds_read_b64_tr_b16 v[52:53], v125 offset:24576
    v_mfma_f32_16x16x32_bf16 v[12:15], v[84:87], v[92:95], v[12:15]
    ds_read_b64_tr_b16 v[54:55], v125 offset:25600
    s_waitcnt lgkmcnt(7)
    v_mfma_f32_16x16x32_bf16 v[16:19], v[80:83], v[96:99], v[16:19]
    ds_read_b128 v[56:59], v113 offset:53248
    v_mfma_f32_16x16x32_bf16 v[20:23], v[84:87], v[96:99], v[20:23]
    ds_read_b128 v[60:63], v113 offset:54272
    s_waitcnt lgkmcnt(8)
    v_mfma_f32_16x16x32_bf16 v[24:27], v[80:83], v[100:103], v[24:27]
    ds_read_b128 v[64:67], v113 offset:55296
    v_mfma_f32_16x16x32_bf16 v[28:31], v[84:87], v[100:103], v[28:31]
    ds_read_b128 v[68:71], v113 offset:56320
    s_waitcnt lgkmcnt(9)
    v_mfma_f32_16x16x32_bf16 v[32:35], v[80:83], v[104:107], v[32:35]
    ds_read_b128 v[72:75], v113 offset:57344
    v_mfma_f32_16x16x32_bf16 v[36:39], v[84:87], v[104:107], v[36:39]
    ds_read_b128 v[76:79], v113 offset:58368
    s_waitcnt lgkmcnt(10)
    v_mfma_f32_16x16x32_bf16 v[40:43], v[80:83], v[108:111], v[40:43]
    v_mfma_f32_16x16x32_bf16 v[44:47], v[84:87], v[108:111], v[44:47]
    s_waitcnt lgkmcnt(5)
    v_mfma_f32_16x16x32_bf16 v[0:3], v[48:51], v[56:59], v[0:3]
    ds_read_b64_tr_b16 v[80:81], v121 offset:32768
    v_mfma_f32_16x16x32_bf16 v[4:7], v[52:55], v[56:59], v[4:7]
    ds_read_b64_tr_b16 v[82:83], v121 offset:33792
    s_waitcnt lgkmcnt(6)
    v_mfma_f32_16x16x32_bf16 v[8:11], v[48:51], v[60:63], v[8:11]
    ds_read_b64_tr_b16 v[84:85], v125 offset:32768
    v_mfma_f32_16x16x32_bf16 v[12:15], v[52:55], v[60:63], v[12:15]
    ds_read_b64_tr_b16 v[86:87], v125 offset:33792
    s_waitcnt lgkmcnt(7)
    v_mfma_f32_16x16x32_bf16 v[16:19], v[48:51], v[64:67], v[16:19]
    ds_read_b128 v[88:91], v113 offset:59392
    v_mfma_f32_16x16x32_bf16 v[20:23], v[52:55], v[64:67], v[20:23]
    ds_read_b128 v[92:95], v113 offset:60416
    s_waitcnt lgkmcnt(8)
    v_mfma_f32_16x16x32_bf16 v[24:27], v[48:51], v[68:71], v[24:27]
    ds_read_b128 v[96:99], v113 offset:61440
    v_mfma_f32_16x16x32_bf16 v[28:31], v[52:55], v[68:71], v[28:31]
    ds_read_b128 v[100:103], v113 offset:62464
    s_waitcnt lgkmcnt(9)
    v_mfma_f32_16x16x32_bf16 v[32:35], v[48:51], v[72:75], v[32:35]
    ds_read_b128 v[104:107], v113 offset:63488
    v_mfma_f32_16x16x32_bf16 v[36:39], v[52:55], v[72:75], v[36:39]
    ds_read_b128 v[108:111], v113 offset:64512
    s_waitcnt lgkmcnt(10)
    v_mfma_f32_16x16x32_bf16 v[40:43], v[48:51], v[76:79], v[40:43]
    v_mfma_f32_16x16x32_bf16 v[44:47], v[52:55], v[76:79], v[44:47]
    s_barrier
    s_waitcnt lgkmcnt(5)
    v_mfma_f32_16x16x32_bf16 v[0:3], v[80:83], v[88:91], v[0:3]
    ds_read_b64_tr_b16 v[48:49], v121 offset:0
    v_mfma_f32_16x16x32_bf16 v[4:7], v[84:87], v[88:91], v[4:7]
    ds_read_b64_tr_b16 v[50:51], v121 offset:1024
    s_waitcnt lgkmcnt(6)
    v_mfma_f32_16x16x32_bf16 v[8:11], v[80:83], v[92:95], v[8:11]
    ds_read_b64_tr_b16 v[52:53], v125 offset:0
    v_mfma_f32_16x16x32_bf16 v[12:15], v[84:87], v[92:95], v[12:15]
    ds_read_b64_tr_b16 v[54:55], v125 offset:1024
    s_waitcnt lgkmcnt(7)
    v_mfma_f32_16x16x32_bf16 v[16:19], v[80:83], v[96:99], v[16:19]
    ds_read_b128 v[56:59], v122 offset:0
    v_mfma_f32_16x16x32_bf16 v[20:23], v[84:87], v[96:99], v[20:23]
    ds_read_b128 v[60:63], v122 offset:1024
    s_waitcnt lgkmcnt(8)
    v_mfma_f32_16x16x32_bf16 v[24:27], v[80:83], v[100:103], v[24:27]
    ds_read_b128 v[64:67], v122 offset:2048
    v_mfma_f32_16x16x32_bf16 v[28:31], v[84:87], v[100:103], v[28:31]
    ds_read_b128 v[68:71], v122 offset:3072
    s_waitcnt lgkmcnt(9)
    v_mfma_f32_16x16x32_bf16 v[32:35], v[80:83], v[104:107], v[32:35]
    ds_read_b128 v[72:75], v122 offset:4096
    v_mfma_f32_16x16x32_bf16 v[36:39], v[84:87], v[104:107], v[36:39]
    ds_read_b128 v[76:79], v122 offset:5120
    s_waitcnt lgkmcnt(10)
    v_mfma_f32_16x16x32_bf16 v[40:43], v[80:83], v[108:111], v[40:43]
    v_mfma_f32_16x16x32_bf16 v[44:47], v[84:87], v[108:111], v[44:47]
    s_waitcnt lgkmcnt(5)
    v_mfma_f32_16x16x32_bf16 v[0:3], v[48:51], v[56:59], v[0:3]
    ds_read_b64_tr_b16 v[80:81], v121 offset:8192
    v_mfma_f32_16x16x32_bf16 v[4:7], v[52:55], v[56:59], v[4:7]
    ds_read_b64_tr_b16 v[82:83], v121 offset:9216
    s_waitcnt lgkmcnt(6)
    v_mfma_f32_16x16x32_bf16 v[8:11], v[48:51], v[60:63], v[8:11]
    ds_read_b64_tr_b16 v[84:85], v125 offset:8192
    v_mfma_f32_16x16x32_bf16 v[12:15], v[52:55], v[60:63], v[12:15]
    ds_read_b64_tr_b16 v[86:87], v125 offset:9216
    s_waitcnt lgkmcnt(7)
    v_mfma_f32_16x16x32_bf16 v[16:19], v[48:51], v[64:67], v[16:19]
    ds_read_b128 v[88:91], v122 offset:6144
    v_mfma_f32_16x16x32_bf16 v[20:23], v[52:55], v[64:67], v[20:23]
    ds_read_b128 v[92:95], v122 offset:7168
    s_waitcnt lgkmcnt(8)
    v_mfma_f32_16x16x32_bf16 v[24:27], v[48:51], v[68:71], v[24:27]
    ds_read_b128 v[96:99], v122 offset:8192
    v_mfma_f32_16x16x32_bf16 v[28:31], v[52:55], v[68:71], v[28:31]
    ds_read_b128 v[100:103], v122 offset:9216
    s_waitcnt lgkmcnt(9)
    v_mfma_f32_16x16x32_bf16 v[32:35], v[48:51], v[72:75], v[32:35]
    ds_read_b128 v[104:107], v122 offset:10240
    v_mfma_f32_16x16x32_bf16 v[36:39], v[52:55], v[72:75], v[36:39]
    ds_read_b128 v[108:111], v122 offset:11264
    s_waitcnt lgkmcnt(10)
    v_mfma_f32_16x16x32_bf16 v[40:43], v[48:51], v[76:79], v[40:43]
    v_mfma_f32_16x16x32_bf16 v[44:47], v[52:55], v[76:79], v[44:47]
    s_barrier
    s_waitcnt lgkmcnt(5)
    v_mfma_f32_16x16x32_bf16 v[0:3], v[80:83], v[88:91], v[0:3]
    ds_read_b64_tr_b16 v[48:49], v112 offset:24576
    v_mfma_f32_16x16x32_bf16 v[4:7], v[84:87], v[88:91], v[4:7]
    ds_read_b64_tr_b16 v[50:51], v112 offset:25600
    s_waitcnt lgkmcnt(6)
    v_mfma_f32_16x16x32_bf16 v[8:11], v[80:83], v[92:95], v[8:11]
    ds_read_b64_tr_b16 v[52:53], v123 offset:24576
    v_mfma_f32_16x16x32_bf16 v[12:15], v[84:87], v[92:95], v[12:15]
    ds_read_b64_tr_b16 v[54:55], v123 offset:25600
    s_waitcnt lgkmcnt(7)
    v_mfma_f32_16x16x32_bf16 v[16:19], v[80:83], v[96:99], v[16:19]
    ds_read_b128 v[56:59], v113 offset:0
    v_mfma_f32_16x16x32_bf16 v[20:23], v[84:87], v[96:99], v[20:23]
    ds_read_b128 v[60:63], v113 offset:1024
    s_waitcnt lgkmcnt(8)
    v_mfma_f32_16x16x32_bf16 v[24:27], v[80:83], v[100:103], v[24:27]
    ds_read_b128 v[64:67], v113 offset:2048
    v_mfma_f32_16x16x32_bf16 v[28:31], v[84:87], v[100:103], v[28:31]
    ds_read_b128 v[68:71], v113 offset:3072
    s_waitcnt lgkmcnt(9)
    v_mfma_f32_16x16x32_bf16 v[32:35], v[80:83], v[104:107], v[32:35]
    ds_read_b128 v[72:75], v113 offset:4096
    v_mfma_f32_16x16x32_bf16 v[36:39], v[84:87], v[104:107], v[36:39]
    ds_read_b128 v[76:79], v113 offset:5120
    s_waitcnt lgkmcnt(10)
    v_mfma_f32_16x16x32_bf16 v[40:43], v[80:83], v[108:111], v[40:43]
    v_mfma_f32_16x16x32_bf16 v[44:47], v[84:87], v[108:111], v[44:47]
    s_waitcnt lgkmcnt(5)
    v_mfma_f32_16x16x32_bf16 v[0:3], v[48:51], v[56:59], v[0:3]
    ds_read_b64_tr_b16 v[80:81], v112 offset:32768
    v_mfma_f32_16x16x32_bf16 v[4:7], v[52:55], v[56:59], v[4:7]
    ds_read_b64_tr_b16 v[82:83], v112 offset:33792
    s_waitcnt lgkmcnt(6)
    v_mfma_f32_16x16x32_bf16 v[8:11], v[48:51], v[60:63], v[8:11]
    ds_read_b64_tr_b16 v[84:85], v123 offset:32768
    v_mfma_f32_16x16x32_bf16 v[12:15], v[52:55], v[60:63], v[12:15]
    ds_read_b64_tr_b16 v[86:87], v123 offset:33792
    s_waitcnt lgkmcnt(7)
    v_mfma_f32_16x16x32_bf16 v[16:19], v[48:51], v[64:67], v[16:19]
    ds_read_b128 v[88:91], v113 offset:6144
    v_mfma_f32_16x16x32_bf16 v[20:23], v[52:55], v[64:67], v[20:23]
    ds_read_b128 v[92:95], v113 offset:7168
    s_waitcnt lgkmcnt(8)
    v_mfma_f32_16x16x32_bf16 v[24:27], v[48:51], v[68:71], v[24:27]
    ds_read_b128 v[96:99], v113 offset:8192
    v_mfma_f32_16x16x32_bf16 v[28:31], v[52:55], v[68:71], v[28:31]
    ds_read_b128 v[100:103], v113 offset:9216
    s_waitcnt lgkmcnt(9)
    v_mfma_f32_16x16x32_bf16 v[32:35], v[48:51], v[72:75], v[32:35]
    ds_read_b128 v[104:107], v113 offset:10240
    v_mfma_f32_16x16x32_bf16 v[36:39], v[52:55], v[72:75], v[36:39]
    ds_read_b128 v[108:111], v113 offset:11264
    s_waitcnt lgkmcnt(10)
    v_mfma_f32_16x16x32_bf16 v[40:43], v[48:51], v[76:79], v[40:43]
    v_mfma_f32_16x16x32_bf16 v[44:47], v[52:55], v[76:79], v[44:47]
    s_barrier
    s_waitcnt lgkmcnt(5)
    v_mfma_f32_16x16x32_bf16 v[0:3], v[80:83], v[88:91], v[0:3]
    ds_read_b64_tr_b16 v[48:49], v120 offset:0
    v_mfma_f32_16x16x32_bf16 v[4:7], v[84:87], v[88:91], v[4:7]
    ds_read_b64_tr_b16 v[50:51], v120 offset:1024
    s_waitcnt lgkmcnt(6)
    v_mfma_f32_16x16x32_bf16 v[8:11], v[80:83], v[92:95], v[8:11]
    ds_read_b64_tr_b16 v[52:53], v124 offset:0
    v_mfma_f32_16x16x32_bf16 v[12:15], v[84:87], v[92:95], v[12:15]
    ds_read_b64_tr_b16 v[54:55], v124 offset:1024
    s_waitcnt lgkmcnt(7)
    v_mfma_f32_16x16x32_bf16 v[16:19], v[80:83], v[96:99], v[16:19]
    ds_read_b128 v[56:59], v113 offset:12288
    v_mfma_f32_16x16x32_bf16 v[20:23], v[84:87], v[96:99], v[20:23]
    ds_read_b128 v[60:63], v113 offset:13312
    s_waitcnt lgkmcnt(8)
    v_mfma_f32_16x16x32_bf16 v[24:27], v[80:83], v[100:103], v[24:27]
    ds_read_b128 v[64:67], v113 offset:14336
    v_mfma_f32_16x16x32_bf16 v[28:31], v[84:87], v[100:103], v[28:31]
    ds_read_b128 v[68:71], v113 offset:15360
    s_waitcnt lgkmcnt(9)
    v_mfma_f32_16x16x32_bf16 v[32:35], v[80:83], v[104:107], v[32:35]
    ds_read_b128 v[72:75], v113 offset:16384
    v_mfma_f32_16x16x32_bf16 v[36:39], v[84:87], v[104:107], v[36:39]
    ds_read_b128 v[76:79], v113 offset:17408
    s_waitcnt lgkmcnt(10)
    v_mfma_f32_16x16x32_bf16 v[40:43], v[80:83], v[108:111], v[40:43]
    v_mfma_f32_16x16x32_bf16 v[44:47], v[84:87], v[108:111], v[44:47]
    s_waitcnt lgkmcnt(5)
    v_mfma_f32_16x16x32_bf16 v[0:3], v[48:51], v[56:59], v[0:3]
    ds_read_b64_tr_b16 v[80:81], v120 offset:8192
    v_mfma_f32_16x16x32_bf16 v[4:7], v[52:55], v[56:59], v[4:7]
    ds_read_b64_tr_b16 v[82:83], v120 offset:9216
    s_waitcnt lgkmcnt(6)
    v_mfma_f32_16x16x32_bf16 v[8:11], v[48:51], v[60:63], v[8:11]
    ds_read_b64_tr_b16 v[84:85], v124 offset:8192
    v_mfma_f32_16x16x32_bf16 v[12:15], v[52:55], v[60:63], v[12:15]
    ds_read_b64_tr_b16 v[86:87], v124 offset:9216
    s_waitcnt lgkmcnt(7)
    v_mfma_f32_16x16x32_bf16 v[16:19], v[48:51], v[64:67], v[16:19]
    ds_read_b128 v[88:91], v113 offset:18432
    v_mfma_f32_16x16x32_bf16 v[20:23], v[52:55], v[64:67], v[20:23]
    ds_read_b128 v[92:95], v113 offset:19456
    s_waitcnt lgkmcnt(8)
    v_mfma_f32_16x16x32_bf16 v[24:27], v[48:51], v[68:71], v[24:27]
    ds_read_b128 v[96:99], v113 offset:20480
    v_mfma_f32_16x16x32_bf16 v[28:31], v[52:55], v[68:71], v[28:31]
    ds_read_b128 v[100:103], v113 offset:21504
    s_waitcnt lgkmcnt(9)
    v_mfma_f32_16x16x32_bf16 v[32:35], v[48:51], v[72:75], v[32:35]
    ds_read_b128 v[104:107], v113 offset:22528
    v_mfma_f32_16x16x32_bf16 v[36:39], v[52:55], v[72:75], v[36:39]
    ds_read_b128 v[108:111], v113 offset:23552
    s_waitcnt lgkmcnt(10)
    v_mfma_f32_16x16x32_bf16 v[40:43], v[48:51], v[76:79], v[40:43]
    v_mfma_f32_16x16x32_bf16 v[44:47], v[52:55], v[76:79], v[44:47]
    s_barrier
    s_waitcnt lgkmcnt(5)
    v_mfma_f32_16x16x32_bf16 v[0:3], v[80:83], v[88:91], v[0:3]
    ds_read_b64_tr_b16 v[48:49], v120 offset:40960
    v_mfma_f32_16x16x32_bf16 v[4:7], v[84:87], v[88:91], v[4:7]
    ds_read_b64_tr_b16 v[50:51], v120 offset:41984
    s_waitcnt lgkmcnt(6)
    v_mfma_f32_16x16x32_bf16 v[8:11], v[80:83], v[92:95], v[8:11]
    ds_read_b64_tr_b16 v[52:53], v124 offset:40960
    v_mfma_f32_16x16x32_bf16 v[12:15], v[84:87], v[92:95], v[12:15]
    ds_read_b64_tr_b16 v[54:55], v124 offset:41984
    s_waitcnt lgkmcnt(7)
    v_mfma_f32_16x16x32_bf16 v[16:19], v[80:83], v[96:99], v[16:19]
    ds_read_b128 v[56:59], v113 offset:40960
    v_mfma_f32_16x16x32_bf16 v[20:23], v[84:87], v[96:99], v[20:23]
    ds_read_b128 v[60:63], v113 offset:41984
    s_waitcnt lgkmcnt(8)
    v_mfma_f32_16x16x32_bf16 v[24:27], v[80:83], v[100:103], v[24:27]
    ds_read_b128 v[64:67], v113 offset:43008
    v_mfma_f32_16x16x32_bf16 v[28:31], v[84:87], v[100:103], v[28:31]
    ds_read_b128 v[68:71], v113 offset:44032
    s_waitcnt lgkmcnt(9)
    v_mfma_f32_16x16x32_bf16 v[32:35], v[80:83], v[104:107], v[32:35]
    ds_read_b128 v[72:75], v113 offset:45056
    v_mfma_f32_16x16x32_bf16 v[36:39], v[84:87], v[104:107], v[36:39]
    ds_read_b128 v[76:79], v113 offset:46080
    s_waitcnt lgkmcnt(10)
    v_mfma_f32_16x16x32_bf16 v[40:43], v[80:83], v[108:111], v[40:43]
    v_mfma_f32_16x16x32_bf16 v[44:47], v[84:87], v[108:111], v[44:47]
    s_waitcnt lgkmcnt(5)
    v_mfma_f32_16x16x32_bf16 v[0:3], v[48:51], v[56:59], v[0:3]
    ds_read_b64_tr_b16 v[80:81], v120 offset:49152
    v_mfma_f32_16x16x32_bf16 v[4:7], v[52:55], v[56:59], v[4:7]
    ds_read_b64_tr_b16 v[82:83], v120 offset:50176
    s_waitcnt lgkmcnt(6)
    v_mfma_f32_16x16x32_bf16 v[8:11], v[48:51], v[60:63], v[8:11]
    ds_read_b64_tr_b16 v[84:85], v124 offset:49152
    v_mfma_f32_16x16x32_bf16 v[12:15], v[52:55], v[60:63], v[12:15]
    ds_read_b64_tr_b16 v[86:87], v124 offset:50176
    s_waitcnt lgkmcnt(7)
    v_mfma_f32_16x16x32_bf16 v[16:19], v[48:51], v[64:67], v[16:19]
    ds_read_b128 v[88:91], v113 offset:47104
    v_mfma_f32_16x16x32_bf16 v[20:23], v[52:55], v[64:67], v[20:23]
    ds_read_b128 v[92:95], v113 offset:48128
    s_waitcnt lgkmcnt(8)
    v_mfma_f32_16x16x32_bf16 v[24:27], v[48:51], v[68:71], v[24:27]
    ds_read_b128 v[96:99], v113 offset:49152
    v_mfma_f32_16x16x32_bf16 v[28:31], v[52:55], v[68:71], v[28:31]
    ds_read_b128 v[100:103], v113 offset:50176
    s_waitcnt lgkmcnt(9)
    v_mfma_f32_16x16x32_bf16 v[32:35], v[48:51], v[72:75], v[32:35]
    ds_read_b128 v[104:107], v113 offset:51200
    v_mfma_f32_16x16x32_bf16 v[36:39], v[52:55], v[72:75], v[36:39]
    ds_read_b128 v[108:111], v113 offset:52224
    s_waitcnt lgkmcnt(10)
    v_mfma_f32_16x16x32_bf16 v[40:43], v[48:51], v[76:79], v[40:43]
    v_mfma_f32_16x16x32_bf16 v[44:47], v[52:55], v[76:79], v[44:47]
    s_barrier
    s_waitcnt lgkmcnt(5)
    v_mfma_f32_16x16x32_bf16 v[0:3], v[80:83], v[88:91], v[0:3]
    ds_read_b64_tr_b16 v[48:49], v121 offset:24576
    v_mfma_f32_16x16x32_bf16 v[4:7], v[84:87], v[88:91], v[4:7]
    ds_read_b64_tr_b16 v[50:51], v121 offset:25600
    s_waitcnt lgkmcnt(6)
    v_mfma_f32_16x16x32_bf16 v[8:11], v[80:83], v[92:95], v[8:11]
    ds_read_b64_tr_b16 v[52:53], v125 offset:24576
    v_mfma_f32_16x16x32_bf16 v[12:15], v[84:87], v[92:95], v[12:15]
    ds_read_b64_tr_b16 v[54:55], v125 offset:25600
    s_waitcnt lgkmcnt(7)
    v_mfma_f32_16x16x32_bf16 v[16:19], v[80:83], v[96:99], v[16:19]
    ds_read_b128 v[56:59], v113 offset:53248
    v_mfma_f32_16x16x32_bf16 v[20:23], v[84:87], v[96:99], v[20:23]
    ds_read_b128 v[60:63], v113 offset:54272
    s_waitcnt lgkmcnt(8)
    v_mfma_f32_16x16x32_bf16 v[24:27], v[80:83], v[100:103], v[24:27]
    ds_read_b128 v[64:67], v113 offset:55296
    v_mfma_f32_16x16x32_bf16 v[28:31], v[84:87], v[100:103], v[28:31]
    ds_read_b128 v[68:71], v113 offset:56320
    s_waitcnt lgkmcnt(9)
    v_mfma_f32_16x16x32_bf16 v[32:35], v[80:83], v[104:107], v[32:35]
    ds_read_b128 v[72:75], v113 offset:57344
    v_mfma_f32_16x16x32_bf16 v[36:39], v[84:87], v[104:107], v[36:39]
    ds_read_b128 v[76:79], v113 offset:58368
    s_waitcnt lgkmcnt(10)
    v_mfma_f32_16x16x32_bf16 v[40:43], v[80:83], v[108:111], v[40:43]
    v_mfma_f32_16x16x32_bf16 v[44:47], v[84:87], v[108:111], v[44:47]
    s_waitcnt lgkmcnt(5)
    v_mfma_f32_16x16x32_bf16 v[0:3], v[48:51], v[56:59], v[0:3]
    ds_read_b64_tr_b16 v[80:81], v121 offset:32768
    v_mfma_f32_16x16x32_bf16 v[4:7], v[52:55], v[56:59], v[4:7]
    ds_read_b64_tr_b16 v[82:83], v121 offset:33792
    s_waitcnt lgkmcnt(6)
    v_mfma_f32_16x16x32_bf16 v[8:11], v[48:51], v[60:63], v[8:11]
    ds_read_b64_tr_b16 v[84:85], v125 offset:32768
    v_mfma_f32_16x16x32_bf16 v[12:15], v[52:55], v[60:63], v[12:15]
    ds_read_b64_tr_b16 v[86:87], v125 offset:33792
    s_waitcnt lgkmcnt(7)
    v_mfma_f32_16x16x32_bf16 v[16:19], v[48:51], v[64:67], v[16:19]
    ds_read_b128 v[88:91], v113 offset:59392
    v_mfma_f32_16x16x32_bf16 v[20:23], v[52:55], v[64:67], v[20:23]
    ds_read_b128 v[92:95], v113 offset:60416
    s_waitcnt lgkmcnt(8)
    v_mfma_f32_16x16x32_bf16 v[24:27], v[48:51], v[68:71], v[24:27]
    ds_read_b128 v[96:99], v113 offset:61440
    v_mfma_f32_16x16x32_bf16 v[28:31], v[52:55], v[68:71], v[28:31]
    ds_read_b128 v[100:103], v113 offset:62464
    s_waitcnt lgkmcnt(9)
    v_mfma_f32_16x16x32_bf16 v[32:35], v[48:51], v[72:75], v[32:35]
    ds_read_b128 v[104:107], v113 offset:63488
    v_mfma_f32_16x16x32_bf16 v[36:39], v[52:55], v[72:75], v[36:39]
    ds_read_b128 v[108:111], v113 offset:64512
    s_waitcnt lgkmcnt(10)
    v_mfma_f32_16x16x32_bf16 v[40:43], v[48:51], v[76:79], v[40:43]
    v_mfma_f32_16x16x32_bf16 v[44:47], v[52:55], v[76:79], v[44:47]
    s_barrier
    s_waitcnt lgkmcnt(5)
    v_mfma_f32_16x16x32_bf16 v[0:3], v[80:83], v[88:91], v[0:3]
    ds_read_b64_tr_b16 v[48:49], v121 offset:0
    v_mfma_f32_16x16x32_bf16 v[4:7], v[84:87], v[88:91], v[4:7]
    ds_read_b64_tr_b16 v[50:51], v121 offset:1024
    s_waitcnt lgkmcnt(6)
    v_mfma_f32_16x16x32_bf16 v[8:11], v[80:83], v[92:95], v[8:11]
    ds_read_b64_tr_b16 v[52:53], v125 offset:0
    v_mfma_f32_16x16x32_bf16 v[12:15], v[84:87], v[92:95], v[12:15]
    ds_read_b64_tr_b16 v[54:55], v125 offset:1024
    s_waitcnt lgkmcnt(7)
    v_mfma_f32_16x16x32_bf16 v[16:19], v[80:83], v[96:99], v[16:19]
    ds_read_b128 v[56:59], v122 offset:0
    v_mfma_f32_16x16x32_bf16 v[20:23], v[84:87], v[96:99], v[20:23]
    ds_read_b128 v[60:63], v122 offset:1024
    s_waitcnt lgkmcnt(8)
    v_mfma_f32_16x16x32_bf16 v[24:27], v[80:83], v[100:103], v[24:27]
    ds_read_b128 v[64:67], v122 offset:2048
    v_mfma_f32_16x16x32_bf16 v[28:31], v[84:87], v[100:103], v[28:31]
    ds_read_b128 v[68:71], v122 offset:3072
    s_waitcnt lgkmcnt(9)
    v_mfma_f32_16x16x32_bf16 v[32:35], v[80:83], v[104:107], v[32:35]
    ds_read_b128 v[72:75], v122 offset:4096
    v_mfma_f32_16x16x32_bf16 v[36:39], v[84:87], v[104:107], v[36:39]
    ds_read_b128 v[76:79], v122 offset:5120
    s_waitcnt lgkmcnt(10)
    v_mfma_f32_16x16x32_bf16 v[40:43], v[80:83], v[108:111], v[40:43]
    v_mfma_f32_16x16x32_bf16 v[44:47], v[84:87], v[108:111], v[44:47]
    s_waitcnt lgkmcnt(5)
    v_mfma_f32_16x16x32_bf16 v[0:3], v[48:51], v[56:59], v[0:3]
    ds_read_b64_tr_b16 v[80:81], v121 offset:8192
    v_mfma_f32_16x16x32_bf16 v[4:7], v[52:55], v[56:59], v[4:7]
    ds_read_b64_tr_b16 v[82:83], v121 offset:9216
    s_waitcnt lgkmcnt(6)
    v_mfma_f32_16x16x32_bf16 v[8:11], v[48:51], v[60:63], v[8:11]
    ds_read_b64_tr_b16 v[84:85], v125 offset:8192
    v_mfma_f32_16x16x32_bf16 v[12:15], v[52:55], v[60:63], v[12:15]
    ds_read_b64_tr_b16 v[86:87], v125 offset:9216
    s_waitcnt lgkmcnt(7)
    v_mfma_f32_16x16x32_bf16 v[16:19], v[48:51], v[64:67], v[16:19]
    ds_read_b128 v[88:91], v122 offset:6144
    v_mfma_f32_16x16x32_bf16 v[20:23], v[52:55], v[64:67], v[20:23]
    ds_read_b128 v[92:95], v122 offset:7168
    s_waitcnt lgkmcnt(8)
    v_mfma_f32_16x16x32_bf16 v[24:27], v[48:51], v[68:71], v[24:27]
    ds_read_b128 v[96:99], v122 offset:8192
    v_mfma_f32_16x16x32_bf16 v[28:31], v[52:55], v[68:71], v[28:31]
    ds_read_b128 v[100:103], v122 offset:9216
    s_waitcnt lgkmcnt(9)
    v_mfma_f32_16x16x32_bf16 v[32:35], v[48:51], v[72:75], v[32:35]
    ds_read_b128 v[104:107], v122 offset:10240
    v_mfma_f32_16x16x32_bf16 v[36:39], v[52:55], v[72:75], v[36:39]
    ds_read_b128 v[108:111], v122 offset:11264
    s_waitcnt lgkmcnt(10)
    v_mfma_f32_16x16x32_bf16 v[40:43], v[48:51], v[76:79], v[40:43]
    v_mfma_f32_16x16x32_bf16 v[44:47], v[52:55], v[76:79], v[44:47]
    s_barrier
    s_waitcnt lgkmcnt(5)
    v_mfma_f32_16x16x32_bf16 v[0:3], v[80:83], v[88:91], v[0:3]
    ds_read_b64_tr_b16 v[48:49], v112 offset:24576
    v_mfma_f32_16x16x32_bf16 v[4:7], v[84:87], v[88:91], v[4:7]
    ds_read_b64_tr_b16 v[50:51], v112 offset:25600
    s_waitcnt lgkmcnt(6)
    v_mfma_f32_16x16x32_bf16 v[8:11], v[80:83], v[92:95], v[8:11]
    ds_read_b64_tr_b16 v[52:53], v123 offset:24576
    v_mfma_f32_16x16x32_bf16 v[12:15], v[84:87], v[92:95], v[12:15]
    ds_read_b64_tr_b16 v[54:55], v123 offset:25600
    s_waitcnt lgkmcnt(7)
    v_mfma_f32_16x16x32_bf16 v[16:19], v[80:83], v[96:99], v[16:19]
    ds_read_b128 v[56:59], v113 offset:0
    v_mfma_f32_16x16x32_bf16 v[20:23], v[84:87], v[96:99], v[20:23]
    ds_read_b128 v[60:63], v113 offset:1024
    s_waitcnt lgkmcnt(8)
    v_mfma_f32_16x16x32_bf16 v[24:27], v[80:83], v[100:103], v[24:27]
    ds_read_b128 v[64:67], v113 offset:2048
    v_mfma_f32_16x16x32_bf16 v[28:31], v[84:87], v[100:103], v[28:31]
    ds_read_b128 v[68:71], v113 offset:3072
    s_waitcnt lgkmcnt(9)
    v_mfma_f32_16x16x32_bf16 v[32:35], v[80:83], v[104:107], v[32:35]
    ds_read_b128 v[72:75], v113 offset:4096
    v_mfma_f32_16x16x32_bf16 v[36:39], v[84:87], v[104:107], v[36:39]
    ds_read_b128 v[76:79], v113 offset:5120
    s_waitcnt lgkmcnt(10)
    v_mfma_f32_16x16x32_bf16 v[40:43], v[80:83], v[108:111], v[40:43]
    v_mfma_f32_16x16x32_bf16 v[44:47], v[84:87], v[108:111], v[44:47]
    s_waitcnt lgkmcnt(5)
    v_mfma_f32_16x16x32_bf16 v[0:3], v[48:51], v[56:59], v[0:3]
    ds_read_b64_tr_b16 v[80:81], v112 offset:32768
    v_mfma_f32_16x16x32_bf16 v[4:7], v[52:55], v[56:59], v[4:7]
    ds_read_b64_tr_b16 v[82:83], v112 offset:33792
    s_waitcnt lgkmcnt(6)
    v_mfma_f32_16x16x32_bf16 v[8:11], v[48:51], v[60:63], v[8:11]
    ds_read_b64_tr_b16 v[84:85], v123 offset:32768
    v_mfma_f32_16x16x32_bf16 v[12:15], v[52:55], v[60:63], v[12:15]
    ds_read_b64_tr_b16 v[86:87], v123 offset:33792
    s_waitcnt lgkmcnt(7)
    v_mfma_f32_16x16x32_bf16 v[16:19], v[48:51], v[64:67], v[16:19]
    ds_read_b128 v[88:91], v113 offset:6144
    v_mfma_f32_16x16x32_bf16 v[20:23], v[52:55], v[64:67], v[20:23]
    ds_read_b128 v[92:95], v113 offset:7168
    s_waitcnt lgkmcnt(8)
    v_mfma_f32_16x16x32_bf16 v[24:27], v[48:51], v[68:71], v[24:27]
    ds_read_b128 v[96:99], v113 offset:8192
    v_mfma_f32_16x16x32_bf16 v[28:31], v[52:55], v[68:71], v[28:31]
    ds_read_b128 v[100:103], v113 offset:9216
    s_waitcnt lgkmcnt(9)
    v_mfma_f32_16x16x32_bf16 v[32:35], v[48:51], v[72:75], v[32:35]
    ds_read_b128 v[104:107], v113 offset:10240
    v_mfma_f32_16x16x32_bf16 v[36:39], v[52:55], v[72:75], v[36:39]
    ds_read_b128 v[108:111], v113 offset:11264
    s_waitcnt lgkmcnt(10)
    v_mfma_f32_16x16x32_bf16 v[40:43], v[48:51], v[76:79], v[40:43]
    v_mfma_f32_16x16x32_bf16 v[44:47], v[52:55], v[76:79], v[44:47]
    s_waitcnt lgkmcnt(5)
    v_mfma_f32_16x16x32_bf16 v[0:3], v[80:83], v[88:91], v[0:3]
    v_mfma_f32_16x16x32_bf16 v[4:7], v[84:87], v[88:91], v[4:7]
    s_waitcnt lgkmcnt(4)
    v_mfma_f32_16x16x32_bf16 v[8:11], v[80:83], v[92:95], v[8:11]
    v_mfma_f32_16x16x32_bf16 v[12:15], v[84:87], v[92:95], v[12:15]
    s_waitcnt lgkmcnt(3)
    v_mfma_f32_16x16x32_bf16 v[16:19], v[80:83], v[96:99], v[16:19]
    v_mfma_f32_16x16x32_bf16 v[20:23], v[84:87], v[96:99], v[20:23]
    s_waitcnt lgkmcnt(2)
    v_mfma_f32_16x16x32_bf16 v[24:27], v[80:83], v[100:103], v[24:27]
    v_mfma_f32_16x16x32_bf16 v[28:31], v[84:87], v[100:103], v[28:31]
    s_waitcnt lgkmcnt(1)
    v_mfma_f32_16x16x32_bf16 v[32:35], v[80:83], v[104:107], v[32:35]
    v_mfma_f32_16x16x32_bf16 v[36:39], v[84:87], v[104:107], v[36:39]
    s_waitcnt lgkmcnt(0)
    v_mfma_f32_16x16x32_bf16 v[40:43], v[80:83], v[108:111], v[40:43]
    v_mfma_f32_16x16x32_bf16 v[44:47], v[84:87], v[108:111], v[44:47]
    s_cmp_eq_u32 s33, s30
    s_cbranch_scc0 L_t_pub
    v_permlane16_swap_b32 v0, v4
    v_permlane16_swap_b32 v1, v5
    v_permlane16_swap_b32 v2, v6
    v_permlane16_swap_b32 v3, v7
    ds_write_b128 v116, v[0:3] offset:0
    ds_write_b128 v116, v[4:7] offset:1024
    v_permlane16_swap_b32 v8, v12
    v_permlane16_swap_b32 v9, v13
    v_permlane16_swap_b32 v10, v14
    v_permlane16_swap_b32 v11, v15
    ds_write_b128 v116, v[8:11] offset:2048
    ds_write_b128 v116, v[12:15] offset:3072
    v_permlane16_swap_b32 v16, v20
    v_permlane16_swap_b32 v17, v21
    v_permlane16_swap_b32 v18, v22
    v_permlane16_swap_b32 v19, v23
    ds_write_b128 v116, v[16:19] offset:4096
    ds_write_b128 v116, v[20:23] offset:5120
    v_permlane16_swap_b32 v24, v28
    v_permlane16_swap_b32 v25, v29
    v_permlane16_swap_b32 v26, v30
    v_permlane16_swap_b32 v27, v31
    ds_write_b128 v116, v[24:27] offset:6144
    ds_write_b128 v116, v[28:31] offset:7168
    v_permlane16_swap_b32 v32, v36
    v_permlane16_swap_b32 v33, v37
    v_permlane16_swap_b32 v34, v38
    v_permlane16_swap_b32 v35, v39
    ds_write_b128 v116, v[32:35] offset:8192
    ds_write_b128 v116, v[36:39] offset:9216
    v_permlane16_swap_b32 v40, v44
    v_permlane16_swap_b32 v41, v45
    v_permlane16_swap_b32 v42, v46
    v_permlane16_swap_b32 v43, v47
    ds_write_b128 v116, v[40:43] offset:10240
    ds_write_b128 v116, v[44:47] offset:11264
    s_waitcnt lgkmcnt(0)
    s_branch L_t_join
L_t_pub:
    v_cvt_pk_bf16_f32 v48, v0, v1
    v_cvt_pk_bf16_f32 v49, v2, v3
    v_cvt_pk_bf16_f32 v50, v4, v5
    v_cvt_pk_bf16_f32 v51, v6, v7
    s_nop 0
    v_permlane16_swap_b32 v48, v50
    v_permlane16_swap_b32 v49, v51
    buffer_store_dwordx4 v[48:51], v117, s[24:27], s70 offen offset:0 sc1
    v_cvt_pk_bf16_f32 v52, v8, v9
    v_cvt_pk_bf16_f32 v53, v10, v11
    v_cvt_pk_bf16_f32 v54, v12, v13
    v_cvt_pk_bf16_f32 v55, v14, v15
    s_nop 0
    v_permlane16_swap_b32 v52, v54
    v_permlane16_swap_b32 v53, v55
    buffer_store_dwordx4 v[52:55], v117, s[24:27], s70 offen offset:1024 sc1
    v_cvt_pk_bf16_f32 v56, v16, v17
    v_cvt_pk_bf16_f32 v57, v18, v19
    v_cvt_pk_bf16_f32 v58, v20, v21
    v_cvt_pk_bf16_f32 v59, v22, v23
    s_nop 0
    v_permlane16_swap_b32 v56, v58
    v_permlane16_swap_b32 v57, v59
    buffer_store_dwordx4 v[56:59], v117, s[24:27], s70 offen offset:2048 sc1
    v_cvt_pk_bf16_f32 v60, v24, v25
    v_cvt_pk_bf16_f32 v61, v26, v27
    v_cvt_pk_bf16_f32 v62, v28, v29
    v_cvt_pk_bf16_f32 v63, v30, v31
    s_nop 0
    v_permlane16_swap_b32 v60, v62
    v_permlane16_swap_b32 v61, v63
    buffer_store_dwordx4 v[60:63], v117, s[24:27], s70 offen offset:3072 sc1
    v_cvt_pk_bf16_f32 v64, v32, v33
    v_cvt_pk_bf16_f32 v65, v34, v35
    v_cvt_pk_bf16_f32 v66, v36, v37
    v_cvt_pk_bf16_f32 v67, v38, v39
    s_nop 0
    v_permlane16_swap_b32 v64, v66
    v_permlane16_swap_b32 v65, v67
    buffer_store_dwordx4 v[64:67], v117, s[24:27], s71 offen offset:0 sc1
    v_cvt_pk_bf16_f32 v68, v40, v41
    v_cvt_pk_bf16_f32 v69, v42, v43
    v_cvt_pk_bf16_f32 v70, v44, v45
    v_cvt_pk_bf16_f32 v71, v46, v47
    s_nop 0
    v_permlane16_swap_b32 v68, v70
    v_permlane16_swap_b32 v69, v71
    buffer_store_dwordx4 v[68:71], v117, s[24:27], s71 offen offset:1024 sc1
    s_waitcnt vmcnt(0)
    s_mov_b64 exec, 1
    buffer_store_dword v162, v160, s[24:27], s72 offen sc1
    s_mov_b64 exec, -1
L_t_join:
    s_barrier
    s_cmp_ge_u32 s28, 6
    s_cbranch_scc1 L_fin4
    s_lshl_b32 s3, s59, 2
    s_add_u32 s3, s3, s30
    s_mul_i32 s76, s3, 24576
    s_lshl_b32 s3, s28, 10
    s_add_u32 s76, s76, s3
    s_add_u32 s76, s76, 16777216
    v_lshlrev_b32 v116, 4, v163
    s_add_u32 s3, s30, 1
    s_and_b32 s3, s3, 3
    s_mul_i32 s3, s3, 6144
    s_add_u32 s77, s76, s3
    buffer_load_dwordx4 v[24:27], v116, s[24:27], s77 offen sc1
    s_add_u32 s3, s30, 2
    s_and_b32 s3, s3, 3
    s_mul_i32 s3, s3, 6144
    s_add_u32 s77, s76, s3
    buffer_load_dwordx4 v[28:31], v116, s[24:27], s77 offen sc1
    s_add_u32 s3, s30, 3
    s_and_b32 s3, s3, 3
    s_mul_i32 s3, s3, 6144
    s_add_u32 s77, s76, s3
    buffer_load_dwordx4 v[32:35], v116, s[24:27], s77 offen sc1
    s_lshl_b32 s3, s28, 11
    s_add_u32 s3, s3, 94208
    v_add_u32 v119, s3, v116
    ds_read_b128 v[8:11], v119
    ds_read_b128 v[12:15], v119 offset:1024
    s_mul_i32 s3, s54, 96
    s_lshl_b32 s77, s28, 4
    s_add_u32 s3, s3, s77
    s_lshl_b32 s3, s3, 12
    s_lshl_b32 s77, s29, 11
    s_add_u32 s3, s3, s77
    s_lshl_b32 s77, s55, 8
    s_add_u32 s3, s3, s77
    s_lshl_b32 s77, s30, 6
    s_add_u32 s3, s3, s77
    v_and_b32 v117, 15, v163
    v_lshlrev_b32 v117, 12, v117
    v_bfe_u32 v118, v163, 4, 1
    v_lshlrev_b32 v118, 5, v118
    v_add_u32 v117, v117, v118
    v_lshrrev_b32 v118, 5, v163
    v_lshlrev_b32 v118, 4, v118
    v_add_u32 v117, v117, v118
    s_waitcnt lgkmcnt(0)
    s_waitcnt vmcnt(2)
    v_lshlrev_b32 v36, 16, v24
    v_and_b32 v37, 0xffff0000, v24
    v_add_f32 v8, v8, v36
    v_add_f32 v9, v9, v37
    v_lshlrev_b32 v38, 16, v25
    v_and_b32 v39, 0xffff0000, v25
    v_add_f32 v10, v10, v38
    v_add_f32 v11, v11, v39
    v_lshlrev_b32 v36, 16, v26
    v_and_b32 v37, 0xffff0000, v26
    v_add_f32 v12, v12, v36
    v_add_f32 v13, v13, v37
    v_lshlrev_b32 v38, 16, v27
    v_and_b32 v39, 0xffff0000, v27
    v_add_f32 v14, v14, v38
    v_add_f32 v15, v15, v39
    s_waitcnt vmcnt(1)
    v_lshlrev_b32 v36, 16, v28
    v_and_b32 v37, 0xffff0000, v28
    v_add_f32 v8, v8, v36
    v_add_f32 v9, v9, v37
    v_lshlrev_b32 v38, 16, v29
    v_and_b32 v39, 0xffff0000, v29
    v_add_f32 v10, v10, v38
    v_add_f32 v11, v11, v39
    v_lshlrev_b32 v36, 16, v30
    v_and_b32 v37, 0xffff0000, v30
    v_add_f32 v12, v12, v36
    v_add_f32 v13, v13, v37
    v_lshlrev_b32 v38, 16, v31
    v_and_b32 v39, 0xffff0000, v31
    v_add_f32 v14, v14, v38
    v_add_f32 v15, v15, v39
    s_waitcnt vmcnt(0)
    v_lshlrev_b32 v36, 16, v32
    v_and_b32 v37, 0xffff0000, v32
    v_add_f32 v8, v8, v36
    v_add_f32 v9, v9, v37
    v_lshlrev_b32 v38, 16, v33
    v_and_b32 v39, 0xffff0000, v33
    v_add_f32 v10, v10, v38
    v_add_f32 v11, v11, v39
    v_lshlrev_b32 v36, 16, v34
    v_and_b32 v37, 0xffff0000, v34
    v_add_f32 v12, v12, v36
    v_add_f32 v13, v13, v37
    v_lshlrev_b32 v38, 16, v35
    v_and_b32 v39, 0xffff0000, v35
    v_add_f32 v14, v14, v38
    v_add_f32 v15, v15, v39
    v_cvt_pk_bf16_f32 v16, v8, v9
    v_cvt_pk_bf16_f32 v17, v10, v11
    v_cvt_pk_bf16_f32 v18, v12, v13
    v_cvt_pk_bf16_f32 v19, v14, v15
    buffer_store_dwordx4 v[16:19], v117, s[8:11], s3 offen
L_fin4:
    s_endpgm
L_mrg_gen:
    s_waitcnt lgkmcnt(0)
    v_max3_f32 v120, v156, v114, v116
    v_max_f32 v120, v120, v118
    v_sub_f32 v122, v156, v120
    v_sub_f32 v124, v114, v120
    v_sub_f32 v126, v116, v120
    v_sub_f32 v128, v118, v120
    v_exp_f32 v122, v122
    v_exp_f32 v124, v124
    v_exp_f32 v126, v126
    v_exp_f32 v128, v128
    v_mul_f32 v130, v122, v157
    v_fma_f32 v130, v124, v115, v130
    v_fma_f32 v130, v126, v117, v130
    v_fma_f32 v130, v128, v119, v130
    v_rcp_f32 v130, v130
    s_nop 0
    v_mul_f32 v122, v122, v130
    v_mul_f32 v124, v124, v130
    v_mul_f32 v126, v126, v130
    v_mul_f32 v128, v128, v130
    v_mul_f32 v0, v0, v122
    v_mul_f32 v1, v1, v122
    v_mul_f32 v2, v2, v122
    v_mul_f32 v3, v3, v122
    v_mul_f32 v4, v4, v122
    v_mul_f32 v5, v5, v122
    v_mul_f32 v6, v6, v122
    v_mul_f32 v7, v7, v122
    v_mul_f32 v8, v8, v122
    v_mul_f32 v9, v9, v122
    v_mul_f32 v10, v10, v122
    v_mul_f32 v11, v11, v122
    v_mul_f32 v12, v12, v122
    v_mul_f32 v13, v13, v122
    v_mul_f32 v14, v14, v122
    v_mul_f32 v15, v15, v122
    v_lshlrev_b32 v120, 16, v16
    v_and_b32 v121, 0xffff0000, v16
    v_fma_f32 v0, v120, v124, v0
    v_fma_f32 v1, v121, v124, v1
    v_lshlrev_b32 v120, 16, v17
    v_and_b32 v121, 0xffff0000, v17
    v_fma_f32 v2, v120, v124, v2
    v_fma_f32 v3, v121, v124, v3
    v_lshlrev_b32 v120, 16, v18
    v_and_b32 v121, 0xffff0000, v18
    v_fma_f32 v4, v120, v124, v4
    v_fma_f32 v5, v121, v124, v5
    v_lshlrev_b32 v120, 16, v19
    v_and_b32 v121, 0xffff0000, v19
    v_fma_f32 v6, v120, v124, v6
    v_fma_f32 v7, v121, v124, v7
    v_lshlrev_b32 v120, 16, v20
    v_and_b32 v121, 0xffff0000, v20
    v_fma_f32 v8, v120, v124, v8
    v_fma_f32 v9, v121, v124, v9
    v_lshlrev_b32 v120, 16, v21
    v_and_b32 v121, 0xffff0000, v21
    v_fma_f32 v10, v120, v124, v10
    v_fma_f32 v11, v121, v124, v11
    v_lshlrev_b32 v120, 16, v22
    v_and_b32 v121, 0xffff0000, v22
    v_fma_f32 v12, v120, v124, v12
    v_fma_f32 v13, v121, v124, v13
    v_lshlrev_b32 v120, 16, v23
    v_and_b32 v121, 0xffff0000, v23
    v_fma_f32 v14, v120, v124, v14
    v_fma_f32 v15, v121, v124, v15
    v_lshlrev_b32 v120, 16, v32
    v_and_b32 v121, 0xffff0000, v32
    v_fma_f32 v0, v120, v126, v0
    v_fma_f32 v1, v121, v126, v1
    v_lshlrev_b32 v120, 16, v33
    v_and_b32 v121, 0xffff0000, v33
    v_fma_f32 v2, v120, v126, v2
    v_fma_f32 v3, v121, v126, v3
    v_lshlrev_b32 v120, 16, v34
    v_and_b32 v121, 0xffff0000, v34
    v_fma_f32 v4, v120, v126, v4
    v_fma_f32 v5, v121, v126, v5
    v_lshlrev_b32 v120, 16, v35
    v_and_b32 v121, 0xffff0000, v35
    v_fma_f32 v6, v120, v126, v6
    v_fma_f32 v7, v121, v126, v7
    v_lshlrev_b32 v120, 16, v36
    v_and_b32 v121, 0xffff0000, v36
    v_fma_f32 v8, v120, v126, v8
    v_fma_f32 v9, v121, v126, v9
    v_lshlrev_b32 v120, 16, v37
    v_and_b32 v121, 0xffff0000, v37
    v_fma_f32 v10, v120, v126, v10
    v_fma_f32 v11, v121, v126, v11
    v_lshlrev_b32 v120, 16, v38
    v_and_b32 v121, 0xffff0000, v38
    v_fma_f32 v12, v120, v126, v12
    v_fma_f32 v13, v121, v126, v13
    v_lshlrev_b32 v120, 16, v39
    v_and_b32 v121, 0xffff0000, v39
    v_fma_f32 v14, v120, v126, v14
    v_fma_f32 v15, v121, v126, v15
    v_lshlrev_b32 v120, 16, v48
    v_and_b32 v121, 0xffff0000, v48
    v_fma_f32 v0, v120, v128, v0
    v_fma_f32 v1, v121, v128, v1
    v_lshlrev_b32 v120, 16, v49
    v_and_b32 v121, 0xffff0000, v49
    v_fma_f32 v2, v120, v128, v2
    v_fma_f32 v3, v121, v128, v3
    v_lshlrev_b32 v120, 16, v50
    v_and_b32 v121, 0xffff0000, v50
    v_fma_f32 v4, v120, v128, v4
    v_fma_f32 v5, v121, v128, v5
    v_lshlrev_b32 v120, 16, v51
    v_and_b32 v121, 0xffff0000, v51
    v_fma_f32 v6, v120, v128, v6
    v_fma_f32 v7, v121, v128, v7
    v_lshlrev_b32 v120, 16, v52
    v_and_b32 v121, 0xffff0000, v52
    v_fma_f32 v8, v120, v128, v8
    v_fma_f32 v9, v121, v128, v9
    v_lshlrev_b32 v120, 16, v53
    v_and_b32 v121, 0xffff0000, v53
    v_fma_f32 v10, v120, v128, v10
    v_fma_f32 v11, v121, v128, v11
    v_lshlrev_b32 v120, 16, v54
    v_and_b32 v121, 0xffff0000, v54
    v_fma_f32 v12, v120, v128, v12
    v_fma_f32 v13, v121, v128, v13
    v_lshlrev_b32 v120, 16, v55
    v_and_b32 v121, 0xffff0000, v55
    v_fma_f32 v14, v120, v128, v14
    v_fma_f32 v15, v121, v128, v15
    s_branch L_mrg_cvt
L_slow_first:
    v_mov_b32 v161, v160
    s_nop 1
    v_permlane32_swap_b32 v160, v161
    s_nop 1
    v_max_f32 v160, v160, v161
    v_cmp_gt_f32 vcc, v160, v159
    v_cmp_gt_f32 s[52:53], s36, v160
    s_nop 1
    s_or_b64 vcc, vcc, s[52:53]
    s_nop 4
    v_cndmask_b32 v156, v156, v160, vcc
    s_mov_b64 s[50:51], -1
    v_add_f32 v159, s37, v156
    s_branch L_slow_sub
L_slow:
    v_mov_b32 v161, v160
    s_nop 1
    v_permlane32_swap_b32 v160, v161
    s_nop 1
    v_max_f32 v160, v160, v161
    v_cmp_gt_f32 vcc, v160, v159
    s_nop 0
    s_cmp_eq_u64 vcc, 0
    s_cbranch_scc1 L_slow_sub
    v_max_f32 v161, v156, v160
    v_cndmask_b32 v161, v156, v161, vcc
    s_mov_b64 s[50:51], -1
    v_sub_f32 v162, v156, v161
    v_exp_f32 v162, v162
    v_mov_b32 v156, v161
    v_add_f32 v159, s37, v161
    v_mul_f32 v157, v157, v162
    v_mul_f32 v0, v162, v0
    v_mul_f32 v1, v162, v1
    v_mul_f32 v2, v162, v2
    v_mul_f32 v3, v162, v3
    v_mul_f32 v4, v162, v4
    v_mul_f32 v5, v162, v5
    v_mul_f32 v6, v162, v6
    v_mul_f32 v7, v162, v7
    v_mul_f32 v8, v162, v8
    v_mul_f32 v9, v162, v9
    v_mul_f32 v10, v162, v10
    v_mul_f32 v11, v162, v11
    v_mul_f32 v12, v162, v12
    v_mul_f32 v13, v162, v13
    v_mul_f32 v14, v162, v14
    v_mul_f32 v15, v162, v15
    v_mul_f32 v16, v162, v16
    v_mul_f32 v17, v162, v17
    v_mul_f32 v18, v162, v18
    v_mul_f32 v19, v162, v19
    v_mul_f32 v20, v162, v20
    v_mul_f32 v21, v162, v21
    v_mul_f32 v22, v162, v22
    v_mul_f32 v23, v162, v23
    v_mul_f32 v24, v162, v24
    v_mul_f32 v25, v162, v25
    v_mul_f32 v26, v162, v26
    v_mul_f32 v27, v162, v27
    v_mul_f32 v28, v162, v28
    v_mul_f32 v29, v162, v29
    v_mul_f32 v30, v162, v30
    v_mul_f32 v31, v162, v31
    v_mul_f32 v32, v162, v32
    v_mul_f32 v33, v162, v33
    v_mul_f32 v34, v162, v34
    v_mul_f32 v35, v162, v35
    v_mul_f32 v36, v162, v36
    v_mul_f32 v37, v162, v37
    v_mul_f32 v38, v162, v38
    v_mul_f32 v39, v162, v39
    v_mul_f32 v40, v162, v40
    v_mul_f32 v41, v162, v41
    v_mul_f32 v42, v162, v42
    v_mul_f32 v43, v162, v43
    v_mul_f32 v44, v162, v44
    v_mul_f32 v45, v162, v45
    v_mul_f32 v46, v162, v46
    v_mul_f32 v47, v162, v47
    v_mul_f32 v48, v162, v48
    v_mul_f32 v49, v162, v49
    v_mul_f32 v50, v162, v50
    v_mul_f32 v51, v162, v51
    v_mul_f32 v52, v162, v52
    v_mul_f32 v53, v162, v53
    v_mul_f32 v54, v162, v54
    v_mul_f32 v55, v162, v55
    v_mul_f32 v56, v162, v56
    v_mul_f32 v57, v162, v57
    v_mul_f32 v58, v162, v58
    v_mul_f32 v59, v162, v59
    v_mul_f32 v60, v162, v60
    v_mul_f32 v61, v162, v61
    v_mul_f32 v62, v162, v62
    v_mul_f32 v63, v162, v63
L_slow_sub:
    v_sub_f32 v96, v96, v156
    v_sub_f32 v97, v97, v156
    v_sub_f32 v98, v98, v156
    v_sub_f32 v99, v99, v156
    v_sub_f32 v100, v100, v156
    v_sub_f32 v101, v101, v156
    v_sub_f32 v102, v102, v156
    v_sub_f32 v103, v103, v156
    v_sub_f32 v104, v104, v156
    v_sub_f32 v105, v105, v156
    v_sub_f32 v106, v106, v156
    v_sub_f32 v107, v107, v156
    v_sub_f32 v108, v108, v156
    v_sub_f32 v109, v109, v156
    v_sub_f32 v110, v110, v156
    v_sub_f32 v111, v111, v156
    s_nop 1
    s_setpc_b64 s[38:39]
L_end:
    s_endpgm
L_code_end:

.section .rodata,"a"
.p2align 6
.amdhsa_kernel gqa_fused_kernel
  .amdhsa_next_free_vgpr 168
  .amdhsa_next_free_sgpr 102
  .amdhsa_accum_offset 168
  .amdhsa_group_segment_fixed_size 0
  .amdhsa_kernarg_size 104
  .amdhsa_user_sgpr_count 2
  .amdhsa_user_sgpr_kernarg_segment_ptr 1
  .amdhsa_system_sgpr_workgroup_id_x 1
.end_amdhsa_kernel
```
